```python
import torch

def _softmax(x, axis=-1):
    return torch.softmax(x, dim=axis)
def _gelu(x):
    return torch.nn.functional.gelu(x, approximate="tanh")
def _silu(x):
    return torch.nn.functional.silu(x)
def _sigmoid(x):
    return torch.sigmoid(x)
def _layernorm(x, axis=-1, eps=1e-5):
    m = x.mean(dim=axis, keepdim=True)
    v = x.var(dim=axis, keepdim=True, unbiased=False)
    return (x - m) / torch.sqrt(v + eps)
def _scatter_add(tgt, idx, src, axis=0):
    return tgt.clone().index_add_(axis, idx, src)
def _segment_sum(src, seg, n):
    out = torch.zeros((n,) + src.shape[1:], dtype=src.dtype)
    return out.index_add_(0, seg, src)
def _pad(x, pw):
    flat = tuple(v for pair in reversed(pw) for v in pair)
    return torch.nn.functional.pad(x, flat)

kernel_name = 'sequential_preLN__grouped_kv_mqa__mixer_s_mlp__prompt'

def setup_inputs():

    _w = (lambda a: (lambda t: t.to(torch.bfloat16) if t.is_floating_point() else t)(torch.as_tensor(a)))
    def _A_setup():
        B, S, D, H = 1, 2048, 512, 32
        Dh = D // H
        return {
            "x": _w((lambda *s: torch.randn(*s, dtype=torch.bfloat16) * 0.05)(B, S, D)),
            "wq": _w((lambda *s: torch.randn(*s, dtype=torch.bfloat16) * 0.05)(D, H * Dh)),
            "wk": _w((lambda *s: torch.randn(*s, dtype=torch.bfloat16) * 0.05)(D, Dh)),
            "wv": _w((lambda *s: torch.randn(*s, dtype=torch.bfloat16) * 0.05)(D, Dh)),
            "wo": _w((lambda *s: torch.randn(*s, dtype=torch.bfloat16) * 0.05)(H * Dh, D)),
        }
    _A_in = _A_setup()

    def _B_setup():
        B, S, D, F = 1, 2048, 512, 1792
        return {
            "x":  _w((lambda *s: torch.randn(*s, dtype=torch.bfloat16) * 0.05)(B, S, D)),
            "w1": _w((lambda *s: torch.randn(*s, dtype=torch.bfloat16) * 3.2)(D, D) * (D ** -0.5)),
            "w2": _w((lambda *s: torch.randn(*s, dtype=torch.bfloat16) * 3.2)(D, D) * (D ** -0.5)),
            "w3": _w((lambda *s: torch.randn(*s, dtype=torch.bfloat16) * 3.2)(D, F) * (D ** -0.5)),
            "w4": _w((lambda *s: torch.randn(*s, dtype=torch.bfloat16) * 1.6)(F, D) * (F ** -0.5)),
        }
    _B_in = _B_setup()

    return {
        "A_x": _A_in["x"],
        "A_wq": _A_in["wq"],
        "A_wk": _A_in["wk"],
        "A_wv": _A_in["wv"],
        "A_wo": _A_in["wo"],
        "B_x": _B_in["x"],
        "B_w1": _B_in["w1"],
        "B_w2": _B_in["w2"],
        "B_w3": _B_in["w3"],
        "B_w4": _B_in["w4"],
    }

def reference(A_x, A_wq, A_wk, A_wv, A_wo, B_x, B_w1, B_w2, B_w3, B_w4):
    def _A_ref(x, wq, wk, wv, wo):
        B, S, D = x.shape
        H = 32
        Dh = D // H
        q = (lambda x, *d: x.permute(*d))((x @ wq).reshape(B, S, H, Dh), 0, 2, 1, 3)
        k = x @ wk
        v = x @ wv
        scores = torch.einsum("bhqd,bkd->bhqk", q, k) * (Dh ** -0.5)
        p = _softmax(scores, axis=-1)
        o = torch.einsum("bhqk,bkd->bhqd", p, v)
        return (lambda x, *d: x.permute(*d))(o, 0, 2, 1, 3).reshape(B, S, H * Dh) @ wo

    def _B_ref(x, w1, w2, w3, w4):
        B, S, D = x.shape
        h = _gelu(_layernorm(x, axis=-1) @ w1)
        c = D // 4
        g0 = _pad(h[:, :, 0*c:1*c], ((0, 0), (1, 0), (0, 0)))[:, :S, :]
        g1 = _pad(h[:, :, 1*c:2*c], ((0, 0), (0, 1), (0, 0)))[:, 1:, :]
        g2 = _pad(h[:, :, 2*c:3*c], ((0, 0), (2, 0), (0, 0)))[:, :S, :]
        g3 = _pad(h[:, :, 3*c:   ], ((0, 0), (0, 2), (0, 0)))[:, 2:, :]
        hs = torch.concatenate([g0, g1, g2, g3], axis=-1) @ w2
        x1 = x + hs
        h2 = _gelu(_layernorm(x1, axis=-1) @ w3) @ w4
        return x1 + h2

    x = A_x
    h = x + _A_ref(_layernorm(x, axis=-1), A_wq, A_wk, A_wv, A_wo)
    h2 = h + _B_ref(_layernorm(h, axis=-1), B_w1, B_w2, B_w3, B_w4)
    return h2
```

```asm
; @launch grid=(256,1,1) block=(512,1,1) lds=163840
.amdgcn_target "amdgcn-amd-amdhsa--gfx950"
.text
.globl sequential_preLN__grouped_kv_mqa__mixer_s_mlp__prompt_kernel
.p2align 8
.type sequential_preLN__grouped_kv_mqa__mixer_s_mlp__prompt_kernel,@function
sequential_preLN__grouped_kv_mqa__mixer_s_mlp__prompt_kernel:
    s_cmp_ge_u32 s2, 256
    s_cbranch_scc1 K_end
    s_nop 0
    s_load_dwordx16 s[76:91], s[0:1], 0
    s_load_dwordx8 s[92:99], s[0:1], 64
    s_load_dwordx2 s[100:101], s[0:1], 96
    v_lshrrev_b32 v2, 6, v0
    v_and_b32 v0, 63, v0
    v_readfirstlane_b32 s49, v2
    s_and_b32 s59, s2, 7
    s_lshl_b32 s59, s59, 5
    s_lshr_b32 s52, s2, 3
    s_add_u32 s44, s59, s52
    s_lshr_b32 s45, s44, 3
    s_and_b32 s46, s44, 7
    v_lshlrev_b32 v1, 4, v0
    s_getpc_b64 s[72:73]
    s_and_b32 s59, s52, 1
    s_lshl_b32 s59, s59, 3
    s_add_u32 s59, s59, s49
    s_lshl_b32 s59, s59, 12
    v_and_b32 v13, 31, v0
    v_lshlrev_b32 v13, 7, v13
    v_add_u32 v14, s59, v13
    v_min_u32 v14, 0xac80, v14
    global_load_dword v62, v14, s[72:73]
    v_lshrrev_b32 v9, 4, v0
    v_and_b32 v10, 15, v0
    v_lshlrev_b32_e64 v8, 10, v9
    v_lshl_add_u32 v8, v10, 4, v8
    s_and_b32 s48, s46, 1
    s_lshl_b32 s60, s45, 16
    s_lshl_b32 s53, s49, 12
    s_add_u32 s60, s60, s53
    s_lshl_b32 s61, s48, 15
    s_add_u32 s60, s60, s61
    s_xor_b32 s61, s60, 0x8000
    v_lshrrev_b32 v11, 2, v0
    v_and_b32 v12, 3, v0
    v_lshlrev_b32_e64 v12, 4, v12
    v_lshl_add_u32 v3, v11, 10, v12
    s_waitcnt lgkmcnt(0)
    s_mov_b32 s4, s76
    s_mov_b32 s5, s77
    s_nop 0
    s_mov_b32 s6, 0x200000
    s_mov_b32 s7, 0x00020000
    s_add_u32 s62, s100, 0xe02000
    s_addc_u32 s63, s101, 0
    s_nop 0
    buffer_load_dwordx4 v[16:19], v8, s[4:7], s60 offen offset:0
    buffer_load_dwordx4 v[20:23], v8, s[4:7], s60 offen offset:256
    buffer_load_dwordx4 v[24:27], v8, s[4:7], s60 offen offset:512
    buffer_load_dwordx4 v[28:31], v8, s[4:7], s60 offen offset:768
    s_load_dword s40, s[62:63], 0
    s_cmp_lt_u32 s46, 2
    s_cselect_b32 s36, s80, s82
    s_cselect_b32 s37, s81, s83
    s_nop 0
    s_mov_b32 s38, 0x4000
    s_mov_b32 s39, 0x00020000
    s_lshl_b32 s59, s49, 11
    s_add_u32 m0, s59, 0
    s_barrier
    s_cmp_lt_u32 s46, 4
    s_cselect_b64 exec, -1, 0
    s_nop 0
    buffer_load_dwordx4 v1, s[36:39], s59 offen offset:0 lds
    buffer_load_dwordx4 v1, s[36:39], s59 offen offset:1024 lds
    s_mov_b64 exec, -1
    s_mov_b32 s32, s78
    s_mov_b32 s33, s79
    s_nop 0
    s_mov_b32 s34, 0x80000
    s_mov_b32 s35, 0x00020000
    s_lshl_b32 s60, s52, 14
    s_add_u32 s60, s60, s59
    s_mov_b64 exec, 0xffff
    buffer_load_dword v63, v13, s[32:35], s60 offen
    s_mov_b64 exec, -1
    s_mov_b32 s42, s61
    v_mov_b32 v61, v8
    s_and_b32 s57, s49, 1
    s_bfe_u32 s58, s49, 0x10001
    s_lshr_b32 s51, s49, 2
    s_lshr_b32 s60, s49, 1
    s_lshl_b32 s68, s60, 13
    s_lshl_b32 s59, s57, 15
    s_add_u32 s68, s68, s59
    s_lshl_b32 s60, s60, 17
    s_lshl_b32 s59, s46, 7
    s_add_u32 s60, s60, s59
    s_lshl_b32 s59, s57, 6
    s_add_u32 s69, s60, s59
    s_mov_b32 s28, s100
    s_mov_b32 s29, s101
    s_mov_b32 s30, 0x2000000
    s_mov_b32 s31, 0x00020000
    s_mov_b32 s8, s84
    s_mov_b32 s9, s85
    s_mov_b32 s10, 0x80000
    s_mov_b32 s11, 0x00020000
    s_mov_b32 s12, s88
    s_mov_b32 s13, s89
    s_mov_b32 s14, 0x80000
    s_mov_b32 s15, 0x00020000
    s_mov_b32 s16, s90
    s_mov_b32 s17, s91
    s_mov_b32 s18, 0x80000
    s_mov_b32 s19, 0x00020000
    s_mov_b32 s20, s92
    s_mov_b32 s21, s93
    s_mov_b32 s22, 0x1c0000
    s_mov_b32 s23, 0x00020000
    s_mov_b32 s24, s94
    s_mov_b32 s25, s95
    s_mov_b32 s26, 0x1c0000
    s_mov_b32 s27, 0x00020000
    s_mov_b32 s55, s96
    s_mov_b32 s56, s97
    s_mul_i32 s59, s48, 33792
    s_lshl_b32 s60, s49, 6
    s_add_u32 s60, s60, s59
    s_add_u32 s60, s60, 16384
    v_mul_u32_u24 v11, 528, v10
    v_lshl_add_u32 v11, v9, 4, v11
    v_add_u32_e64 v12, s60, v11
    s_sub_u32 s60, s60, s59
    s_sub_u32 s60, s60, s59
    s_add_u32 s60, s60, 33792
    v_add_u32 v11, s60, v11
    v_lshrrev_b32 v9, 5, v0
    v_mul_u32_u24 v9, 528, v9
    v_and_b32_e64 v10, 31, v0
    v_lshl_add_u32 v9, v10, 4, v9
    s_mul_i32 s60, s49, 8448
    s_add_u32 s60, s60, s59
    s_nop 0
    s_add_u32 s60, s60, 16384
    v_add_u32_e64 v10, s60, v9
    v_bfe_u32 v13, v0, 2, 1
    v_bfe_u32 v14, v0, 3, 1
    v_sub_u32_e64 v13, v13, v14
    s_lshl_b32 s60, s46, 5
    s_and_b32 s60, s60, 64
    v_mad_i32_i24 v10, v13, s60, v10
    s_mul_i32 s59, s51, 33792
    s_mul_i32 s60, s57, 16896
    s_add_u32 s60, s60, s59
    s_nop 0
    s_add_u32 s60, s60, 16384
    v_add_u32 v9, s60, v9
    v_lshrrev_b32 v13, 5, v0
    v_lshlrev_b32_e64 v13, 8, v13
    v_bfe_u32 v14, v0, 2, 2
    v_lshl_add_u32 v13, v14, 5, v13
    v_and_b32_e64 v14, 1, v0
    v_lshl_add_u32 v13, v14, 4, v13
    v_bfe_u32 v14, v0, 1, 1
    v_lshl_add_u32 v13, v14, 3, v13
    v_add_u32 v13, s53, v13
    v_lshrrev_b32 v4, 5, v0
    v_lshlrev_b32_e64 v4, 9, v4
    v_bfe_u32 v14, v0, 2, 2
    v_lshl_add_u32 v4, v14, 6, v4
    v_and_b32_e64 v14, 1, v0
    v_lshl_add_u32 v4, v14, 4, v4
    v_bfe_u32 v14, v0, 1, 1
    v_lshl_add_u32 v4, v14, 3, v4
    v_bfe_u32 v14, v0, 4, 1
    v_xor_b32_e64 v15, s57, v14
    v_lshl_add_u32 v8, v15, 5, v4
    v_lshl_add_u32 v4, v14, 5, v4
    s_lshl_b32 s59, s58, 15
    s_lshl_b32 s60, s57, 14
    s_add_u32 s59, s59, s60
    s_nop 0
    s_add_u32 s59, s59, 83968
    v_add_u32 v8, s59, v8
    v_add_u32 v4, s53, v4
    v_add_u32 v5, 0x20000, v4
    v_add_u32 v2, 0x10000, v1
    v_mov_b32 v15, 0x3f803f80
    s_waitcnt vmcnt(3)
    s_nop 0
    buffer_load_dwordx4 v[32:35], v61, s[4:7], s42 offen offset:0
    buffer_load_dwordx4 v[36:39], v61, s[4:7], s42 offen offset:256
    buffer_load_dwordx4 v[40:43], v61, s[4:7], s42 offen offset:512
    buffer_load_dwordx4 v[44:47], v61, s[4:7], s42 offen offset:768
    s_call_b64 s[74:75], L_norm
    s_nop 0
    s_add_u32 s40, s40, 0x9e3779b8
    s_and_b32 s40, s40, -8
    s_waitcnt vmcnt(5)
    s_cmp_lg_u32 s51, 0
    s_cbranch_scc1 LA_n1
LA_n1:
    s_barrier
    s_cmp_lt_u32 s46, 4
    s_cselect_b32 s67, s49, 8
    s_cmp_ge_u32 s67, 4
    s_cbranch_scc1 LA_nochain
    s_setprio 3
    ds_read_b64_tr_b16 v[64:65], v13 offset:0
    ds_read_b64_tr_b16 v[66:67], v13 offset:128
    ds_read_b128 v[128:131], v10 offset:0
    ds_read_b64_tr_b16 v[68:69], v13 offset:512
    ds_read_b64_tr_b16 v[70:71], v13 offset:640
    ds_read_b128 v[132:135], v10 offset:1056
    ds_read_b64_tr_b16 v[72:73], v13 offset:1024
    ds_read_b64_tr_b16 v[74:75], v13 offset:1152
    ds_read_b128 v[136:139], v10 offset:2112
    ds_read_b64_tr_b16 v[76:77], v13 offset:1536
    ds_read_b64_tr_b16 v[78:79], v13 offset:1664
    ds_read_b128 v[140:143], v10 offset:3168
    ds_read_b64_tr_b16 v[80:81], v13 offset:2048
    ds_read_b64_tr_b16 v[82:83], v13 offset:2176
    ds_read_b128 v[144:147], v10 offset:4224
    ds_read_b64_tr_b16 v[84:85], v13 offset:2560
    ds_read_b64_tr_b16 v[86:87], v13 offset:2688
    ds_read_b128 v[148:151], v10 offset:5280
    ds_read_b64_tr_b16 v[88:89], v13 offset:3072
    ds_read_b64_tr_b16 v[90:91], v13 offset:3200
    ds_read_b128 v[152:155], v10 offset:6336
    ds_read_b64_tr_b16 v[92:93], v13 offset:3584
    ds_read_b64_tr_b16 v[94:95], v13 offset:3712
    ds_read_b128 v[156:159], v10 offset:7392
    s_lshl_b32 s59, s49, 11
    s_nop 0
    s_add_u32 s59, s59, 149504
    v_add_u32 v14, s59, v1
    s_cmp_lt_u32 s46, 2
    s_cbranch_scc0 LA_v
    s_waitcnt lgkmcnt(15)
    v_mfma_f32_32x32x16_bf16 v[192:207], v[64:67], v[128:131], 0
    s_waitcnt lgkmcnt(15)
    s_nop 0
    v_mfma_f32_32x32x16_bf16 v[192:207], v[68:71], v[132:135], v[192:207]
    s_waitcnt lgkmcnt(15)
    s_nop 0
    v_mfma_f32_32x32x16_bf16 v[192:207], v[72:75], v[136:139], v[192:207]
    s_waitcnt lgkmcnt(12)
    s_nop 0
    v_mfma_f32_32x32x16_bf16 v[192:207], v[76:79], v[140:143], v[192:207]
    s_waitcnt lgkmcnt(9)
    s_nop 0
    v_mfma_f32_32x32x16_bf16 v[192:207], v[80:83], v[144:147], v[192:207]
    s_waitcnt lgkmcnt(6)
    s_nop 0
    v_mfma_f32_32x32x16_bf16 v[192:207], v[84:87], v[148:151], v[192:207]
    s_waitcnt lgkmcnt(3)
    s_nop 0
    v_mfma_f32_32x32x16_bf16 v[192:207], v[88:91], v[152:155], v[192:207]
    s_waitcnt lgkmcnt(0)
    s_nop 0
    v_mfma_f32_32x32x16_bf16 v[192:207], v[92:95], v[156:159], v[192:207]
    s_nop 11
    s_branch LA_part
LA_v:
    s_waitcnt lgkmcnt(15)
    s_nop 0
    v_mfma_f32_32x32x16_bf16 v[192:207], v[128:131], v[64:67], 0
    s_waitcnt lgkmcnt(15)
    s_nop 0
    v_mfma_f32_32x32x16_bf16 v[192:207], v[132:135], v[68:71], v[192:207]
    s_waitcnt lgkmcnt(15)
    s_nop 0
    v_mfma_f32_32x32x16_bf16 v[192:207], v[136:139], v[72:75], v[192:207]
    s_waitcnt lgkmcnt(12)
    s_nop 0
    v_mfma_f32_32x32x16_bf16 v[192:207], v[140:143], v[76:79], v[192:207]
    s_waitcnt lgkmcnt(9)
    s_nop 0
    v_mfma_f32_32x32x16_bf16 v[192:207], v[144:147], v[80:83], v[192:207]
    s_waitcnt lgkmcnt(6)
    s_nop 0
    v_mfma_f32_32x32x16_bf16 v[192:207], v[148:151], v[84:87], v[192:207]
    s_waitcnt lgkmcnt(3)
    s_nop 0
    v_mfma_f32_32x32x16_bf16 v[192:207], v[152:155], v[88:91], v[192:207]
    s_waitcnt lgkmcnt(0)
    s_nop 0
    v_mfma_f32_32x32x16_bf16 v[192:207], v[156:159], v[92:95], v[192:207]
    v_and_b32_e64 v60, 16, v0
    v_cmp_eq_u32 vcc, 0, v60
    s_nop 9
    v_cndmask_b32 v192, v192, v200, vcc
    v_cndmask_b32 v193, v193, v201, vcc
    v_cndmask_b32 v194, v194, v202, vcc
    v_cndmask_b32 v195, v195, v203, vcc
    v_cndmask_b32 v196, v196, v204, vcc
    v_cndmask_b32 v197, v197, v205, vcc
    v_cndmask_b32 v198, v198, v206, vcc
    v_cndmask_b32 v199, v199, v207, vcc
LA_part:
    ds_write_b128 v14, v[192:195]
    ds_write_b128 v14, v[196:199] offset:1024
    s_waitcnt lgkmcnt(0)
    s_setprio 0
    s_barrier
    s_nop 0
    s_add_u32 m0, s68, 83968
    s_add_u32 s59, s69, 0
    s_nop 0
    buffer_load_dwordx4 v3, s[32:35], s59 offen offset:0 lds
    s_add_u32 s59, s69, 15360
    buffer_load_dwordx4 v3, s[32:35], s59 offen offset:1024 lds
    s_add_u32 s59, s69, 30720
    buffer_load_dwordx4 v3, s[32:35], s59 offen offset:2048 lds
    s_add_u32 s59, s69, 46080
    buffer_load_dwordx4 v3, s[32:35], s59 offen offset:3072 lds
    s_add_u32 m0, s68, 88064
    s_add_u32 s59, s69, 65536
    buffer_load_dwordx4 v3, s[32:35], s59 offen offset:0 lds
    s_add_u32 s59, s69, 80896
    buffer_load_dwordx4 v3, s[32:35], s59 offen offset:1024 lds
    s_add_u32 s59, s69, 96256
    buffer_load_dwordx4 v3, s[32:35], s59 offen offset:2048 lds
    s_add_u32 s59, s69, 111616
    buffer_load_dwordx4 v3, s[32:35], s59 offen offset:3072 lds
    s_branch LA_join
LA_nochain:
    s_cmp_eq_u32 s67, 4
    s_cbranch_scc1 LA_fin
    s_cmp_eq_u32 s51, 0
    s_cbranch_scc1 LA_n2
LA_n2:
    s_nop 0
    s_add_u32 m0, s68, 83968
    s_add_u32 s59, s69, 0
    s_nop 0
    buffer_load_dwordx4 v3, s[32:35], s59 offen offset:0 lds
    s_add_u32 s59, s69, 15360
    buffer_load_dwordx4 v3, s[32:35], s59 offen offset:1024 lds
    s_add_u32 s59, s69, 30720
    buffer_load_dwordx4 v3, s[32:35], s59 offen offset:2048 lds
    s_add_u32 s59, s69, 46080
    buffer_load_dwordx4 v3, s[32:35], s59 offen offset:3072 lds
    s_add_u32 m0, s68, 88064
    s_add_u32 s59, s69, 65536
    buffer_load_dwordx4 v3, s[32:35], s59 offen offset:0 lds
    s_add_u32 s59, s69, 80896
    buffer_load_dwordx4 v3, s[32:35], s59 offen offset:1024 lds
    s_add_u32 s59, s69, 96256
    buffer_load_dwordx4 v3, s[32:35], s59 offen offset:2048 lds
    s_add_u32 s59, s69, 111616
    buffer_load_dwordx4 v3, s[32:35], s59 offen offset:3072 lds
    s_barrier
    s_branch LA_join
LA_fin:
    s_setprio 3
    s_nop 0
    v_add_u32 v14, 0x24800, v1
    s_barrier
    s_nop 0
    ds_read_b128 v[64:67], v14 offset:0
    ds_read_b128 v[68:71], v14 offset:1024
    ds_read_b128 v[72:75], v14 offset:2048
    ds_read_b128 v[76:79], v14 offset:3072
    ds_read_b128 v[80:83], v14 offset:4096
    ds_read_b128 v[84:87], v14 offset:5120
    ds_read_b128 v[88:91], v14 offset:6144
    ds_read_b128 v[92:95], v14 offset:7168
    s_lshl_b32 s59, s45, 1
    s_add_u32 s59, s59, s48
    s_lshl_b32 s59, s59, 1
    s_lshr_b32 s60, s46, 1
    s_add_u32 s59, s59, s60
    s_lshl_b32 s60, s59, 10
    s_add_u32 s60, s60, 0x200000
    s_waitcnt lgkmcnt(0)
    s_nop 0
    v_pk_add_f32 v[64:65], v[64:65], v[72:73]
    v_pk_add_f32 v[80:81], v[80:81], v[88:89]
    v_pk_add_f32 v[66:67], v[66:67], v[74:75]
    v_pk_add_f32 v[82:83], v[82:83], v[90:91]
    v_pk_add_f32 v[68:69], v[68:69], v[76:77]
    v_pk_add_f32 v[84:85], v[84:85], v[92:93]
    v_pk_add_f32 v[70:71], v[70:71], v[78:79]
    v_pk_add_f32 v[86:87], v[86:87], v[94:95]
    v_pk_add_f32 v[64:65], v[64:65], v[80:81]
    v_pk_add_f32 v[66:67], v[66:67], v[82:83]
    v_pk_add_f32 v[68:69], v[68:69], v[84:85]
    v_pk_add_f32 v[70:71], v[70:71], v[86:87]
    v_cvt_pk_bf16_f32 v72, v64, v65
    v_cvt_pk_bf16_f32 v73, v66, v67
    v_cvt_pk_bf16_f32 v74, v68, v69
    v_cvt_pk_bf16_f32 v75, v70, v71
    buffer_store_dwordx4 v[72:75], v1, s[28:31], s60 offen sc1
    s_add_u32 m0, s68, 83968
    s_add_u32 s59, s69, 0
    s_nop 0
    buffer_load_dwordx4 v3, s[32:35], s59 offen offset:0 lds
    s_add_u32 s59, s69, 15360
    buffer_load_dwordx4 v3, s[32:35], s59 offen offset:1024 lds
    s_add_u32 s59, s69, 30720
    buffer_load_dwordx4 v3, s[32:35], s59 offen offset:2048 lds
    s_add_u32 s59, s69, 46080
    buffer_load_dwordx4 v3, s[32:35], s59 offen offset:3072 lds
    s_add_u32 m0, s68, 88064
    s_add_u32 s59, s69, 65536
    buffer_load_dwordx4 v3, s[32:35], s59 offen offset:0 lds
    s_add_u32 s59, s69, 80896
    buffer_load_dwordx4 v3, s[32:35], s59 offen offset:1024 lds
    s_add_u32 s59, s69, 96256
    buffer_load_dwordx4 v3, s[32:35], s59 offen offset:2048 lds
    s_add_u32 s59, s69, 111616
    buffer_load_dwordx4 v3, s[32:35], s59 offen offset:3072 lds
    v_mov_b32 v60, s40
    s_lshl_b32 s59, s45, 7
    s_lshl_b32 s60, s46, 2
    s_add_u32 s59, s59, s60
    s_add_u32 s59, s59, 0xe00000
    s_waitcnt vmcnt(8)
    s_mov_b64 exec, 1
    buffer_store_dword v60, v1, s[28:31], s59 offen sc1
    s_mov_b64 exec, -1
    s_setprio 0
    v_mov_b32 v16, v32
    v_mov_b32 v17, v33
    v_mov_b32 v18, v34
    v_mov_b32 v19, v35
    v_mov_b32 v20, v36
    v_mov_b32 v21, v37
    v_mov_b32 v22, v38
    v_mov_b32 v23, v39
    v_mov_b32 v24, v40
    v_mov_b32 v25, v41
    v_mov_b32 v26, v42
    v_mov_b32 v27, v43
    v_mov_b32 v28, v44
    v_mov_b32 v29, v45
    v_mov_b32 v30, v46
    v_mov_b32 v31, v47
    v_mov_b32 v12, v11
    s_call_b64 s[74:75], L_norm
    s_waitcnt vmcnt(1)
    s_branch LA_join2
L_norm:
    v_dot2_f32_bf16 v48, v16, v15, 0
    v_dot2_f32_bf16 v49, v16, v16, 0
    v_dot2_f32_bf16 v48, v17, v15, v48
    v_dot2_f32_bf16 v49, v17, v17, v49
    v_dot2_f32_bf16 v48, v18, v15, v48
    v_dot2_f32_bf16 v49, v18, v18, v49
    v_dot2_f32_bf16 v48, v19, v15, v48
    v_dot2_f32_bf16 v49, v19, v19, v49
    v_dot2_f32_bf16 v48, v20, v15, v48
    v_dot2_f32_bf16 v49, v20, v20, v49
    v_dot2_f32_bf16 v48, v21, v15, v48
    v_dot2_f32_bf16 v49, v21, v21, v49
    v_dot2_f32_bf16 v48, v22, v15, v48
    v_dot2_f32_bf16 v49, v22, v22, v49
    v_dot2_f32_bf16 v48, v23, v15, v48
    v_dot2_f32_bf16 v49, v23, v23, v49
    v_dot2_f32_bf16 v48, v24, v15, v48
    v_dot2_f32_bf16 v49, v24, v24, v49
    v_dot2_f32_bf16 v48, v25, v15, v48
    v_dot2_f32_bf16 v49, v25, v25, v49
    v_dot2_f32_bf16 v48, v26, v15, v48
    v_dot2_f32_bf16 v49, v26, v26, v49
    v_dot2_f32_bf16 v48, v27, v15, v48
    v_dot2_f32_bf16 v49, v27, v27, v49
    v_dot2_f32_bf16 v48, v28, v15, v48
    v_dot2_f32_bf16 v49, v28, v28, v49
    v_dot2_f32_bf16 v48, v29, v15, v48
    v_dot2_f32_bf16 v49, v29, v29, v49
    v_dot2_f32_bf16 v48, v30, v15, v48
    v_dot2_f32_bf16 v49, v30, v30, v49
    v_dot2_f32_bf16 v48, v31, v15, v48
    v_dot2_f32_bf16 v49, v31, v31, v49
    s_nop 2
    s_nop 0
    v_add_f32_dpp v48, v48, v48 quad_perm:[1,0,3,2] row_mask:0xf bank_mask:0xf
    v_add_f32_dpp v49, v49, v49 quad_perm:[1,0,3,2] row_mask:0xf bank_mask:0xf
    s_nop 0
    s_nop 0
    v_add_f32_dpp v48, v48, v48 quad_perm:[2,3,0,1] row_mask:0xf bank_mask:0xf
    v_add_f32_dpp v49, v49, v49 quad_perm:[2,3,0,1] row_mask:0xf bank_mask:0xf
    s_nop 0
    s_nop 0
    v_add_f32_dpp v48, v48, v48 row_half_mirror row_mask:0xf bank_mask:0xf
    v_add_f32_dpp v49, v49, v49 row_half_mirror row_mask:0xf bank_mask:0xf
    s_nop 0
    s_nop 0
    v_add_f32_dpp v48, v48, v48 row_mirror row_mask:0xf bank_mask:0xf
    v_add_f32_dpp v49, v49, v49 row_mirror row_mask:0xf bank_mask:0xf
    s_nop 0
    s_nop 0
    v_mul_f32 v48, 0x3b000000, v48
    v_mul_f32 v49, 0x3b000000, v49
    v_fma_f32 v49, -v48, v48, v49
    v_max_f32_e64 v49, 0, v49
    v_add_f32 v49, 0x3727c5ac, v49
    v_rsq_f32 v50, v49
    s_nop 0
    v_mul_f32 v48, v48, v50
    v_lshlrev_b32 v52, 16, v16
    v_and_b32 v53, 0xffff0000, v16
    v_lshlrev_b32_e64 v54, 16, v17
    v_and_b32 v55, 0xffff0000, v17
    v_lshlrev_b32_e64 v56, 16, v18
    v_and_b32 v57, 0xffff0000, v18
    v_lshlrev_b32_e64 v58, 16, v19
    v_and_b32 v59, 0xffff0000, v19
    v_pk_fma_f32 v[52:53], v[52:53], v[50:51], v[48:49] op_sel_hi:[1,0,0] neg_lo:[0,0,1] neg_hi:[0,0,1]
    v_pk_fma_f32 v[54:55], v[54:55], v[50:51], v[48:49] op_sel_hi:[1,0,0] neg_lo:[0,0,1] neg_hi:[0,0,1]
    v_pk_fma_f32 v[56:57], v[56:57], v[50:51], v[48:49] op_sel_hi:[1,0,0] neg_lo:[0,0,1] neg_hi:[0,0,1]
    v_pk_fma_f32 v[58:59], v[58:59], v[50:51], v[48:49] op_sel_hi:[1,0,0] neg_lo:[0,0,1] neg_hi:[0,0,1]
    v_cvt_pk_bf16_f32 v224, v52, v53
    v_cvt_pk_bf16_f32 v225, v54, v55
    v_cvt_pk_bf16_f32 v226, v56, v57
    v_cvt_pk_bf16_f32 v227, v58, v59
    ds_write_b128 v12, v[224:227] offset:0
    v_lshlrev_b32_e64 v52, 16, v20
    v_and_b32 v53, 0xffff0000, v20
    v_lshlrev_b32_e64 v54, 16, v21
    v_and_b32 v55, 0xffff0000, v21
    v_lshlrev_b32_e64 v56, 16, v22
    v_and_b32 v57, 0xffff0000, v22
    v_lshlrev_b32_e64 v58, 16, v23
    v_and_b32 v59, 0xffff0000, v23
    v_pk_fma_f32 v[52:53], v[52:53], v[50:51], v[48:49] op_sel_hi:[1,0,0] neg_lo:[0,0,1] neg_hi:[0,0,1]
    v_pk_fma_f32 v[54:55], v[54:55], v[50:51], v[48:49] op_sel_hi:[1,0,0] neg_lo:[0,0,1] neg_hi:[0,0,1]
    v_pk_fma_f32 v[56:57], v[56:57], v[50:51], v[48:49] op_sel_hi:[1,0,0] neg_lo:[0,0,1] neg_hi:[0,0,1]
    v_pk_fma_f32 v[58:59], v[58:59], v[50:51], v[48:49] op_sel_hi:[1,0,0] neg_lo:[0,0,1] neg_hi:[0,0,1]
    v_cvt_pk_bf16_f32 v228, v52, v53
    v_cvt_pk_bf16_f32 v229, v54, v55
    v_cvt_pk_bf16_f32 v230, v56, v57
    v_cvt_pk_bf16_f32 v231, v58, v59
    ds_write_b128 v12, v[228:231] offset:8448
    v_lshlrev_b32_e64 v52, 16, v24
    v_and_b32 v53, 0xffff0000, v24
    v_lshlrev_b32_e64 v54, 16, v25
    v_and_b32 v55, 0xffff0000, v25
    v_lshlrev_b32_e64 v56, 16, v26
    v_and_b32 v57, 0xffff0000, v26
    v_lshlrev_b32_e64 v58, 16, v27
    v_and_b32 v59, 0xffff0000, v27
    v_pk_fma_f32 v[52:53], v[52:53], v[50:51], v[48:49] op_sel_hi:[1,0,0] neg_lo:[0,0,1] neg_hi:[0,0,1]
    v_pk_fma_f32 v[54:55], v[54:55], v[50:51], v[48:49] op_sel_hi:[1,0,0] neg_lo:[0,0,1] neg_hi:[0,0,1]
    v_pk_fma_f32 v[56:57], v[56:57], v[50:51], v[48:49] op_sel_hi:[1,0,0] neg_lo:[0,0,1] neg_hi:[0,0,1]
    v_pk_fma_f32 v[58:59], v[58:59], v[50:51], v[48:49] op_sel_hi:[1,0,0] neg_lo:[0,0,1] neg_hi:[0,0,1]
    v_cvt_pk_bf16_f32 v232, v52, v53
    v_cvt_pk_bf16_f32 v233, v54, v55
    v_cvt_pk_bf16_f32 v234, v56, v57
    v_cvt_pk_bf16_f32 v235, v58, v59
    ds_write_b128 v12, v[232:235] offset:16896
    v_lshlrev_b32_e64 v52, 16, v28
    v_and_b32 v53, 0xffff0000, v28
    v_lshlrev_b32_e64 v54, 16, v29
    v_and_b32 v55, 0xffff0000, v29
    v_lshlrev_b32_e64 v56, 16, v30
    v_and_b32 v57, 0xffff0000, v30
    v_lshlrev_b32_e64 v58, 16, v31
    v_and_b32 v59, 0xffff0000, v31
    v_pk_fma_f32 v[52:53], v[52:53], v[50:51], v[48:49] op_sel_hi:[1,0,0] neg_lo:[0,0,1] neg_hi:[0,0,1]
    v_pk_fma_f32 v[54:55], v[54:55], v[50:51], v[48:49] op_sel_hi:[1,0,0] neg_lo:[0,0,1] neg_hi:[0,0,1]
    v_pk_fma_f32 v[56:57], v[56:57], v[50:51], v[48:49] op_sel_hi:[1,0,0] neg_lo:[0,0,1] neg_hi:[0,0,1]
    v_pk_fma_f32 v[58:59], v[58:59], v[50:51], v[48:49] op_sel_hi:[1,0,0] neg_lo:[0,0,1] neg_hi:[0,0,1]
    v_cvt_pk_bf16_f32 v236, v52, v53
    v_cvt_pk_bf16_f32 v237, v54, v55
    v_cvt_pk_bf16_f32 v238, v56, v57
    v_cvt_pk_bf16_f32 v239, v58, v59
    ds_write_b128 v12, v[236:239] offset:25344
    s_waitcnt lgkmcnt(0)
    s_setpc_b64 s[74:75]
LA_join:
    s_waitcnt vmcnt(8)
    v_mov_b32 v16, v32
    v_mov_b32 v17, v33
    v_mov_b32 v18, v34
    v_mov_b32 v19, v35
    v_mov_b32 v20, v36
    v_mov_b32 v21, v37
    v_mov_b32 v22, v38
    v_mov_b32 v23, v39
    v_mov_b32 v24, v40
    v_mov_b32 v25, v41
    v_mov_b32 v26, v42
    v_mov_b32 v27, v43
    v_mov_b32 v28, v44
    v_mov_b32 v29, v45
    v_mov_b32 v30, v46
    v_mov_b32 v31, v47
    v_mov_b32_e64 v12, v11
    s_call_b64 s[74:75], L_norm
    s_waitcnt vmcnt(0)
LA_join2:
    s_barrier
    ds_read_b64_tr_b16 v[64:65], v8 offset:0
    ds_read_b64_tr_b16 v[66:67], v8 offset:256
    ds_read_b128 v[128:131], v9 offset:0
    ds_read_b64_tr_b16 v[68:69], v8 offset:1024
    ds_read_b64_tr_b16 v[70:71], v8 offset:1280
    ds_read_b128 v[132:135], v9 offset:1056
    ds_read_b64_tr_b16 v[72:73], v8 offset:2048
    ds_read_b64_tr_b16 v[74:75], v8 offset:2304
    ds_read_b128 v[136:139], v9 offset:2112
    ds_read_b64_tr_b16 v[76:77], v8 offset:3072
    ds_read_b64_tr_b16 v[78:79], v8 offset:3328
    ds_read_b128 v[140:143], v9 offset:3168
    ds_read_b64_tr_b16 v[80:81], v8 offset:4096
    ds_read_b64_tr_b16 v[82:83], v8 offset:4352
    ds_read_b128 v[144:147], v9 offset:4224
    s_waitcnt lgkmcnt(12)
    s_nop 0
    v_mfma_f32_32x32x16_bf16 v[208:223], v[64:67], v[128:131], 0
    s_add_u32 s32, s28, 0x800000
    s_addc_u32 s33, s29, 0
    s_nop 0
    s_mov_b32 s34, 0x200000
    s_mov_b32 s35, 0x00020000
    ds_read_b64_tr_b16 v[84:85], v8 offset:5120
    ds_read_b64_tr_b16 v[86:87], v8 offset:5376
    ds_read_b128 v[148:151], v9 offset:5280
    s_waitcnt lgkmcnt(12)
    s_nop 0
    v_mfma_f32_32x32x16_bf16 v[208:223], v[68:71], v[132:135], v[208:223]
    s_mov_b32 s36, s55
    s_mov_b32 s37, s56
    s_mov_b32 s38, 0x200000
    s_mov_b32 s39, 0x00020000
    ds_read_b64_tr_b16 v[88:89], v8 offset:6144
    ds_read_b64_tr_b16 v[90:91], v8 offset:6400
    ds_read_b128 v[152:155], v9 offset:6336
    s_waitcnt lgkmcnt(12)
    s_nop 0
    v_mfma_f32_32x32x16_bf16 v[208:223], v[72:75], v[136:139], v[208:223]
    s_lshr_b32 s47, s44, 2
    s_and_b32 s48, s44, 3
    s_and_b32 s50, s49, 3
    s_lshr_b32 s43, s45, 2
    ds_read_b64_tr_b16 v[92:93], v8 offset:7168
    ds_read_b64_tr_b16 v[94:95], v8 offset:7424
    ds_read_b128 v[156:159], v9 offset:7392
    s_waitcnt lgkmcnt(12)
    s_nop 0
    v_mfma_f32_32x32x16_bf16 v[208:223], v[76:79], v[140:143], v[208:223]
    s_lshl_b32 s54, s51, 18
    s_lshl_b32 s59, s48, 8
    s_add_u32 s54, s54, s59
    s_lshl_b32 s59, s50, 6
    s_add_u32 s54, s54, s59
    s_nop 0
    ds_read_b64_tr_b16 v[96:97], v8 offset:8192
    ds_read_b64_tr_b16 v[98:99], v8 offset:8448
    ds_read_b128 v[160:163], v9 offset:8448
    s_waitcnt lgkmcnt(12)
    s_nop 0
    v_mfma_f32_32x32x16_bf16 v[208:223], v[80:83], v[144:147], v[208:223]
    s_mul_i32 s55, s46, 448
    s_min_u32 s59, s49, 6
    s_lshl_b32 s59, s59, 6
    s_add_u32 s55, s55, s59
    s_nop 0
    ds_read_b64_tr_b16 v[100:101], v8 offset:9216
    ds_read_b64_tr_b16 v[102:103], v8 offset:9472
    ds_read_b128 v[164:167], v9 offset:9504
    s_waitcnt lgkmcnt(12)
    s_nop 0
    v_mfma_f32_32x32x16_bf16 v[208:223], v[84:87], v[148:151], v[208:223]
    s_and_b32 s61, s54, 0x3ff
    s_xor_b32 s59, s46, 2
    s_and_b32 s59, s59, 6
    s_cmp_eq_u32 s51, 0
    s_cselect_b32 s59, s46, s59
    ds_read_b64_tr_b16 v[104:105], v8 offset:10240
    ds_read_b64_tr_b16 v[106:107], v8 offset:10496
    ds_read_b128 v[168:171], v9 offset:10560
    s_waitcnt lgkmcnt(12)
    s_nop 0
    v_mfma_f32_32x32x16_bf16 v[208:223], v[88:91], v[152:155], v[208:223]
    s_mul_i32 s56, s59, 229376
    s_add_u32 s56, s56, s61
    s_xor_b32 s59, s59, 1
    s_mul_i32 s69, s59, 229376
    s_add_u32 s69, s69, s61
    s_nop 0
    ds_read_b64_tr_b16 v[108:109], v8 offset:11264
    ds_read_b64_tr_b16 v[110:111], v8 offset:11520
    ds_read_b128 v[172:175], v9 offset:11616
    s_waitcnt lgkmcnt(12)
    s_nop 0
    v_mfma_f32_32x32x16_bf16 v[208:223], v[92:95], v[156:159], v[208:223]
    s_lshl_b32 s59, s45, 1
    s_add_u32 s59, s59, s51
    s_lshl_b32 s59, s59, 5
    s_lshl_b32 s60, s46, 2
    ds_read_b64_tr_b16 v[112:113], v8 offset:12288
    ds_read_b64_tr_b16 v[114:115], v8 offset:12544
    ds_read_b128 v[176:179], v9 offset:12672
    s_waitcnt lgkmcnt(12)
    s_nop 0
    v_mfma_f32_32x32x16_bf16 v[208:223], v[96:99], v[160:163], v[208:223]
    s_add_u32 s59, s59, s60
    s_add_u32 s59, s59, s50
    s_lshl_b32 s59, s59, 10
    s_nop 0
    s_add_u32 s68, s59, 0x400000
    ds_read_b64_tr_b16 v[116:117], v8 offset:13312
    ds_read_b64_tr_b16 v[118:119], v8 offset:13568
    ds_read_b128 v[180:183], v9 offset:13728
    s_waitcnt lgkmcnt(12)
    s_nop 0
    v_mfma_f32_32x32x16_bf16 v[208:223], v[100:103], v[164:167], v[208:223]
    s_mov_b32 s62, 0xffff0000
    s_mov_b32 s63, 0xffff0000
    ds_read_b64_tr_b16 v[120:121], v8 offset:14336
    ds_read_b64_tr_b16 v[122:123], v8 offset:14592
    ds_read_b128 v[184:187], v9 offset:14784
    s_waitcnt lgkmcnt(12)
    s_nop 0
    v_mfma_f32_32x32x16_bf16 v[208:223], v[104:107], v[168:171], v[208:223]
    s_getreg_b32 s66, hwreg(HW_REG_XCC_ID)
    s_and_b32 s66, s66, 7
    s_or_b32 s66, s66, s40
    s_nop 0
    ds_read_b64_tr_b16 v[124:125], v8 offset:15360
    ds_read_b64_tr_b16 v[126:127], v8 offset:15616
    ds_read_b128 v[188:191], v9 offset:15840
    s_waitcnt lgkmcnt(12)
    s_nop 0
    v_mfma_f32_32x32x16_bf16 v[208:223], v[108:111], v[172:175], v[208:223]
    s_cmp_lg_u32 s49, 7
    s_cselect_b64 s[72:73], -1, 0
    v_lshrrev_b32_e64 v6, 2, v0
    v_mul_u32_u24 v6, 3584, v6
    v_and_b32_e64 v14, 3, v0
    v_lshl_add_u32 v6, v14, 4, v6
    s_waitcnt lgkmcnt(9)
    s_nop 0
    v_mfma_f32_32x32x16_bf16 v[208:223], v[112:115], v[176:179], v[208:223]
    v_lshlrev_b32 v243, 7, v0
    v_and_b32 v14, 32, v0
    v_lshl_or_b32 v243, v14, 25, v243
    s_waitcnt lgkmcnt(6)
    s_nop 0
    v_mfma_f32_32x32x16_bf16 v[208:223], v[116:119], v[180:183], v[208:223]
    s_lshl_b32 s59, s49, 11
    s_nop 0
    s_add_u32 s59, s59, 131072
    v_add_u32_e64 v12, s59, v1
    v_xor_b32 v13, 0x800, v12
    s_waitcnt lgkmcnt(3)
    s_nop 0
    v_mfma_f32_32x32x16_bf16 v[208:223], v[120:123], v[184:187], v[208:223]
    s_waitcnt lgkmcnt(0)
    s_nop 0
    v_mfma_f32_32x32x16_bf16 v[208:223], v[124:127], v[188:191], v[208:223]
    s_lshl_b32 s59, s44, 13
    s_lshl_b32 s61, s49, 10
    s_add_u32 s57, s59, s61
    s_lshl_b32 s60, s50, 11
    s_add_u32 s58, s59, s60
    s_barrier
    s_nop 4
    s_nop 0
    ds_write_b128 v12, v[216:219]
    ds_write_b128 v12, v[220:223] offset:1024
    s_cmp_lg_u32 s49, 0
    s_cbranch_scc1 LA_kvok
    v_and_b32 v14, 31, v0
    v_lshlrev_b32_e64 v14, 7, v14
    s_mov_b32 s67, 0
    s_mov_b32 s59, 0xe00000
LA_kvw:
    buffer_load_dwordx4 v[16:19], v14, s[28:31], s59 offen sc1
    s_add_u32 s67, s67, 1
    s_waitcnt vmcnt(0)
    v_xor_b32 v16, s40, v16
    v_xor_b32 v17, s40, v17
    v_xor_b32 v18, s40, v18
    v_xor_b32 v19, s40, v19
    v_or3_b32 v16, v16, v17, v18
    v_or_b32_e64 v16, v16, v19
    v_cmp_ne_u32 vcc, 0, v16
    s_cbranch_vccz LA_kvok
    s_cmp_lt_u32 s67, 1000000
    s_cbranch_scc1 LA_kvw
LA_kvok:
    s_waitcnt lgkmcnt(0)
    s_barrier
    s_lshl_b32 s61, s49, 10
    s_add_u32 m0, s61, 0
    s_nop 0
    s_add_u32 s59, s61, 0x200000
    buffer_load_dwordx4 v1, s[28:31], s59 offen sc1 lds
    s_lshl_b32 s61, s49, 10
    s_nop 0
    s_add_u32 m0, s61, 8192
    s_add_u32 s59, s61, 0x202000
    buffer_load_dwordx4 v1, s[28:31], s59 offen sc1 lds
    s_lshl_b32 s61, s49, 10
    s_nop 0
    s_add_u32 m0, s61, 16384
    s_add_u32 s59, s61, 0x204000
    buffer_load_dwordx4 v1, s[28:31], s59 offen sc1 lds
    ds_read_b128 v[8:11], v13
    ds_read_b128 v[16:19], v13 offset:1024
    s_mov_b32 s60, 0x3eb8aa3b
    s_waitcnt lgkmcnt(0)
    v_add_f32 v208, v208, v8
    v_add_f32 v209, v209, v9
    v_add_f32 v210, v210, v10
    v_add_f32 v211, v211, v11
    v_add_f32 v212, v212, v16
    v_add_f32 v213, v213, v17
    v_add_f32 v214, v214, v18
    v_add_f32 v215, v215, v19
    v_mul_f32 v208, s60, v208
    v_mul_f32 v209, s60, v209
    v_mul_f32 v210, s60, v210
    v_mul_f32 v211, s60, v211
    v_mul_f32 v212, s60, v212
    v_mul_f32 v213, s60, v213
    v_mul_f32 v214, s60, v214
    v_mul_f32_e64 v215, s60, v215
    v_cvt_pk_bf16_f32 v56, v208, v209
    v_cvt_pk_bf16_f32 v57, v210, v211
    v_cvt_pk_bf16_f32 v58, v212, v213
    v_cvt_pk_bf16_f32 v59, v214, v215
    v_mov_b32 v244, -1
    v_mov_b32 v245, -1
    v_mov_b32 v246, -1
    v_mov_b32 v247, -1
    v_and_b32 v8, 27, v0
    v_cmp_eq_u32 vcc, 0, v8
    v_mov_b32 v8, 0x3f803f80
    s_nop 0
    v_cndmask_b32 v8, 0, v8, vcc
    v_mov_b32 v64, v8
    v_mov_b32 v65, v8
    v_mov_b32 v66, v8
    v_mov_b32 v67, v8
    v_mov_b32 v68, v8
    v_mov_b32 v69, v8
    v_mov_b32 v70, v8
    v_mov_b32 v71, v8
    v_mov_b32 v76, v8
    v_mov_b32 v77, v8
    v_mov_b32 v78, v8
    v_mov_b32 v79, v8
    v_mov_b32 v80, v8
    v_mov_b32 v81, v8
    v_mov_b32 v82, v8
    v_mov_b32 v83, v8
    s_waitcnt vmcnt(0)
    s_barrier
    ds_read_b128 v[60:63], v1 offset:0
    ds_read_b128 v[72:75], v1 offset:2048
    s_mov_b64 exec, s[62:63]
    s_nop 0
    ds_read_b128 v[64:67], v1 offset:1024
    ds_read_b128 v[68:71], v1 offset:768
    s_mov_b64 exec, -1
    s_waitcnt lgkmcnt(3)
    v_mfma_f32_32x32x16_bf16 v[8:23], v[60:63], v[56:59], 0
    v_mov_b32 v7, 0xdddd
    v_mov_b32 v40, 0
    v_mov_b32 v41, 0
    v_mov_b32 v42, 0
    v_mov_b32 v43, 0
    v_mov_b32 v44, 0
    v_mov_b32 v45, 0
    v_mov_b32 v46, 0
    v_mov_b32 v47, 0
    v_mov_b32 v48, 0
    v_mov_b32 v49, 0
    v_mov_b32 v50, 0
    v_mov_b32 v51, 0
    v_mov_b32 v52, 0
    v_mov_b32 v53, 0
    v_mov_b32 v54, 0
    v_mov_b32 v55, 0
    s_setprio 3
    v_exp_f32 v8, v8
    v_exp_f32 v9, v9
    v_exp_f32 v10, v10
    v_exp_f32 v11, v11
    v_exp_f32 v12, v12
    s_waitcnt lgkmcnt(0)
    v_exp_f32 v13, v13
    v_mfma_f32_32x32x16_bf16 v[24:39], v[72:75], v[56:59], 0
    v_exp_f32 v14, v14
    v_exp_f32 v15, v15
    ds_read_b128 v[60:63], v1 offset:4096
    v_exp_f32 v16, v16
    v_exp_f32 v17, v17
    v_exp_f32_e64 v18, v18
    v_smfmac_f32_32x32x32_bf16 v[40:55], v[64:67], v[8:15], v7
    v_exp_f32 v19, v19
    v_exp_f32_e64 v20, v20
    s_mov_b64 exec, s[62:63]
    ds_read_b128 v[76:79], v1 offset:3072
    ds_read_b128 v[80:83], v1 offset:2816
    s_mov_b64 exec, -1
    v_exp_f32 v21, v21
    v_exp_f32 v22, v22
    s_lshl_b32 s61, s49, 10
    s_add_u32 m0, s61, 24576
    s_add_u32 s59, s61, 0x206000
    buffer_load_dwordx4 v1, s[28:31], s59 offen sc1 lds
    s_lshl_b32 s61, s49, 10
    s_nop 0
    s_add_u32 m0, s61, 32768
    s_add_u32 s59, s61, 0x208000
    buffer_load_dwordx4 v1, s[28:31], s59 offen sc1 lds
    v_exp_f32 v23, v23
    v_exp_f32 v24, v24
    v_exp_f32_e64 v25, v25
    v_smfmac_f32_32x32x32_bf16 v[40:55], v[68:71], v[16:23], v7
    v_exp_f32 v26, v26
    v_exp_f32 v27, v27
    v_exp_f32 v28, v28
    s_waitcnt lgkmcnt(0)
    v_exp_f32_e64 v29, v29
    v_mfma_f32_32x32x16_bf16 v[8:23], v[60:63], v[56:59], 0
    v_exp_f32 v30, v30
    v_exp_f32 v31, v31
    ds_read_b128 v[72:75], v1 offset:6144
    v_exp_f32 v32, v32
    v_exp_f32 v33, v33
    v_exp_f32_e64 v34, v34
    v_smfmac_f32_32x32x32_bf16 v[40:55], v[76:79], v[24:31], v7
    v_exp_f32 v35, v35
    v_exp_f32_e64 v36, v36
    s_mov_b64 exec, s[62:63]
    ds_read_b128 v[64:67], v1 offset:5120
    ds_read_b128 v[68:71], v1 offset:4864
    s_mov_b64 exec, -1
    v_exp_f32 v37, v37
    v_exp_f32 v38, v38
    s_lshl_b32 s61, s49, 10
    s_add_u32 m0, s61, 40960
    s_add_u32 s59, s61, 0x20a000
    buffer_load_dwordx4 v1, s[28:31], s59 offen sc1 lds
    s_lshl_b32 s61, s49, 10
    s_nop 0
    s_add_u32 m0, s61, 49152
    s_add_u32 s59, s61, 0x20c000
    buffer_load_dwordx4 v1, s[28:31], s59 offen sc1 lds
    v_exp_f32 v39, v39
    v_exp_f32 v8, v8
    v_exp_f32_e64 v9, v9
    v_smfmac_f32_32x32x32_bf16 v[40:55], v[80:83], v[32:39], v7
    v_exp_f32 v10, v10
    v_exp_f32 v11, v11
    v_exp_f32 v12, v12
    s_waitcnt lgkmcnt(0)
    v_exp_f32_e64 v13, v13
    v_mfma_f32_32x32x16_bf16 v[24:39], v[72:75], v[56:59], 0
    v_exp_f32 v14, v14
    v_exp_f32 v15, v15
    ds_read_b128 v[60:63], v1 offset:8192
    v_exp_f32 v16, v16
    v_exp_f32 v17, v17
    v_exp_f32_e64 v18, v18
    v_smfmac_f32_32x32x32_bf16 v[40:55], v[64:67], v[8:15], v7
    v_exp_f32 v19, v19
    v_exp_f32_e64 v20, v20
    s_mov_b64 exec, s[62:63]
    ds_read_b128 v[76:79], v1 offset:7168
    ds_read_b128 v[80:83], v1 offset:6912
    s_mov_b64 exec, -1
    v_exp_f32 v21, v21
    v_exp_f32 v22, v22
    s_lshl_b32 s61, s49, 10
    s_add_u32 m0, s61, 57344
    s_add_u32 s59, s61, 0x20e000
    buffer_load_dwordx4 v1, s[28:31], s59 offen sc1 lds
    s_lshl_b32 s61, s49, 10
    s_nop 0
    s_add_u32 m0, s61, 65536
    s_add_u32 s59, s61, 0x210000
    buffer_load_dwordx4 v1, s[28:31], s59 offen sc1 lds
    v_exp_f32 v23, v23
    v_exp_f32 v24, v24
    v_exp_f32_e64 v25, v25
    v_smfmac_f32_32x32x32_bf16 v[40:55], v[68:71], v[16:23], v7
    v_exp_f32 v26, v26
    v_exp_f32 v27, v27
    v_exp_f32 v28, v28
    s_waitcnt lgkmcnt(0)
    v_exp_f32_e64 v29, v29
    v_mfma_f32_32x32x16_bf16 v[8:23], v[60:63], v[56:59], 0
    v_exp_f32 v30, v30
    v_exp_f32 v31, v31
    ds_read_b128 v[72:75], v1 offset:10240
    v_exp_f32 v32, v32
    v_exp_f32 v33, v33
    v_exp_f32_e64 v34, v34
    v_smfmac_f32_32x32x32_bf16 v[40:55], v[76:79], v[24:31], v7
    v_exp_f32 v35, v35
    v_exp_f32_e64 v36, v36
    s_mov_b64 exec, s[62:63]
    ds_read_b128 v[64:67], v1 offset:9216
    ds_read_b128 v[68:71], v1 offset:8960
    s_mov_b64 exec, -1
    v_exp_f32 v37, v37
    v_exp_f32 v38, v38
    s_lshl_b32 s61, s49, 10
    s_add_u32 m0, s61, 73728
    s_add_u32 s59, s61, 0x212000
    buffer_load_dwordx4 v1, s[28:31], s59 offen sc1 lds
    v_exp_f32 v39, v39
    v_exp_f32 v8, v8
    v_exp_f32_e64 v9, v9
    v_smfmac_f32_32x32x32_bf16 v[40:55], v[80:83], v[32:39], v7
    v_exp_f32 v10, v10
    v_exp_f32 v11, v11
    v_exp_f32 v12, v12
    s_waitcnt lgkmcnt(0)
    v_exp_f32_e64 v13, v13
    v_mfma_f32_32x32x16_bf16 v[24:39], v[72:75], v[56:59], 0
    v_exp_f32 v14, v14
    v_exp_f32 v15, v15
    ds_read_b128 v[60:63], v1 offset:12288
    v_exp_f32 v16, v16
    v_exp_f32 v17, v17
    v_exp_f32_e64 v18, v18
    v_smfmac_f32_32x32x32_bf16 v[40:55], v[64:67], v[8:15], v7
    v_exp_f32 v19, v19
    v_exp_f32_e64 v20, v20
    s_mov_b64 exec, s[62:63]
    ds_read_b128 v[76:79], v1 offset:11264
    ds_read_b128 v[80:83], v1 offset:11008
    s_mov_b64 exec, -1
    v_exp_f32 v21, v21
    v_exp_f32_e64 v22, v22
    s_lshl_b32 s60, s44, 11
    s_cmp_eq_u32 s49, 0
    s_cselect_b64 exec, 0xffff, 0
    buffer_load_dword v255, v243, s[8:11], s60 offen
    s_cmp_eq_u32 s49, 1
    s_nop 0
    s_cselect_b64 exec, 0xffff, 0
    buffer_load_dword v255, v243, s[12:15], s60 offen
    s_cmp_eq_u32 s49, 2
    s_nop 0
    s_cselect_b64 exec, 0xffff, 0
    buffer_load_dword v255, v243, s[16:19], s60 offen
    s_mul_i32 s60, s44, 7168
    s_and_b32 s61, s49, 1
    s_nop 0
    s_mul_i32 s61, s61, 3584
    s_add_u32 s60, s60, s61
    s_lshr_b32 s61, s49, 1
    s_cmp_eq_u32 s61, 2
    s_nop 0
    s_cselect_b64 exec, 0xfffffff, 0
    buffer_load_dword v255, v243, s[20:23], s60 offen
    s_cmp_eq_u32 s61, 3
    s_nop 0
    s_cselect_b64 exec, 0xfffffff, 0
    buffer_load_dword v255, v243, s[24:27], s60 offen
    s_mov_b64 exec, -1
    v_exp_f32 v23, v23
    v_exp_f32 v24, v24
    v_exp_f32 v25, v25
    v_smfmac_f32_32x32x32_bf16 v[40:55], v[68:71], v[16:23], v7
    v_exp_f32 v26, v26
    v_exp_f32 v27, v27
    v_exp_f32 v28, v28
    s_waitcnt lgkmcnt(0)
    v_exp_f32_e64 v29, v29
    v_mfma_f32_32x32x16_bf16 v[8:23], v[60:63], v[56:59], 0
    v_exp_f32 v30, v30
    v_exp_f32 v31, v31
    ds_read_b128 v[72:75], v1 offset:14336
    v_exp_f32 v32, v32
    v_exp_f32 v33, v33
    v_exp_f32_e64 v34, v34
    v_smfmac_f32_32x32x32_bf16 v[40:55], v[76:79], v[24:31], v7
    v_exp_f32 v35, v35
    v_exp_f32_e64 v36, v36
    s_mov_b64 exec, s[62:63]
    ds_read_b128 v[64:67], v1 offset:13312
    ds_read_b128 v[68:71], v1 offset:13056
    s_mov_b64 exec, -1
    v_exp_f32 v37, v37
    v_exp_f32 v38, v38
    v_exp_f32 v39, v39
    s_setprio 2
    v_exp_f32 v8, v8
    v_exp_f32_e64 v9, v9
    v_smfmac_f32_32x32x32_bf16 v[40:55], v[80:83], v[32:39], v7
    v_exp_f32 v10, v10
    v_exp_f32 v11, v11
    v_exp_f32 v12, v12
    s_waitcnt lgkmcnt(0)
    v_exp_f32_e64 v13, v13
    v_mfma_f32_32x32x16_bf16 v[24:39], v[72:75], v[56:59], 0
    v_exp_f32 v14, v14
    v_exp_f32 v15, v15
    ds_read_b128 v[60:63], v1 offset:16384
    v_exp_f32 v16, v16
    v_exp_f32 v17, v17
    v_exp_f32_e64 v18, v18
    v_smfmac_f32_32x32x32_bf16 v[40:55], v[64:67], v[8:15], v7
    v_exp_f32 v19, v19
    v_exp_f32_e64 v20, v20
    s_mov_b64 exec, s[62:63]
    ds_read_b128 v[76:79], v1 offset:15360
    ds_read_b128 v[80:83], v1 offset:15104
    s_mov_b64 exec, -1
    v_exp_f32 v21, v21
    v_exp_f32 v22, v22
    v_exp_f32 v23, v23
    v_exp_f32 v24, v24
    v_exp_f32 v25, v25
    v_smfmac_f32_32x32x32_bf16 v[40:55], v[68:71], v[16:23], v7
    v_exp_f32 v26, v26
    v_exp_f32 v27, v27
    v_exp_f32 v28, v28
    s_waitcnt lgkmcnt(0)
    v_exp_f32_e64 v29, v29
    v_mfma_f32_32x32x16_bf16 v[8:23], v[60:63], v[56:59], 0
    v_exp_f32 v30, v30
    v_exp_f32 v31, v31
    ds_read_b128 v[72:75], v1 offset:18432
    v_exp_f32 v32, v32
    v_exp_f32 v33, v33
    v_exp_f32_e64 v34, v34
    v_smfmac_f32_32x32x32_bf16 v[40:55], v[76:79], v[24:31], v7
    v_exp_f32 v35, v35
    v_exp_f32_e64 v36, v36
    s_mov_b64 exec, s[62:63]
    ds_read_b128 v[64:67], v1 offset:17408
    ds_read_b128 v[68:71], v1 offset:17152
    s_mov_b64 exec, -1
    v_exp_f32 v37, v37
    v_exp_f32 v38, v38
    v_exp_f32 v39, v39
    s_setprio 1
    v_exp_f32 v8, v8
    v_exp_f32_e64 v9, v9
    v_smfmac_f32_32x32x32_bf16 v[40:55], v[80:83], v[32:39], v7
    v_exp_f32 v10, v10
    v_exp_f32 v11, v11
    v_exp_f32 v12, v12
    s_waitcnt lgkmcnt(0)
    v_exp_f32_e64 v13, v13
    v_mfma_f32_32x32x16_bf16 v[24:39], v[72:75], v[56:59], 0
    v_exp_f32 v14, v14
    v_exp_f32 v15, v15
    ds_read_b128 v[60:63], v1 offset:20480
    v_exp_f32 v16, v16
    v_exp_f32 v17, v17
    v_exp_f32_e64 v18, v18
    v_smfmac_f32_32x32x32_bf16 v[40:55], v[64:67], v[8:15], v7
    v_exp_f32 v19, v19
    v_exp_f32_e64 v20, v20
    s_mov_b64 exec, s[62:63]
    ds_read_b128 v[76:79], v1 offset:19456
    ds_read_b128 v[80:83], v1 offset:19200
    s_mov_b64 exec, -1
    v_exp_f32 v21, v21
    v_exp_f32 v22, v22
    v_exp_f32 v23, v23
    s_setprio 0
    v_exp_f32 v24, v24
    v_exp_f32_e64 v25, v25
    v_smfmac_f32_32x32x32_bf16 v[40:55], v[68:71], v[16:23], v7
    v_exp_f32 v26, v26
    v_exp_f32 v27, v27
    v_exp_f32 v28, v28
    s_waitcnt lgkmcnt(0)
    v_exp_f32_e64 v29, v29
    v_mfma_f32_32x32x16_bf16 v[8:23], v[60:63], v[56:59], 0
    v_exp_f32 v30, v30
    v_exp_f32 v31, v31
    ds_read_b128 v[72:75], v1 offset:22528
    v_exp_f32 v32, v32
    v_exp_f32 v33, v33
    v_exp_f32_e64 v34, v34
    v_smfmac_f32_32x32x32_bf16 v[40:55], v[76:79], v[24:31], v7
    v_exp_f32 v35, v35
    v_exp_f32_e64 v36, v36
    s_mov_b64 exec, s[62:63]
    ds_read_b128 v[64:67], v1 offset:21504
    ds_read_b128 v[68:71], v1 offset:21248
    s_mov_b64 exec, -1
    v_exp_f32 v37, v37
    v_exp_f32 v38, v38
    v_exp_f32 v39, v39
    s_waitcnt vmcnt(5)
    s_barrier
    s_setprio 3
    v_exp_f32 v8, v8
    v_exp_f32_e64 v9, v9
    v_smfmac_f32_32x32x32_bf16 v[40:55], v[80:83], v[32:39], v7
    v_exp_f32 v10, v10
    v_exp_f32 v11, v11
    v_exp_f32 v12, v12
    s_waitcnt lgkmcnt(0)
    v_exp_f32_e64 v13, v13
    v_mfma_f32_32x32x16_bf16 v[24:39], v[72:75], v[56:59], 0
    v_exp_f32 v14, v14
    v_exp_f32 v15, v15
    ds_read_b128 v[60:63], v1 offset:24576
    v_exp_f32 v16, v16
    v_exp_f32 v17, v17
    v_exp_f32_e64 v18, v18
    v_smfmac_f32_32x32x32_bf16 v[40:55], v[64:67], v[8:15], v7
    v_exp_f32 v19, v19
    v_exp_f32_e64 v20, v20
    s_mov_b64 exec, s[62:63]
    ds_read_b128 v[76:79], v1 offset:23552
    ds_read_b128 v[80:83], v1 offset:23296
    s_mov_b64 exec, -1
    v_exp_f32 v21, v21
    v_exp_f32 v22, v22
    v_exp_f32 v23, v23
    v_exp_f32 v24, v24
    v_exp_f32 v25, v25
    v_smfmac_f32_32x32x32_bf16 v[40:55], v[68:71], v[16:23], v7
    v_exp_f32 v26, v26
    v_exp_f32 v27, v27
    v_exp_f32 v28, v28
    s_waitcnt lgkmcnt(0)
    v_exp_f32_e64 v29, v29
    v_mfma_f32_32x32x16_bf16 v[8:23], v[60:63], v[56:59], 0
    v_exp_f32 v30, v30
    v_exp_f32 v31, v31
    ds_read_b128 v[72:75], v1 offset:26624
    v_exp_f32 v32, v32
    v_exp_f32 v33, v33
    v_exp_f32_e64 v34, v34
    v_smfmac_f32_32x32x32_bf16 v[40:55], v[76:79], v[24:31], v7
    v_exp_f32 v35, v35
    v_exp_f32_e64 v36, v36
    s_mov_b64 exec, s[62:63]
    ds_read_b128 v[64:67], v1 offset:25600
    ds_read_b128 v[68:71], v1 offset:25344
    s_mov_b64 exec, -1
    v_exp_f32 v37, v37
    v_exp_f32 v38, v38
    s_add_u32 s59, s68, 0x0
    buffer_store_dwordx4 v[244:247], v1, s[28:31], s59 offen sc1
    v_exp_f32 v39, v39
    v_exp_f32 v8, v8
    v_exp_f32_e64 v9, v9
    v_smfmac_f32_32x32x32_bf16 v[40:55], v[80:83], v[32:39], v7
    v_exp_f32_e64 v10, v10
    s_add_u32 m0, s53, 131072
    s_add_u32 s59, s54, 0
    s_nop 0
    buffer_load_dwordx4 v3, s[8:11], s59 offen lds
    v_exp_f32 v11, v11
    v_exp_f32 v12, v12
    s_waitcnt lgkmcnt(0)
    v_exp_f32 v13, v13
    v_mfma_f32_32x32x16_bf16 v[24:39], v[72:75], v[56:59], 0
    v_exp_f32_e64 v14, v14
    s_add_u32 m0, s53, 132096
    s_add_u32 s59, s54, 16384
    buffer_load_dwordx4 v3, s[8:11], s59 offen lds
    v_exp_f32_e64 v15, v15
    ds_read_b128 v[60:63], v1 offset:28672
    v_exp_f32 v16, v16
    v_exp_f32 v17, v17
    v_exp_f32_e64 v18, v18
    v_smfmac_f32_32x32x32_bf16 v[40:55], v[64:67], v[8:15], v7
    s_add_u32 m0, s53, 133120
    s_add_u32 s59, s54, 32768
    buffer_load_dwordx4 v3, s[8:11], s59 offen lds
    v_exp_f32 v19, v19
    v_exp_f32_e64 v20, v20
    s_mov_b64 exec, s[62:63]
    ds_read_b128 v[76:79], v1 offset:27648
    ds_read_b128 v[80:83], v1 offset:27392
    s_mov_b64 exec, -1
    v_exp_f32 v21, v21
    v_exp_f32_e64 v22, v22
    s_add_u32 m0, s53, 134144
    s_add_u32 s59, s54, 49152
    buffer_load_dwordx4 v3, s[8:11], s59 offen lds
    v_exp_f32 v23, v23
    v_exp_f32 v24, v24
    v_exp_f32_e64 v25, v25
    v_smfmac_f32_32x32x32_bf16 v[40:55], v[68:71], v[16:23], v7
    v_exp_f32 v26, v26
    v_exp_f32 v27, v27
    v_exp_f32 v28, v28
    s_waitcnt lgkmcnt(0)
    v_exp_f32_e64 v29, v29
    v_mfma_f32_32x32x16_bf16 v[8:23], v[60:63], v[56:59], 0
    v_exp_f32 v30, v30
    v_exp_f32 v31, v31
    ds_read_b128 v[72:75], v1 offset:30720
    v_exp_f32 v32, v32
    v_exp_f32 v33, v33
    v_exp_f32_e64 v34, v34
    v_smfmac_f32_32x32x32_bf16 v[40:55], v[76:79], v[24:31], v7
    v_exp_f32 v35, v35
    v_exp_f32_e64 v36, v36
    s_mov_b64 exec, s[62:63]
    ds_read_b128 v[64:67], v1 offset:29696
    ds_read_b128 v[68:71], v1 offset:29440
    s_mov_b64 exec, -1
    v_exp_f32 v37, v37
    v_exp_f32 v38, v38
    s_lshl_b32 s61, s49, 10
    s_add_u32 m0, s61, 81920
    s_add_u32 s59, s61, 0x214000
    buffer_load_dwordx4 v1, s[28:31], s59 offen sc1 lds
    v_exp_f32 v39, v39
    v_exp_f32 v8, v8
    v_exp_f32_e64 v9, v9
    v_smfmac_f32_32x32x32_bf16 v[40:55], v[80:83], v[32:39], v7
    v_exp_f32 v10, v10
    v_exp_f32 v11, v11
    v_exp_f32 v12, v12
    s_waitcnt lgkmcnt(0)
    v_exp_f32_e64 v13, v13
    v_mfma_f32_32x32x16_bf16 v[24:39], v[72:75], v[56:59], 0
    v_exp_f32 v14, v14
    v_exp_f32 v15, v15
    ds_read_b128 v[60:63], v1 offset:32768
    v_exp_f32 v16, v16
    v_exp_f32 v17, v17
    v_exp_f32_e64 v18, v18
    v_smfmac_f32_32x32x32_bf16 v[40:55], v[64:67], v[8:15], v7
    v_exp_f32 v19, v19
    v_exp_f32_e64 v20, v20
    s_mov_b64 exec, s[62:63]
    ds_read_b128 v[76:79], v1 offset:31744
    ds_read_b128 v[80:83], v1 offset:31488
    s_mov_b64 exec, -1
    v_exp_f32 v21, v21
    v_exp_f32_e64 v22, v22
    s_add_u32 s59, s57, 0x600000
    buffer_store_dwordx4 v[244:247], v1, s[28:31], s59 offen sc1
    v_exp_f32 v23, v23
    v_exp_f32 v24, v24
    v_exp_f32_e64 v25, v25
    v_smfmac_f32_32x32x32_bf16 v[40:55], v[68:71], v[16:23], v7
    v_exp_f32 v26, v26
    v_exp_f32 v27, v27
    v_exp_f32 v28, v28
    s_waitcnt lgkmcnt(0)
    v_exp_f32_e64 v29, v29
    v_mfma_f32_32x32x16_bf16 v[8:23], v[60:63], v[56:59], 0
    v_exp_f32 v30, v30
    v_exp_f32 v31, v31
    ds_read_b128 v[72:75], v1 offset:34816
    v_exp_f32 v32, v32
    v_exp_f32 v33, v33
    v_exp_f32_e64 v34, v34
    v_smfmac_f32_32x32x32_bf16 v[40:55], v[76:79], v[24:31], v7
    v_exp_f32 v35, v35
    v_exp_f32_e64 v36, v36
    s_mov_b64 exec, s[62:63]
    ds_read_b128 v[64:67], v1 offset:33792
    ds_read_b128 v[68:71], v1 offset:33536
    s_mov_b64 exec, -1
    v_exp_f32 v37, v37
    v_exp_f32_e64 v38, v38
    s_add_u32 s59, s57, 0x800000
    buffer_store_dwordx4 v[244:247], v1, s[28:31], s59 offen sc1
    v_exp_f32 v39, v39
    v_exp_f32 v8, v8
    v_exp_f32_e64 v9, v9
    v_smfmac_f32_32x32x32_bf16 v[40:55], v[80:83], v[32:39], v7
    v_exp_f32 v10, v10
    v_exp_f32 v11, v11
    v_exp_f32 v12, v12
    s_waitcnt lgkmcnt(0)
    v_exp_f32_e64 v13, v13
    v_mfma_f32_32x32x16_bf16 v[24:39], v[72:75], v[56:59], 0
    v_exp_f32 v14, v14
    v_exp_f32 v15, v15
    ds_read_b128 v[60:63], v1 offset:36864
    v_exp_f32 v16, v16
    v_exp_f32 v17, v17
    v_exp_f32_e64 v18, v18
    v_smfmac_f32_32x32x32_bf16 v[40:55], v[64:67], v[8:15], v7
    v_exp_f32 v19, v19
    v_exp_f32_e64 v20, v20
    s_mov_b64 exec, s[62:63]
    ds_read_b128 v[76:79], v1 offset:35840
    ds_read_b128 v[80:83], v1 offset:35584
    s_mov_b64 exec, -1
    v_exp_f32 v21, v21
    v_exp_f32 v22, v22
    s_lshl_b32 s61, s49, 10
    s_add_u32 m0, s61, 90112
    s_add_u32 s59, s61, 0x216000
    buffer_load_dwordx4 v1, s[28:31], s59 offen sc1 lds
    v_exp_f32 v23, v23
    v_exp_f32 v24, v24
    v_exp_f32_e64 v25, v25
    v_smfmac_f32_32x32x32_bf16 v[40:55], v[68:71], v[16:23], v7
    v_exp_f32 v26, v26
    v_exp_f32 v27, v27
    v_exp_f32 v28, v28
    s_waitcnt lgkmcnt(0)
    v_exp_f32_e64 v29, v29
    v_mfma_f32_32x32x16_bf16 v[8:23], v[60:63], v[56:59], 0
    v_exp_f32 v30, v30
    s_waitcnt vmcnt(4)
    ds_read_b64_tr_b16 v[84:85], v5 offset:0
    ds_read_b64_tr_b16 v[86:87], v5 offset:256
    ds_read_b64_tr_b16 v[88:89], v5 offset:1024
    ds_read_b64_tr_b16 v[90:91], v5 offset:1280
    v_exp_f32_e64 v31, v31
    ds_read_b128 v[72:75], v1 offset:38912
    v_exp_f32 v32, v32
    v_exp_f32 v33, v33
    v_exp_f32_e64 v34, v34
    v_smfmac_f32_32x32x32_bf16 v[40:55], v[76:79], v[24:31], v7
    v_exp_f32 v35, v35
    v_exp_f32_e64 v36, v36
    s_mov_b64 exec, s[62:63]
    ds_read_b128 v[64:67], v1 offset:37888
    ds_read_b128 v[68:71], v1 offset:37632
    s_mov_b64 exec, -1
    v_exp_f32 v37, v37
    v_exp_f32_e64 v38, v38
    ds_read_b64_tr_b16 v[92:93], v5 offset:2048
    ds_read_b64_tr_b16 v[94:95], v5 offset:2304
    ds_read_b64_tr_b16 v[96:97], v5 offset:3072
    ds_read_b64_tr_b16 v[98:99], v5 offset:3328
    v_exp_f32 v39, v39
    v_exp_f32 v8, v8
    v_exp_f32_e64 v9, v9
    v_smfmac_f32_32x32x32_bf16 v[40:55], v[80:83], v[32:39], v7
    v_exp_f32 v10, v10
    s_waitcnt lgkmcnt(0)
    s_add_u32 m0, s53, 131072
    s_add_u32 s59, s54, 65536
    buffer_load_dwordx4 v3, s[8:11], s59 offen lds
    v_exp_f32 v11, v11
    v_exp_f32 v12, v12
    v_exp_f32_e64 v13, v13
    v_mfma_f32_32x32x16_bf16 v[24:39], v[72:75], v[56:59], 0
    v_exp_f32_e64 v14, v14
    s_add_u32 m0, s53, 132096
    s_add_u32 s59, s54, 81920
    buffer_load_dwordx4 v3, s[8:11], s59 offen lds
    v_exp_f32_e64 v15, v15
    ds_read_b128 v[60:63], v1 offset:40960
    v_exp_f32 v16, v16
    v_exp_f32 v17, v17
    v_exp_f32_e64 v18, v18
    v_smfmac_f32_32x32x32_bf16 v[40:55], v[64:67], v[8:15], v7
    s_add_u32 m0, s53, 133120
    s_add_u32 s59, s54, 98304
    buffer_load_dwordx4 v3, s[8:11], s59 offen lds
    v_exp_f32 v19, v19
    v_exp_f32_e64 v20, v20
    s_mov_b64 exec, s[62:63]
    ds_read_b128 v[76:79], v1 offset:39936
    ds_read_b128 v[80:83], v1 offset:39680
    s_mov_b64 exec, -1
    v_exp_f32 v21, v21
    v_exp_f32_e64 v22, v22
    s_add_u32 m0, s53, 134144
    s_add_u32 s59, s54, 114688
    buffer_load_dwordx4 v3, s[8:11], s59 offen lds
    v_exp_f32 v23, v23
    v_exp_f32 v24, v24
    v_exp_f32_e64 v25, v25
    v_smfmac_f32_32x32x32_bf16 v[40:55], v[68:71], v[16:23], v7
    v_exp_f32 v26, v26
    v_exp_f32 v27, v27
    v_exp_f32 v28, v28
    s_waitcnt lgkmcnt(0)
    v_exp_f32_e64 v29, v29
    v_mfma_f32_32x32x16_bf16 v[8:23], v[60:63], v[56:59], 0
    v_exp_f32 v30, v30
    v_exp_f32 v31, v31
    ds_read_b128 v[72:75], v1 offset:43008
    v_exp_f32 v32, v32
    v_exp_f32 v33, v33
    v_exp_f32_e64 v34, v34
    v_smfmac_f32_32x32x32_bf16 v[40:55], v[76:79], v[24:31], v7
    v_exp_f32 v35, v35
    v_exp_f32_e64 v36, v36
    s_mov_b64 exec, s[62:63]
    ds_read_b128 v[64:67], v1 offset:41984
    ds_read_b128 v[68:71], v1 offset:41728
    s_mov_b64 exec, -1
    v_exp_f32 v37, v37
    v_exp_f32_e64 v38, v38
    s_add_u32 s59, s57, 0xa00000
    buffer_store_dwordx4 v[244:247], v1, s[28:31], s59 offen sc1
    v_exp_f32 v39, v39
    v_exp_f32 v8, v8
    v_exp_f32_e64 v9, v9
    v_smfmac_f32_32x32x32_bf16 v[40:55], v[80:83], v[32:39], v7
    v_exp_f32 v10, v10
    v_exp_f32 v11, v11
    v_exp_f32 v12, v12
    s_waitcnt lgkmcnt(0)
    v_exp_f32_e64 v13, v13
    v_mfma_f32_32x32x16_bf16 v[24:39], v[72:75], v[56:59], 0
    v_exp_f32 v14, v14
    v_exp_f32 v15, v15
    ds_read_b128 v[60:63], v1 offset:45056
    v_exp_f32 v16, v16
    v_exp_f32 v17, v17
    v_exp_f32_e64 v18, v18
    v_smfmac_f32_32x32x32_bf16 v[40:55], v[64:67], v[8:15], v7
    v_exp_f32 v19, v19
    v_exp_f32_e64 v20, v20
    s_mov_b64 exec, s[62:63]
    ds_read_b128 v[76:79], v1 offset:44032
    ds_read_b128 v[80:83], v1 offset:43776
    s_mov_b64 exec, -1
    v_exp_f32 v21, v21
    v_exp_f32_e64 v22, v22
    s_add_u32 s59, s57, 0x1000000
    buffer_store_dwordx4 v[244:247], v1, s[28:31], s59 offen sc1
    v_exp_f32 v23, v23
    v_exp_f32 v24, v24
    v_exp_f32_e64 v25, v25
    v_smfmac_f32_32x32x32_bf16 v[40:55], v[68:71], v[16:23], v7
    v_exp_f32 v26, v26
    v_exp_f32 v27, v27
    v_exp_f32 v28, v28
    s_waitcnt lgkmcnt(0)
    v_exp_f32_e64 v29, v29
    v_mfma_f32_32x32x16_bf16 v[8:23], v[60:63], v[56:59], 0
    v_exp_f32 v30, v30
    v_exp_f32 v31, v31
    ds_read_b128 v[72:75], v1 offset:47104
    v_exp_f32 v32, v32
    v_exp_f32 v33, v33
    v_exp_f32_e64 v34, v34
    v_smfmac_f32_32x32x32_bf16 v[40:55], v[76:79], v[24:31], v7
    v_exp_f32 v35, v35
    v_exp_f32_e64 v36, v36
    s_mov_b64 exec, s[62:63]
    ds_read_b128 v[64:67], v1 offset:46080
    ds_read_b128 v[68:71], v1 offset:45824
    s_mov_b64 exec, -1
    v_exp_f32 v37, v37
    v_exp_f32 v38, v38
    s_lshl_b32 s61, s49, 10
    s_add_u32 m0, s61, 98304
    s_add_u32 s59, s61, 0x218000
    buffer_load_dwordx4 v1, s[28:31], s59 offen sc1 lds
    v_exp_f32 v39, v39
    v_exp_f32 v8, v8
    v_exp_f32_e64 v9, v9
    v_smfmac_f32_32x32x32_bf16 v[40:55], v[80:83], v[32:39], v7
    v_exp_f32 v10, v10
    v_exp_f32 v11, v11
    v_exp_f32 v12, v12
    s_waitcnt lgkmcnt(0)
    v_exp_f32_e64 v13, v13
    v_mfma_f32_32x32x16_bf16 v[24:39], v[72:75], v[56:59], 0
    v_exp_f32 v14, v14
    v_exp_f32 v15, v15
    ds_read_b128 v[60:63], v1 offset:49152
    v_exp_f32 v16, v16
    v_exp_f32 v17, v17
    v_exp_f32_e64 v18, v18
    v_smfmac_f32_32x32x32_bf16 v[40:55], v[64:67], v[8:15], v7
    v_exp_f32 v19, v19
    v_exp_f32_e64 v20, v20
    s_mov_b64 exec, s[62:63]
    ds_read_b128 v[76:79], v1 offset:48128
    ds_read_b128 v[80:83], v1 offset:47872
    s_mov_b64 exec, -1
    v_exp_f32 v21, v21
    v_exp_f32_e64 v22, v22
    s_lshl_b32 s42, s44, 10
    s_and_b32 s60, s49, 1
    s_lshl_b32 s60, s60, 18
    s_add_u32 s60, s60, s42
    s_add_u32 s59, s60, 0xd00000
    buffer_store_dwordx4 v[244:247], v1, s[28:31], s59 offen sc1
    v_exp_f32 v23, v23
    v_exp_f32 v24, v24
    v_exp_f32_e64 v25, v25
    v_smfmac_f32_32x32x32_bf16 v[40:55], v[68:71], v[16:23], v7
    v_exp_f32 v26, v26
    v_exp_f32 v27, v27
    v_exp_f32 v28, v28
    s_waitcnt lgkmcnt(0)
    v_exp_f32_e64 v29, v29
    v_mfma_f32_32x32x16_bf16 v[8:23], v[60:63], v[56:59], 0
    v_exp_f32 v30, v30
    s_waitcnt vmcnt(4)
    ds_read_b64_tr_b16 v[100:101], v5 offset:0
    ds_read_b64_tr_b16 v[102:103], v5 offset:256
    ds_read_b64_tr_b16 v[104:105], v5 offset:1024
    ds_read_b64_tr_b16 v[106:107], v5 offset:1280
    v_exp_f32_e64 v31, v31
    ds_read_b128 v[72:75], v1 offset:51200
    v_exp_f32 v32, v32
    v_exp_f32 v33, v33
    v_exp_f32_e64 v34, v34
    v_smfmac_f32_32x32x32_bf16 v[40:55], v[76:79], v[24:31], v7
    v_exp_f32 v35, v35
    v_exp_f32_e64 v36, v36
    s_mov_b64 exec, s[62:63]
    ds_read_b128 v[64:67], v1 offset:50176
    ds_read_b128 v[68:71], v1 offset:49920
    s_mov_b64 exec, -1
    v_exp_f32 v37, v37
    v_exp_f32_e64 v38, v38
    ds_read_b64_tr_b16 v[108:109], v5 offset:2048
    ds_read_b64_tr_b16 v[110:111], v5 offset:2304
    ds_read_b64_tr_b16 v[112:113], v5 offset:3072
    ds_read_b64_tr_b16 v[114:115], v5 offset:3328
    v_exp_f32 v39, v39
    v_exp_f32 v8, v8
    v_exp_f32_e64 v9, v9
    v_smfmac_f32_32x32x32_bf16 v[40:55], v[80:83], v[32:39], v7
    v_exp_f32 v10, v10
    s_waitcnt lgkmcnt(0)
    s_add_u32 m0, s53, 131072
    s_add_u32 s59, s54, 131072
    buffer_load_dwordx4 v3, s[8:11], s59 offen lds
    v_exp_f32 v11, v11
    v_exp_f32 v12, v12
    v_exp_f32_e64 v13, v13
    v_mfma_f32_32x32x16_bf16 v[24:39], v[72:75], v[56:59], 0
    v_exp_f32_e64 v14, v14
    s_add_u32 m0, s53, 132096
    s_add_u32 s59, s54, 147456
    buffer_load_dwordx4 v3, s[8:11], s59 offen lds
    v_exp_f32_e64 v15, v15
    ds_read_b128 v[60:63], v1 offset:53248
    v_exp_f32 v16, v16
    v_exp_f32 v17, v17
    v_exp_f32_e64 v18, v18
    v_smfmac_f32_32x32x32_bf16 v[40:55], v[64:67], v[8:15], v7
    s_add_u32 m0, s53, 133120
    s_add_u32 s59, s54, 163840
    buffer_load_dwordx4 v3, s[8:11], s59 offen lds
    v_exp_f32 v19, v19
    v_exp_f32_e64 v20, v20
    s_mov_b64 exec, s[62:63]
    ds_read_b128 v[76:79], v1 offset:52224
    ds_read_b128 v[80:83], v1 offset:51968
    s_mov_b64 exec, -1
    v_exp_f32 v21, v21
    v_exp_f32_e64 v22, v22
    s_add_u32 m0, s53, 134144
    s_add_u32 s59, s54, 180224
    buffer_load_dwordx4 v3, s[8:11], s59 offen lds
    v_exp_f32 v23, v23
    v_exp_f32 v24, v24
    v_exp_f32_e64 v25, v25
    v_smfmac_f32_32x32x32_bf16 v[40:55], v[68:71], v[16:23], v7
    v_exp_f32 v26, v26
    v_exp_f32 v27, v27
    v_exp_f32 v28, v28
    s_waitcnt lgkmcnt(0)
    v_exp_f32_e64 v29, v29
    v_mfma_f32_32x32x16_bf16 v[8:23], v[60:63], v[56:59], 0
    v_exp_f32 v30, v30
    v_exp_f32 v31, v31
    ds_read_b128 v[72:75], v1 offset:55296
    v_exp_f32 v32, v32
    v_exp_f32 v33, v33
    v_exp_f32_e64 v34, v34
    v_smfmac_f32_32x32x32_bf16 v[40:55], v[76:79], v[24:31], v7
    v_exp_f32 v35, v35
    v_exp_f32_e64 v36, v36
    s_mov_b64 exec, s[62:63]
    ds_read_b128 v[64:67], v1 offset:54272
    ds_read_b128 v[68:71], v1 offset:54016
    s_mov_b64 exec, -1
    v_exp_f32 v37, v37
    v_exp_f32_e64 v38, v38
    s_mul_i32 s60, s44, 28672
    s_mul_i32 s61, s49, 3584
    s_add_u32 s60, s60, s61
    s_nop 0
    s_add_u32 s59, s60, 0x1200000
    buffer_store_dwordx4 v[244:247], v1, s[28:31], s59 offen sc1
    v_exp_f32 v39, v39
    v_exp_f32 v8, v8
    v_exp_f32_e64 v9, v9
    v_smfmac_f32_32x32x32_bf16 v[40:55], v[80:83], v[32:39], v7
    v_exp_f32 v10, v10
    v_exp_f32 v11, v11
    v_exp_f32 v12, v12
    s_waitcnt lgkmcnt(0)
    v_exp_f32_e64 v13, v13
    v_mfma_f32_32x32x16_bf16 v[24:39], v[72:75], v[56:59], 0
    v_exp_f32 v14, v14
    v_exp_f32 v15, v15
    ds_read_b128 v[60:63], v1 offset:57344
    v_exp_f32 v16, v16
    v_exp_f32 v17, v17
    v_exp_f32_e64 v18, v18
    v_smfmac_f32_32x32x32_bf16 v[40:55], v[64:67], v[8:15], v7
    v_exp_f32 v19, v19
    v_exp_f32_e64 v20, v20
    s_mov_b64 exec, s[62:63]
    ds_read_b128 v[76:79], v1 offset:56320
    ds_read_b128 v[80:83], v1 offset:56064
    s_mov_b64 exec, -1
    v_exp_f32 v21, v21
    v_exp_f32 v22, v22
    s_lshl_b32 s61, s49, 10
    s_add_u32 m0, s61, 106496
    s_add_u32 s59, s61, 0x21a000
    buffer_load_dwordx4 v1, s[28:31], s59 offen sc1 lds
    v_exp_f32 v23, v23
    v_exp_f32 v24, v24
    v_exp_f32_e64 v25, v25
    v_smfmac_f32_32x32x32_bf16 v[40:55], v[68:71], v[16:23], v7
    v_exp_f32 v26, v26
    v_exp_f32 v27, v27
    v_exp_f32 v28, v28
    s_waitcnt lgkmcnt(0)
    v_exp_f32_e64 v29, v29
    v_mfma_f32_32x32x16_bf16 v[8:23], v[60:63], v[56:59], 0
    v_exp_f32 v30, v30
    v_exp_f32 v31, v31
    ds_read_b128 v[72:75], v1 offset:59392
    v_exp_f32 v32, v32
    v_exp_f32 v33, v33
    v_exp_f32_e64 v34, v34
    v_smfmac_f32_32x32x32_bf16 v[40:55], v[76:79], v[24:31], v7
    v_exp_f32 v35, v35
    v_exp_f32_e64 v36, v36
    s_mov_b64 exec, s[62:63]
    ds_read_b128 v[64:67], v1 offset:58368
    ds_read_b128 v[68:71], v1 offset:58112
    s_mov_b64 exec, -1
    v_exp_f32 v37, v37
    v_exp_f32_e64 v38, v38
    s_mul_i32 s60, s44, 28672
    s_mul_i32 s61, s49, 3584
    s_add_u32 s60, s60, s61
    s_nop 0
    s_add_u32 s59, s60, 0x1200400
    buffer_store_dwordx4 v[244:247], v1, s[28:31], s59 offen sc1
    v_exp_f32 v39, v39
    s_setprio 2
    v_exp_f32 v8, v8
    v_exp_f32 v9, v9
    v_smfmac_f32_32x32x32_bf16 v[40:55], v[80:83], v[32:39], v7
    v_exp_f32 v10, v10
    v_exp_f32 v11, v11
    v_exp_f32 v12, v12
    s_waitcnt lgkmcnt(0)
    v_exp_f32_e64 v13, v13
    v_mfma_f32_32x32x16_bf16 v[24:39], v[72:75], v[56:59], 0
    v_exp_f32 v14, v14
    v_exp_f32 v15, v15
    ds_read_b128 v[60:63], v1 offset:61440
    v_exp_f32 v16, v16
    v_exp_f32 v17, v17
    v_exp_f32_e64 v18, v18
    v_smfmac_f32_32x32x32_bf16 v[40:55], v[64:67], v[8:15], v7
    v_exp_f32 v19, v19
    v_exp_f32_e64 v20, v20
    s_mov_b64 exec, s[62:63]
    ds_read_b128 v[76:79], v1 offset:60416
    ds_read_b128 v[80:83], v1 offset:60160
    s_mov_b64 exec, -1
    v_exp_f32 v21, v21
    v_exp_f32_e64 v22, v22
    s_mul_i32 s60, s44, 28672
    s_mul_i32 s61, s49, 3584
    s_add_u32 s60, s60, s61
    s_nop 0
    s_add_u32 s59, s60, 0x1200800
    buffer_store_dwordx4 v[244:247], v1, s[28:31], s59 offen sc1
    v_exp_f32 v23, v23
    v_exp_f32 v24, v24
    v_exp_f32_e64 v25, v25
    v_smfmac_f32_32x32x32_bf16 v[40:55], v[68:71], v[16:23], v7
    v_exp_f32 v26, v26
    v_exp_f32 v27, v27
    v_exp_f32 v28, v28
    s_waitcnt lgkmcnt(0)
    v_exp_f32_e64 v29, v29
    v_mfma_f32_32x32x16_bf16 v[8:23], v[60:63], v[56:59], 0
    v_exp_f32 v30, v30
    s_waitcnt vmcnt(4)
    ds_read_b64_tr_b16 v[116:117], v5 offset:0
    ds_read_b64_tr_b16 v[118:119], v5 offset:256
    ds_read_b64_tr_b16 v[120:121], v5 offset:1024
    ds_read_b64_tr_b16 v[122:123], v5 offset:1280
    v_exp_f32_e64 v31, v31
    ds_read_b128 v[72:75], v1 offset:63488
    v_exp_f32 v32, v32
    v_exp_f32 v33, v33
    v_exp_f32_e64 v34, v34
    v_smfmac_f32_32x32x32_bf16 v[40:55], v[76:79], v[24:31], v7
    v_exp_f32 v35, v35
    v_exp_f32_e64 v36, v36
    s_mov_b64 exec, s[62:63]
    ds_read_b128 v[64:67], v1 offset:62464
    ds_read_b128 v[68:71], v1 offset:62208
    s_mov_b64 exec, -1
    v_exp_f32 v37, v37
    v_exp_f32_e64 v38, v38
    ds_read_b64_tr_b16 v[124:125], v5 offset:2048
    ds_read_b64_tr_b16 v[126:127], v5 offset:2304
    ds_read_b64_tr_b16 v[128:129], v5 offset:3072
    ds_read_b64_tr_b16 v[130:131], v5 offset:3328
    v_exp_f32 v39, v39
    v_exp_f32 v8, v8
    v_exp_f32_e64 v9, v9
    v_smfmac_f32_32x32x32_bf16 v[40:55], v[80:83], v[32:39], v7
    v_exp_f32 v10, v10
    s_waitcnt lgkmcnt(0)
    s_add_u32 m0, s53, 131072
    s_add_u32 s59, s54, 196608
    buffer_load_dwordx4 v3, s[8:11], s59 offen lds
    v_exp_f32 v11, v11
    v_exp_f32 v12, v12
    v_exp_f32_e64 v13, v13
    v_mfma_f32_32x32x16_bf16 v[24:39], v[72:75], v[56:59], 0
    v_exp_f32_e64 v14, v14
    s_add_u32 m0, s53, 132096
    s_add_u32 s59, s54, 212992
    buffer_load_dwordx4 v3, s[8:11], s59 offen lds
    v_exp_f32_e64 v15, v15
    ds_read_b128 v[60:63], v2 offset:0
    v_exp_f32 v16, v16
    v_exp_f32 v17, v17
    v_exp_f32_e64 v18, v18
    v_smfmac_f32_32x32x32_bf16 v[40:55], v[64:67], v[8:15], v7
    s_add_u32 m0, s53, 133120
    s_add_u32 s59, s54, 229376
    buffer_load_dwordx4 v3, s[8:11], s59 offen lds
    v_exp_f32 v19, v19
    v_exp_f32_e64 v20, v20
    s_mov_b64 exec, s[62:63]
    ds_read_b128 v[76:79], v1 offset:64512
    ds_read_b128 v[80:83], v1 offset:64256
    s_mov_b64 exec, -1
    v_exp_f32 v21, v21
    v_exp_f32_e64 v22, v22
    s_add_u32 m0, s53, 134144
    s_add_u32 s59, s54, 245760
    buffer_load_dwordx4 v3, s[8:11], s59 offen lds
    v_exp_f32 v23, v23
    v_exp_f32 v24, v24
    v_exp_f32_e64 v25, v25
    v_smfmac_f32_32x32x32_bf16 v[40:55], v[68:71], v[16:23], v7
    v_exp_f32 v26, v26
    v_exp_f32 v27, v27
    v_exp_f32 v28, v28
    s_waitcnt lgkmcnt(0)
    v_exp_f32_e64 v29, v29
    v_mfma_f32_32x32x16_bf16 v[8:23], v[60:63], v[56:59], 0
    v_exp_f32 v30, v30
    v_exp_f32 v31, v31
    ds_read_b128 v[72:75], v2 offset:2048
    v_exp_f32 v32, v32
    v_exp_f32 v33, v33
    v_exp_f32_e64 v34, v34
    v_smfmac_f32_32x32x32_bf16 v[40:55], v[76:79], v[24:31], v7
    v_exp_f32 v35, v35
    v_exp_f32_e64 v36, v36
    s_mov_b64 exec, s[62:63]
    ds_read_b128 v[64:67], v2 offset:1024
    ds_read_b128 v[68:71], v2 offset:768
    s_mov_b64 exec, -1
    v_exp_f32 v37, v37
    v_exp_f32 v38, v38
    s_lshl_b32 s61, s49, 10
    s_add_u32 m0, s61, 114688
    s_add_u32 s59, s61, 0x21c000
    buffer_load_dwordx4 v1, s[28:31], s59 offen sc1 lds
    v_exp_f32 v39, v39
    v_exp_f32 v8, v8
    v_exp_f32_e64 v9, v9
    v_smfmac_f32_32x32x32_bf16 v[40:55], v[80:83], v[32:39], v7
    v_exp_f32 v10, v10
    v_exp_f32 v11, v11
    v_exp_f32 v12, v12
    s_waitcnt lgkmcnt(0)
    v_exp_f32_e64 v13, v13
    v_mfma_f32_32x32x16_bf16 v[24:39], v[72:75], v[56:59], 0
    v_exp_f32 v14, v14
    v_exp_f32 v15, v15
    ds_read_b128 v[60:63], v2 offset:4096
    v_exp_f32 v16, v16
    v_exp_f32 v17, v17
    v_exp_f32_e64 v18, v18
    v_smfmac_f32_32x32x32_bf16 v[40:55], v[64:67], v[8:15], v7
    v_exp_f32 v19, v19
    v_exp_f32_e64 v20, v20
    s_mov_b64 exec, s[62:63]
    ds_read_b128 v[76:79], v2 offset:3072
    ds_read_b128 v[80:83], v2 offset:2816
    s_mov_b64 exec, -1
    v_exp_f32 v21, v21
    v_exp_f32_e64 v22, v22
    s_mul_i32 s60, s44, 28672
    s_mul_i32 s61, s49, 3584
    s_add_u32 s60, s60, s61
    s_nop 0
    s_add_u32 s59, s60, 0x1200a00
    buffer_store_dwordx4 v[244:247], v1, s[28:31], s59 offen sc1
    v_exp_f32 v23, v23
    v_exp_f32 v24, v24
    v_exp_f32_e64 v25, v25
    v_smfmac_f32_32x32x32_bf16 v[40:55], v[68:71], v[16:23], v7
    v_exp_f32 v26, v26
    v_exp_f32 v27, v27
    v_exp_f32 v28, v28
    s_waitcnt lgkmcnt(0)
    v_exp_f32_e64 v29, v29
    v_mfma_f32_32x32x16_bf16 v[8:23], v[60:63], v[56:59], 0
    v_exp_f32 v30, v30
    v_exp_f32 v31, v31
    ds_read_b128 v[72:75], v2 offset:6144
    v_exp_f32 v32, v32
    v_exp_f32 v33, v33
    v_exp_f32_e64 v34, v34
    v_smfmac_f32_32x32x32_bf16 v[40:55], v[76:79], v[24:31], v7
    v_exp_f32 v35, v35
    v_exp_f32_e64 v36, v36
    s_mov_b64 exec, s[62:63]
    ds_read_b128 v[64:67], v2 offset:5120
    ds_read_b128 v[68:71], v2 offset:4864
    s_mov_b64 exec, -1
    v_exp_f32 v37, v37
    v_exp_f32 v38, v38
    s_lshl_b32 s61, s49, 10
    s_add_u32 m0, s61, 122880
    s_add_u32 s59, s61, 0x21e000
    buffer_load_dwordx4 v1, s[28:31], s59 offen sc1 lds
    v_exp_f32 v39, v39
    s_setprio 1
    v_exp_f32 v8, v8
    v_exp_f32 v9, v9
    v_smfmac_f32_32x32x32_bf16 v[40:55], v[80:83], v[32:39], v7
    v_exp_f32 v10, v10
    v_exp_f32 v11, v11
    v_exp_f32 v12, v12
    s_waitcnt lgkmcnt(0)
    v_exp_f32_e64 v13, v13
    v_mfma_f32_32x32x16_bf16 v[24:39], v[72:75], v[56:59], 0
    v_exp_f32 v14, v14
    v_exp_f32 v15, v15
    ds_read_b128 v[60:63], v2 offset:8192
    v_exp_f32 v16, v16
    v_exp_f32 v17, v17
    v_exp_f32_e64 v18, v18
    v_smfmac_f32_32x32x32_bf16 v[40:55], v[64:67], v[8:15], v7
    v_exp_f32 v19, v19
    v_exp_f32_e64 v20, v20
    s_mov_b64 exec, s[62:63]
    ds_read_b128 v[76:79], v2 offset:7168
    ds_read_b128 v[80:83], v2 offset:6912
    s_mov_b64 exec, -1
    v_exp_f32 v21, v21
    v_exp_f32 v22, v22
    v_exp_f32 v23, v23
    v_exp_f32 v24, v24
    v_exp_f32 v25, v25
    v_smfmac_f32_32x32x32_bf16 v[40:55], v[68:71], v[16:23], v7
    v_exp_f32 v26, v26
    v_exp_f32 v27, v27
    v_exp_f32 v28, v28
    s_waitcnt lgkmcnt(0)
    v_exp_f32_e64 v29, v29
    v_mfma_f32_32x32x16_bf16 v[8:23], v[60:63], v[56:59], 0
    v_exp_f32 v30, v30
    v_exp_f32 v31, v31
    ds_read_b128 v[72:75], v2 offset:10240
    v_exp_f32 v32, v32
    v_exp_f32 v33, v33
    v_exp_f32_e64 v34, v34
    v_smfmac_f32_32x32x32_bf16 v[40:55], v[76:79], v[24:31], v7
    v_exp_f32 v35, v35
    v_exp_f32_e64 v36, v36
    s_mov_b64 exec, s[62:63]
    ds_read_b128 v[64:67], v2 offset:9216
    ds_read_b128 v[68:71], v2 offset:8960
    s_mov_b64 exec, -1
    v_exp_f32 v37, v37
    v_exp_f32 v38, v38
    v_exp_f32 v39, v39
    v_exp_f32 v8, v8
    v_exp_f32 v9, v9
    v_smfmac_f32_32x32x32_bf16 v[40:55], v[80:83], v[32:39], v7
    v_exp_f32 v10, v10
    v_exp_f32 v11, v11
    v_exp_f32 v12, v12
    s_waitcnt lgkmcnt(0)
    v_exp_f32_e64 v13, v13
    v_mfma_f32_32x32x16_bf16 v[24:39], v[72:75], v[56:59], 0
    v_exp_f32 v14, v14
    v_exp_f32 v15, v15
    ds_read_b128 v[60:63], v2 offset:12288
    v_exp_f32 v16, v16
    v_exp_f32 v17, v17
    v_exp_f32_e64 v18, v18
    v_smfmac_f32_32x32x32_bf16 v[40:55], v[64:67], v[8:15], v7
    v_exp_f32 v19, v19
    v_exp_f32_e64 v20, v20
    s_mov_b64 exec, s[62:63]
    ds_read_b128 v[76:79], v2 offset:11264
    ds_read_b128 v[80:83], v2 offset:11008
    s_mov_b64 exec, -1
    v_exp_f32 v21, v21
    v_exp_f32 v22, v22
    v_exp_f32 v23, v23
    s_setprio 0
    v_exp_f32 v24, v24
    v_exp_f32_e64 v25, v25
    v_smfmac_f32_32x32x32_bf16 v[40:55], v[68:71], v[16:23], v7
    v_exp_f32 v26, v26
    v_exp_f32 v27, v27
    v_exp_f32 v28, v28
    s_waitcnt lgkmcnt(0)
    v_exp_f32_e64 v29, v29
    v_mfma_f32_32x32x16_bf16 v[8:23], v[60:63], v[56:59], 0
    v_exp_f32 v30, v30
    v_exp_f32 v31, v31
    ds_read_b128 v[72:75], v2 offset:14336
    v_exp_f32 v32, v32
    v_exp_f32 v33, v33
    v_exp_f32_e64 v34, v34
    v_smfmac_f32_32x32x32_bf16 v[40:55], v[76:79], v[24:31], v7
    v_exp_f32 v35, v35
    v_exp_f32_e64 v36, v36
    s_mov_b64 exec, s[62:63]
    ds_read_b128 v[64:67], v2 offset:13312
    ds_read_b128 v[68:71], v2 offset:13056
    s_mov_b64 exec, -1
    v_exp_f32 v37, v37
    v_exp_f32 v38, v38
    v_exp_f32 v39, v39
    s_waitcnt vmcnt(0)
    s_barrier
    v_mov_b32 v252, s66
    s_lshl_b32 s59, s45, 7
    s_lshl_b32 s60, s46, 2
    s_add_u32 s59, s59, s60
    s_add_u32 s59, s59, 0xe01000
    s_cmp_lg_u32 s49, 0
    s_cselect_b64 exec, 0, 1
    buffer_store_dword v252, v1, s[28:31], s59 offen sc1
    s_mov_b64 exec, -1
    s_setprio 3
    v_exp_f32 v8, v8
    v_exp_f32 v9, v9
    v_smfmac_f32_32x32x32_bf16 v[40:55], v[80:83], v[32:39], v7
    v_exp_f32_e64 v10, v10
    s_add_u32 m0, s53, 0
    s_add_u32 s59, s54, 0
    buffer_load_dwordx4 v3, s[12:15], s59 offen lds
    v_exp_f32 v11, v11
    v_exp_f32 v12, v12
    s_waitcnt lgkmcnt(0)
    v_exp_f32 v13, v13
    v_mfma_f32_32x32x16_bf16 v[24:39], v[72:75], v[56:59], 0
    v_exp_f32_e64 v14, v14
    s_add_u32 m0, s53, 1024
    s_add_u32 s59, s54, 16384
    buffer_load_dwordx4 v3, s[12:15], s59 offen lds
    v_exp_f32_e64 v15, v15
    ds_read_b128 v[60:63], v2 offset:16384
    v_exp_f32 v16, v16
    v_exp_f32 v17, v17
    v_exp_f32_e64 v18, v18
    v_smfmac_f32_32x32x32_bf16 v[40:55], v[64:67], v[8:15], v7
    s_add_u32 m0, s53, 2048
    s_add_u32 s59, s54, 32768
    buffer_load_dwordx4 v3, s[12:15], s59 offen lds
    v_exp_f32 v19, v19
    v_exp_f32_e64 v20, v20
    s_mov_b64 exec, s[62:63]
    ds_read_b128 v[76:79], v2 offset:15360
    ds_read_b128 v[80:83], v2 offset:15104
    s_mov_b64 exec, -1
    v_exp_f32 v21, v21
    v_exp_f32_e64 v22, v22
    s_add_u32 m0, s53, 3072
    s_add_u32 s59, s54, 49152
    buffer_load_dwordx4 v3, s[12:15], s59 offen lds
    v_exp_f32 v23, v23
    v_exp_f32 v24, v24
    v_exp_f32_e64 v25, v25
    v_smfmac_f32_32x32x32_bf16 v[40:55], v[68:71], v[16:23], v7
    v_exp_f32 v26, v26
    v_exp_f32 v27, v27
    v_exp_f32 v28, v28
    s_waitcnt lgkmcnt(0)
    v_exp_f32_e64 v29, v29
    v_mfma_f32_32x32x16_bf16 v[8:23], v[60:63], v[56:59], 0
    v_exp_f32 v30, v30
    v_exp_f32 v31, v31
    ds_read_b128 v[72:75], v2 offset:18432
    v_exp_f32 v32, v32
    v_exp_f32 v33, v33
    v_exp_f32_e64 v34, v34
    v_smfmac_f32_32x32x32_bf16 v[40:55], v[76:79], v[24:31], v7
    v_exp_f32 v35, v35
    v_exp_f32_e64 v36, v36
    s_mov_b64 exec, s[62:63]
    ds_read_b128 v[64:67], v2 offset:17408
    ds_read_b128 v[68:71], v2 offset:17152
    s_mov_b64 exec, -1
    v_exp_f32 v37, v37
    v_exp_f32 v38, v38
    s_mov_b32 s70, s43
    s_mov_b32 s71, 57344
    s_cmp_eq_u32 s49, 7
    s_nop 0
    s_cselect_b32 s71, 16384, s71
    s_cselect_b32 s43, 0, s43
    s_cselect_b32 s55, s56, s55
    s_cselect_b32 s20, s24, s20
    s_cselect_b32 s21, s25, s21
    s_cselect_b64 vcc, -1, 0
    v_cndmask_b32 v6, v6, v3, vcc
    v_exp_f32 v39, v39
    v_exp_f32 v8, v8
    v_exp_f32_e64 v9, v9
    v_smfmac_f32_32x32x32_bf16 v[40:55], v[80:83], v[32:39], v7
    v_exp_f32_e64 v10, v10
    s_add_u32 m0, s53, 32768
    s_add_u32 s59, s54, 65536
    buffer_load_dwordx4 v3, s[12:15], s59 offen lds
    v_exp_f32 v11, v11
    v_exp_f32 v12, v12
    s_waitcnt lgkmcnt(0)
    v_exp_f32 v13, v13
    v_mfma_f32_32x32x16_bf16 v[24:39], v[72:75], v[56:59], 0
    v_exp_f32_e64 v14, v14
    s_add_u32 m0, s53, 33792
    s_add_u32 s59, s54, 81920
    buffer_load_dwordx4 v3, s[12:15], s59 offen lds
    v_exp_f32_e64 v15, v15
    ds_read_b128 v[60:63], v2 offset:20480
    v_exp_f32 v16, v16
    v_exp_f32 v17, v17
    v_exp_f32_e64 v18, v18
    v_smfmac_f32_32x32x32_bf16 v[40:55], v[64:67], v[8:15], v7
    s_add_u32 m0, s53, 34816
    s_add_u32 s59, s54, 98304
    buffer_load_dwordx4 v3, s[12:15], s59 offen lds
    v_exp_f32 v19, v19
    v_exp_f32_e64 v20, v20
    s_mov_b64 exec, s[62:63]
    ds_read_b128 v[76:79], v2 offset:19456
    ds_read_b128 v[80:83], v2 offset:19200
    s_mov_b64 exec, -1
    v_exp_f32 v21, v21
    v_exp_f32_e64 v22, v22
    s_add_u32 m0, s53, 35840
    s_add_u32 s59, s54, 114688
    buffer_load_dwordx4 v3, s[12:15], s59 offen lds
    v_exp_f32 v23, v23
    v_exp_f32 v24, v24
    v_exp_f32_e64 v25, v25
    v_smfmac_f32_32x32x32_bf16 v[40:55], v[68:71], v[16:23], v7
    v_exp_f32 v26, v26
    v_exp_f32 v27, v27
    v_exp_f32 v28, v28
    s_waitcnt lgkmcnt(0)
    v_exp_f32_e64 v29, v29
    v_mfma_f32_32x32x16_bf16 v[8:23], v[60:63], v[56:59], 0
    v_exp_f32_e64 v30, v30
    ds_read_b64_tr_b16 v[132:133], v5 offset:0
    ds_read_b64_tr_b16 v[134:135], v5 offset:256
    ds_read_b64_tr_b16 v[136:137], v5 offset:1024
    ds_read_b64_tr_b16 v[138:139], v5 offset:1280
    v_exp_f32_e64 v31, v31
    ds_read_b128 v[72:75], v2 offset:22528
    v_exp_f32 v32, v32
    v_exp_f32 v33, v33
    v_exp_f32_e64 v34, v34
    v_smfmac_f32_32x32x32_bf16 v[40:55], v[76:79], v[24:31], v7
    v_exp_f32 v35, v35
    v_exp_f32_e64 v36, v36
    s_mov_b64 exec, s[62:63]
    ds_read_b128 v[64:67], v2 offset:21504
    ds_read_b128 v[68:71], v2 offset:21248
    s_mov_b64 exec, -1
    v_exp_f32 v37, v37
    v_exp_f32_e64 v38, v38
    ds_read_b64_tr_b16 v[140:141], v5 offset:2048
    ds_read_b64_tr_b16 v[142:143], v5 offset:2304
    ds_read_b64_tr_b16 v[144:145], v5 offset:3072
    ds_read_b64_tr_b16 v[146:147], v5 offset:3328
    v_exp_f32 v39, v39
    v_exp_f32 v8, v8
    v_exp_f32_e64 v9, v9
    v_smfmac_f32_32x32x32_bf16 v[40:55], v[80:83], v[32:39], v7
    v_exp_f32 v10, v10
    s_waitcnt lgkmcnt(0)
    s_add_u32 m0, s53, 131072
    s_add_u32 s59, s54, 131072
    buffer_load_dwordx4 v3, s[12:15], s59 offen lds
    v_exp_f32 v11, v11
    v_exp_f32 v12, v12
    v_exp_f32_e64 v13, v13
    v_mfma_f32_32x32x16_bf16 v[24:39], v[72:75], v[56:59], 0
    v_exp_f32_e64 v14, v14
    s_add_u32 m0, s53, 132096
    s_add_u32 s59, s54, 147456
    buffer_load_dwordx4 v3, s[12:15], s59 offen lds
    v_exp_f32_e64 v15, v15
    ds_read_b128 v[60:63], v2 offset:24576
    v_exp_f32 v16, v16
    v_exp_f32 v17, v17
    v_exp_f32_e64 v18, v18
    v_smfmac_f32_32x32x32_bf16 v[40:55], v[64:67], v[8:15], v7
    s_add_u32 m0, s53, 133120
    s_add_u32 s59, s54, 163840
    buffer_load_dwordx4 v3, s[12:15], s59 offen lds
    v_exp_f32 v19, v19
    v_exp_f32_e64 v20, v20
    s_mov_b64 exec, s[62:63]
    ds_read_b128 v[76:79], v2 offset:23552
    ds_read_b128 v[80:83], v2 offset:23296
    s_mov_b64 exec, -1
    v_exp_f32 v21, v21
    v_exp_f32_e64 v22, v22
    s_add_u32 m0, s53, 134144
    s_add_u32 s59, s54, 180224
    buffer_load_dwordx4 v3, s[12:15], s59 offen lds
    v_exp_f32 v23, v23
    v_exp_f32 v24, v24
    v_exp_f32_e64 v25, v25
    v_smfmac_f32_32x32x32_bf16 v[40:55], v[68:71], v[16:23], v7
    v_exp_f32 v26, v26
    v_exp_f32 v27, v27
    v_exp_f32 v28, v28
    s_waitcnt lgkmcnt(0)
    v_exp_f32_e64 v29, v29
    v_mfma_f32_32x32x16_bf16 v[8:23], v[60:63], v[56:59], 0
    v_exp_f32 v30, v30
    v_exp_f32 v31, v31
    ds_read_b128 v[72:75], v2 offset:26624
    v_exp_f32 v32, v32
    v_exp_f32 v33, v33
    v_exp_f32_e64 v34, v34
    v_smfmac_f32_32x32x32_bf16 v[40:55], v[76:79], v[24:31], v7
    v_exp_f32 v35, v35
    v_exp_f32_e64 v36, v36
    s_mov_b64 exec, s[62:63]
    ds_read_b128 v[64:67], v2 offset:25600
    ds_read_b128 v[68:71], v2 offset:25344
    s_mov_b64 exec, -1
    v_exp_f32 v37, v37
    v_exp_f32 v38, v38
    v_exp_f32 v39, v39
    v_exp_f32 v8, v8
    v_exp_f32 v9, v9
    v_smfmac_f32_32x32x32_bf16 v[40:55], v[80:83], v[32:39], v7
    v_exp_f32 v10, v10
    v_exp_f32 v11, v11
    v_exp_f32 v12, v12
    s_waitcnt lgkmcnt(0)
    v_exp_f32_e64 v13, v13
    v_mfma_f32_32x32x16_bf16 v[24:39], v[72:75], v[56:59], 0
    v_exp_f32 v14, v14
    v_exp_f32 v15, v15
    ds_read_b128 v[60:63], v2 offset:28672
    v_exp_f32 v16, v16
    v_exp_f32 v17, v17
    v_exp_f32_e64 v18, v18
    v_smfmac_f32_32x32x32_bf16 v[40:55], v[64:67], v[8:15], v7
    v_exp_f32 v19, v19
    v_exp_f32_e64 v20, v20
    s_mov_b64 exec, s[62:63]
    ds_read_b128 v[76:79], v2 offset:27648
    ds_read_b128 v[80:83], v2 offset:27392
    s_mov_b64 exec, -1
    v_exp_f32 v21, v21
    v_exp_f32 v22, v22
    v_exp_f32 v23, v23
    v_exp_f32 v24, v24
    v_exp_f32 v25, v25
    v_smfmac_f32_32x32x32_bf16 v[40:55], v[68:71], v[16:23], v7
    v_exp_f32 v26, v26
    v_exp_f32 v27, v27
    v_exp_f32 v28, v28
    s_waitcnt lgkmcnt(0)
    v_exp_f32_e64 v29, v29
    v_mfma_f32_32x32x16_bf16 v[8:23], v[60:63], v[56:59], 0
    v_exp_f32 v30, v30
    s_waitcnt vmcnt(8)
    ds_read_b64_tr_b16 v[148:149], v4 offset:0
    ds_read_b64_tr_b16 v[150:151], v4 offset:256
    ds_read_b64_tr_b16 v[152:153], v4 offset:1024
    ds_read_b64_tr_b16 v[154:155], v4 offset:1280
    v_exp_f32_e64 v31, v31
    ds_read_b128 v[72:75], v2 offset:30720
    v_exp_f32 v32, v32
    v_exp_f32 v33, v33
    v_exp_f32_e64 v34, v34
    v_smfmac_f32_32x32x32_bf16 v[40:55], v[76:79], v[24:31], v7
    v_exp_f32 v35, v35
    v_exp_f32_e64 v36, v36
    s_mov_b64 exec, s[62:63]
    ds_read_b128 v[64:67], v2 offset:29696
    ds_read_b128 v[68:71], v2 offset:29440
    s_mov_b64 exec, -1
    v_exp_f32 v37, v37
    v_exp_f32_e64 v38, v38
    ds_read_b64_tr_b16 v[156:157], v4 offset:2048
    ds_read_b64_tr_b16 v[158:159], v4 offset:2304
    ds_read_b64_tr_b16 v[160:161], v4 offset:3072
    ds_read_b64_tr_b16 v[162:163], v4 offset:3328
    v_exp_f32 v39, v39
    v_exp_f32 v8, v8
    v_exp_f32_e64 v9, v9
    v_smfmac_f32_32x32x32_bf16 v[40:55], v[80:83], v[32:39], v7
    v_exp_f32_e64 v10, v10
    s_waitcnt lgkmcnt(0)
    s_add_u32 m0, s53, 0
    s_add_u32 s59, s54, 196608
    buffer_load_dwordx4 v3, s[12:15], s59 offen lds
    v_exp_f32 v11, v11
    v_exp_f32 v12, v12
    v_exp_f32_e64 v13, v13
    v_mfma_f32_32x32x16_bf16 v[24:39], v[72:75], v[56:59], 0
    v_exp_f32_e64 v14, v14
    s_add_u32 m0, s53, 1024
    s_add_u32 s59, s54, 212992
    buffer_load_dwordx4 v3, s[12:15], s59 offen lds
    v_exp_f32_e64 v15, v15
    ds_read_b128 v[60:63], v2 offset:32768
    v_exp_f32 v16, v16
    v_exp_f32 v17, v17
    v_exp_f32_e64 v18, v18
    v_smfmac_f32_32x32x32_bf16 v[40:55], v[64:67], v[8:15], v7
    s_add_u32 m0, s53, 2048
    s_add_u32 s59, s54, 229376
    buffer_load_dwordx4 v3, s[12:15], s59 offen lds
    v_exp_f32 v19, v19
    v_exp_f32_e64 v20, v20
    s_mov_b64 exec, s[62:63]
    ds_read_b128 v[76:79], v2 offset:31744
    ds_read_b128 v[80:83], v2 offset:31488
    s_mov_b64 exec, -1
    v_exp_f32 v21, v21
    v_exp_f32_e64 v22, v22
    s_add_u32 m0, s53, 3072
    s_add_u32 s59, s54, 245760
    buffer_load_dwordx4 v3, s[12:15], s59 offen lds
    v_exp_f32 v23, v23
    v_exp_f32 v24, v24
    v_exp_f32_e64 v25, v25
    v_smfmac_f32_32x32x32_bf16 v[40:55], v[68:71], v[16:23], v7
    v_exp_f32 v26, v26
    v_exp_f32 v27, v27
    v_exp_f32 v28, v28
    s_waitcnt lgkmcnt(0)
    v_exp_f32_e64 v29, v29
    v_mfma_f32_32x32x16_bf16 v[8:23], v[60:63], v[56:59], 0
    v_exp_f32 v30, v30
    s_waitcnt vmcnt(8)
    ds_read_b64_tr_b16 v[164:165], v4 offset:32768
    ds_read_b64_tr_b16 v[166:167], v4 offset:33024
    ds_read_b64_tr_b16 v[168:169], v4 offset:33792
    ds_read_b64_tr_b16 v[170:171], v4 offset:34048
    v_exp_f32_e64 v31, v31
    ds_read_b128 v[72:75], v2 offset:34816
    v_exp_f32 v32, v32
    v_exp_f32 v33, v33
    v_exp_f32_e64 v34, v34
    v_smfmac_f32_32x32x32_bf16 v[40:55], v[76:79], v[24:31], v7
    v_exp_f32 v35, v35
    v_exp_f32_e64 v36, v36
    s_mov_b64 exec, s[62:63]
    ds_read_b128 v[64:67], v2 offset:33792
    ds_read_b128 v[68:71], v2 offset:33536
    s_mov_b64 exec, -1
    v_exp_f32 v37, v37
    v_exp_f32_e64 v38, v38
    ds_read_b64_tr_b16 v[172:173], v4 offset:34816
    ds_read_b64_tr_b16 v[174:175], v4 offset:35072
    ds_read_b64_tr_b16 v[176:177], v4 offset:35840
    ds_read_b64_tr_b16 v[178:179], v4 offset:36096
    v_exp_f32 v39, v39
    v_exp_f32 v8, v8
    v_exp_f32_e64 v9, v9
    v_smfmac_f32_32x32x32_bf16 v[40:55], v[80:83], v[32:39], v7
    v_exp_f32 v10, v10
    s_waitcnt lgkmcnt(0)
    s_add_u32 m0, s53, 32768
    s_add_u32 s59, s54, 0
    s_nop 0
    buffer_load_dwordx4 v3, s[16:19], s59 offen lds
    v_exp_f32 v11, v11
    v_exp_f32 v12, v12
    v_exp_f32_e64 v13, v13
    v_mfma_f32_32x32x16_bf16 v[24:39], v[72:75], v[56:59], 0
    v_exp_f32_e64 v14, v14
    s_add_u32 m0, s53, 33792
    s_add_u32 s59, s54, 16384
    buffer_load_dwordx4 v3, s[16:19], s59 offen lds
    v_exp_f32_e64 v15, v15
    ds_read_b128 v[60:63], v2 offset:36864
    v_exp_f32 v16, v16
    v_exp_f32 v17, v17
    v_exp_f32_e64 v18, v18
    v_smfmac_f32_32x32x32_bf16 v[40:55], v[64:67], v[8:15], v7
    s_add_u32 m0, s53, 34816
    s_add_u32 s59, s54, 32768
    buffer_load_dwordx4 v3, s[16:19], s59 offen lds
    v_exp_f32 v19, v19
    v_exp_f32_e64 v20, v20
    s_mov_b64 exec, s[62:63]
    ds_read_b128 v[76:79], v2 offset:35840
    ds_read_b128 v[80:83], v2 offset:35584
    s_mov_b64 exec, -1
    v_exp_f32 v21, v21
    v_exp_f32_e64 v22, v22
    s_add_u32 m0, s53, 35840
    s_add_u32 s59, s54, 49152
    buffer_load_dwordx4 v3, s[16:19], s59 offen lds
    v_exp_f32 v23, v23
    v_exp_f32 v24, v24
    v_exp_f32_e64 v25, v25
    v_smfmac_f32_32x32x32_bf16 v[40:55], v[68:71], v[16:23], v7
    v_exp_f32 v26, v26
    v_exp_f32 v27, v27
    v_exp_f32 v28, v28
    s_waitcnt lgkmcnt(0)
    v_exp_f32_e64 v29, v29
    v_mfma_f32_32x32x16_bf16 v[8:23], v[60:63], v[56:59], 0
    v_exp_f32 v30, v30
    s_waitcnt vmcnt(8)
    ds_read_b64_tr_b16 v[180:181], v5 offset:0
    ds_read_b64_tr_b16 v[182:183], v5 offset:256
    ds_read_b64_tr_b16 v[184:185], v5 offset:1024
    ds_read_b64_tr_b16 v[186:187], v5 offset:1280
    v_exp_f32_e64 v31, v31
    ds_read_b128 v[72:75], v2 offset:38912
    v_exp_f32 v32, v32
    v_exp_f32 v33, v33
    v_exp_f32_e64 v34, v34
    v_smfmac_f32_32x32x32_bf16 v[40:55], v[76:79], v[24:31], v7
    v_exp_f32 v35, v35
    v_exp_f32_e64 v36, v36
    s_mov_b64 exec, s[62:63]
    ds_read_b128 v[64:67], v2 offset:37888
    ds_read_b128 v[68:71], v2 offset:37632
    s_mov_b64 exec, -1
    v_exp_f32 v37, v37
    v_exp_f32_e64 v38, v38
    ds_read_b64_tr_b16 v[188:189], v5 offset:2048
    ds_read_b64_tr_b16 v[190:191], v5 offset:2304
    ds_read_b64_tr_b16 v[192:193], v5 offset:3072
    ds_read_b64_tr_b16 v[194:195], v5 offset:3328
    v_exp_f32 v39, v39
    v_exp_f32 v8, v8
    v_exp_f32_e64 v9, v9
    v_smfmac_f32_32x32x32_bf16 v[40:55], v[80:83], v[32:39], v7
    v_exp_f32 v10, v10
    s_waitcnt lgkmcnt(0)
    s_add_u32 m0, s53, 131072
    s_add_u32 s59, s54, 65536
    buffer_load_dwordx4 v3, s[16:19], s59 offen lds
    v_exp_f32 v11, v11
    v_exp_f32 v12, v12
    v_exp_f32_e64 v13, v13
    v_mfma_f32_32x32x16_bf16 v[24:39], v[72:75], v[56:59], 0
    v_exp_f32_e64 v14, v14
    s_add_u32 m0, s53, 132096
    s_add_u32 s59, s54, 81920
    buffer_load_dwordx4 v3, s[16:19], s59 offen lds
    v_exp_f32_e64 v15, v15
    ds_read_b128 v[60:63], v2 offset:40960
    v_exp_f32 v16, v16
    v_exp_f32 v17, v17
    v_exp_f32_e64 v18, v18
    v_smfmac_f32_32x32x32_bf16 v[40:55], v[64:67], v[8:15], v7
    s_add_u32 m0, s53, 133120
    s_add_u32 s59, s54, 98304
    buffer_load_dwordx4 v3, s[16:19], s59 offen lds
    v_exp_f32 v19, v19
    v_exp_f32_e64 v20, v20
    s_mov_b64 exec, s[62:63]
    ds_read_b128 v[76:79], v2 offset:39936
    ds_read_b128 v[80:83], v2 offset:39680
    s_mov_b64 exec, -1
    v_exp_f32 v21, v21
    v_exp_f32_e64 v22, v22
    s_add_u32 m0, s53, 134144
    s_add_u32 s59, s54, 114688
    buffer_load_dwordx4 v3, s[16:19], s59 offen lds
    v_exp_f32 v23, v23
    v_exp_f32 v24, v24
    v_exp_f32_e64 v25, v25
    v_smfmac_f32_32x32x32_bf16 v[40:55], v[68:71], v[16:23], v7
    v_exp_f32 v26, v26
    v_exp_f32 v27, v27
    v_exp_f32 v28, v28
    s_waitcnt lgkmcnt(0)
    v_exp_f32_e64 v29, v29
    v_mfma_f32_32x32x16_bf16 v[8:23], v[60:63], v[56:59], 0
    v_exp_f32 v30, v30
    v_exp_f32 v31, v31
    ds_read_b128 v[72:75], v2 offset:43008
    v_exp_f32 v32, v32
    v_exp_f32 v33, v33
    v_exp_f32_e64 v34, v34
    v_smfmac_f32_32x32x32_bf16 v[40:55], v[76:79], v[24:31], v7
    v_exp_f32 v35, v35
    v_exp_f32_e64 v36, v36
    s_mov_b64 exec, s[62:63]
    ds_read_b128 v[64:67], v2 offset:41984
    ds_read_b128 v[68:71], v2 offset:41728
    s_mov_b64 exec, -1
    v_exp_f32 v37, v37
    v_exp_f32 v38, v38
    v_exp_f32 v39, v39
    v_exp_f32 v8, v8
    v_exp_f32 v9, v9
    v_smfmac_f32_32x32x32_bf16 v[40:55], v[80:83], v[32:39], v7
    v_exp_f32 v10, v10
    v_exp_f32 v11, v11
    v_exp_f32 v12, v12
    s_waitcnt lgkmcnt(0)
    v_exp_f32_e64 v13, v13
    v_mfma_f32_32x32x16_bf16 v[24:39], v[72:75], v[56:59], 0
    v_exp_f32 v14, v14
    v_exp_f32 v15, v15
    ds_read_b128 v[60:63], v2 offset:45056
    v_exp_f32 v16, v16
    v_exp_f32 v17, v17
    v_exp_f32_e64 v18, v18
    v_smfmac_f32_32x32x32_bf16 v[40:55], v[64:67], v[8:15], v7
    v_exp_f32 v19, v19
    v_exp_f32_e64 v20, v20
    s_mov_b64 exec, s[62:63]
    ds_read_b128 v[76:79], v2 offset:44032
    ds_read_b128 v[80:83], v2 offset:43776
    s_mov_b64 exec, -1
    v_exp_f32 v21, v21
    v_exp_f32 v22, v22
    v_and_b32 v252, 31, v0
    v_lshlrev_b32 v252, 10, v252
    v_lshrrev_b32 v253, 5, v0
    v_lshl_add_u32 v252, v253, 4, v252
    s_lshl_b32 s60, s47, 15
    s_lshl_b32 s61, s48, 8
    s_add_u32 s60, s60, s61
    s_lshl_b32 s61, s50, 6
    s_add_u32 s60, s60, s61
    s_nop 0
    buffer_load_dwordx4 v[244:247], v252, s[4:7], s60 offen
    buffer_load_dwordx4 v[248:251], v252, s[4:7], s60 offen offset:32
    v_exp_f32 v23, v23
    v_exp_f32 v24, v24
    v_exp_f32_e64 v25, v25
    v_smfmac_f32_32x32x32_bf16 v[40:55], v[68:71], v[16:23], v7
    v_exp_f32 v26, v26
    v_exp_f32 v27, v27
    v_exp_f32 v28, v28
    s_waitcnt lgkmcnt(0)
    v_exp_f32_e64 v29, v29
    v_mfma_f32_32x32x16_bf16 v[8:23], v[60:63], v[56:59], 0
    v_exp_f32 v30, v30
    v_exp_f32 v31, v31
    ds_read_b128 v[72:75], v2 offset:47104
    v_exp_f32 v32, v32
    v_exp_f32 v33, v33
    v_exp_f32_e64 v34, v34
    v_smfmac_f32_32x32x32_bf16 v[40:55], v[76:79], v[24:31], v7
    v_exp_f32 v35, v35
    v_exp_f32_e64 v36, v36
    s_mov_b64 exec, s[62:63]
    ds_read_b128 v[64:67], v2 offset:46080
    ds_read_b128 v[68:71], v2 offset:45824
    s_mov_b64 exec, -1
    v_exp_f32 v37, v37
    v_exp_f32 v38, v38
    v_exp_f32 v39, v39
    s_setprio 2
    v_exp_f32 v8, v8
    v_exp_f32_e64 v9, v9
    v_smfmac_f32_32x32x32_bf16 v[40:55], v[80:83], v[32:39], v7
    v_exp_f32 v10, v10
    v_exp_f32 v11, v11
    v_exp_f32 v12, v12
    s_waitcnt lgkmcnt(0)
    v_exp_f32_e64 v13, v13
    v_mfma_f32_32x32x16_bf16 v[24:39], v[72:75], v[56:59], 0
    v_exp_f32 v14, v14
    s_waitcnt vmcnt(10)
    ds_read_b64_tr_b16 v[196:197], v4 offset:0
    ds_read_b64_tr_b16 v[198:199], v4 offset:256
    ds_read_b64_tr_b16 v[200:201], v4 offset:1024
    ds_read_b64_tr_b16 v[202:203], v4 offset:1280
    v_exp_f32_e64 v15, v15
    ds_read_b128 v[60:63], v2 offset:49152
    v_exp_f32 v16, v16
    v_exp_f32 v17, v17
    v_exp_f32_e64 v18, v18
    v_smfmac_f32_32x32x32_bf16 v[40:55], v[64:67], v[8:15], v7
    v_exp_f32 v19, v19
    v_exp_f32_e64 v20, v20
    s_mov_b64 exec, s[62:63]
    ds_read_b128 v[76:79], v2 offset:48128
    ds_read_b128 v[80:83], v2 offset:47872
    s_mov_b64 exec, -1
    v_exp_f32 v21, v21
    v_exp_f32_e64 v22, v22
    ds_read_b64_tr_b16 v[204:205], v4 offset:2048
    ds_read_b64_tr_b16 v[206:207], v4 offset:2304
    ds_read_b64_tr_b16 v[208:209], v4 offset:3072
    ds_read_b64_tr_b16 v[210:211], v4 offset:3328
    v_exp_f32 v23, v23
    v_exp_f32 v24, v24
    v_exp_f32_e64 v25, v25
    v_smfmac_f32_32x32x32_bf16 v[40:55], v[68:71], v[16:23], v7
    v_exp_f32_e64 v26, v26
    s_waitcnt lgkmcnt(0)
    s_add_u32 m0, s53, 0
    s_add_u32 s59, s54, 196608
    buffer_load_dwordx4 v3, s[16:19], s59 offen lds
    v_exp_f32 v27, v27
    v_exp_f32 v28, v28
    v_exp_f32_e64 v29, v29
    v_mfma_f32_32x32x16_bf16 v[8:23], v[60:63], v[56:59], 0
    v_exp_f32_e64 v30, v30
    s_add_u32 m0, s53, 1024
    s_add_u32 s59, s54, 212992
    buffer_load_dwordx4 v3, s[16:19], s59 offen lds
    v_exp_f32_e64 v31, v31
    ds_read_b128 v[72:75], v2 offset:51200
    v_exp_f32 v32, v32
    v_exp_f32 v33, v33
    v_exp_f32_e64 v34, v34
    v_smfmac_f32_32x32x32_bf16 v[40:55], v[76:79], v[24:31], v7
    s_add_u32 m0, s53, 2048
    s_add_u32 s59, s54, 229376
    buffer_load_dwordx4 v3, s[16:19], s59 offen lds
    v_exp_f32 v35, v35
    v_exp_f32_e64 v36, v36
    s_mov_b64 exec, s[62:63]
    ds_read_b128 v[64:67], v2 offset:50176
    ds_read_b128 v[68:71], v2 offset:49920
    s_mov_b64 exec, -1
    v_exp_f32 v37, v37
    v_exp_f32_e64 v38, v38
    s_add_u32 m0, s53, 3072
    s_add_u32 s59, s54, 245760
    buffer_load_dwordx4 v3, s[16:19], s59 offen lds
    v_exp_f32 v39, v39
    v_exp_f32 v8, v8
    v_exp_f32_e64 v9, v9
    v_smfmac_f32_32x32x32_bf16 v[40:55], v[80:83], v[32:39], v7
    v_exp_f32 v10, v10
    v_exp_f32 v11, v11
    v_exp_f32 v12, v12
    s_waitcnt lgkmcnt(0)
    v_exp_f32_e64 v13, v13
    v_mfma_f32_32x32x16_bf16 v[24:39], v[72:75], v[56:59], 0
    v_exp_f32 v14, v14
    s_waitcnt vmcnt(10)
    ds_read_b64_tr_b16 v[212:213], v4 offset:32768
    ds_read_b64_tr_b16 v[214:215], v4 offset:33024
    ds_read_b64_tr_b16 v[216:217], v4 offset:33792
    ds_read_b64_tr_b16 v[218:219], v4 offset:34048
    v_exp_f32_e64 v15, v15
    ds_read_b128 v[60:63], v2 offset:53248
    v_exp_f32 v16, v16
    v_exp_f32 v17, v17
    v_exp_f32_e64 v18, v18
    v_smfmac_f32_32x32x32_bf16 v[40:55], v[64:67], v[8:15], v7
    v_exp_f32 v19, v19
    v_exp_f32_e64 v20, v20
    s_mov_b64 exec, s[62:63]
    ds_read_b128 v[76:79], v2 offset:52224
    ds_read_b128 v[80:83], v2 offset:51968
    s_mov_b64 exec, -1
    v_exp_f32 v21, v21
    v_exp_f32_e64 v22, v22
    ds_read_b64_tr_b16 v[220:221], v4 offset:34816
    ds_read_b64_tr_b16 v[222:223], v4 offset:35072
    ds_read_b64_tr_b16 v[224:225], v4 offset:35840
    ds_read_b64_tr_b16 v[226:227], v4 offset:36096
    v_exp_f32 v23, v23
    v_exp_f32 v24, v24
    v_exp_f32_e64 v25, v25
    v_smfmac_f32_32x32x32_bf16 v[40:55], v[68:71], v[16:23], v7
    v_exp_f32 v26, v26
    v_exp_f32 v27, v27
    v_exp_f32 v28, v28
    s_waitcnt lgkmcnt(4)
    v_exp_f32_e64 v29, v29
    v_mfma_f32_32x32x16_bf16 v[8:23], v[60:63], v[56:59], 0
    v_exp_f32 v30, v30
    v_exp_f32 v31, v31
    ds_read_b128 v[72:75], v2 offset:55296
    v_exp_f32 v32, v32
    v_exp_f32 v33, v33
    v_exp_f32_e64 v34, v34
    v_smfmac_f32_32x32x32_bf16 v[40:55], v[76:79], v[24:31], v7
    v_exp_f32 v35, v35
    v_exp_f32_e64 v36, v36
    s_mov_b64 exec, s[62:63]
    ds_read_b128 v[64:67], v2 offset:54272
    ds_read_b128 v[68:71], v2 offset:54016
    s_mov_b64 exec, -1
    v_exp_f32 v37, v37
    v_exp_f32_e64 v38, v38
    s_waitcnt lgkmcnt(3)
    s_add_u32 s74, s43, 0
    s_and_b32 s74, s74, 7
    s_mul_i32 s74, s74, s71
    s_lshl_b32 s74, s74, 2
    s_add_u32 s74, s74, s55
    s_add_u32 m0, s53, 32768
    s_nop 0
    s_nop 0
    buffer_load_dwordx4 v6, s[20:23], s74 offen lds
    s_add_u32 m0, s53, 33792
    s_add_u32 s74, s74, s71
    s_nop 0
    buffer_load_dwordx4 v6, s[20:23], s74 offen lds
    s_add_u32 m0, s53, 34816
    s_add_u32 s74, s74, s71
    s_nop 0
    buffer_load_dwordx4 v6, s[20:23], s74 offen lds
    s_add_u32 m0, s53, 35840
    s_add_u32 s74, s74, s71
    s_nop 0
    buffer_load_dwordx4 v6, s[20:23], s74 offen lds
    v_exp_f32 v39, v39
    v_exp_f32 v8, v8
    v_exp_f32_e64 v9, v9
    v_smfmac_f32_32x32x32_bf16 v[40:55], v[80:83], v[32:39], v7
    v_exp_f32 v10, v10
    v_exp_f32 v11, v11
    v_exp_f32 v12, v12
    s_waitcnt lgkmcnt(0)
    v_exp_f32_e64 v13, v13
    v_mfma_f32_32x32x16_bf16 v[24:39], v[72:75], v[56:59], 0
    v_exp_f32 v14, v14
    s_waitcnt vmcnt(10)
    ds_read_b64_tr_b16 v[228:229], v5 offset:0
    ds_read_b64_tr_b16 v[230:231], v5 offset:256
    ds_read_b64_tr_b16 v[232:233], v5 offset:1024
    ds_read_b64_tr_b16 v[234:235], v5 offset:1280
    v_exp_f32_e64 v15, v15
    ds_read_b128 v[60:63], v2 offset:57344
    v_exp_f32 v16, v16
    v_exp_f32 v17, v17
    v_exp_f32_e64 v18, v18
    v_smfmac_f32_32x32x32_bf16 v[40:55], v[64:67], v[8:15], v7
    v_exp_f32 v19, v19
    v_exp_f32_e64 v20, v20
    s_mov_b64 exec, s[62:63]
    ds_read_b128 v[76:79], v2 offset:56320
    ds_read_b128 v[80:83], v2 offset:56064
    s_mov_b64 exec, -1
    v_exp_f32 v21, v21
    v_exp_f32_e64 v22, v22
    ds_read_b64_tr_b16 v[236:237], v5 offset:2048
    ds_read_b64_tr_b16 v[238:239], v5 offset:2304
    ds_read_b64_tr_b16 v[240:241], v5 offset:3072
    ds_read_b64_tr_b16 v[242:243], v5 offset:3328
    v_exp_f32 v23, v23
    v_exp_f32 v24, v24
    v_exp_f32_e64 v25, v25
    v_smfmac_f32_32x32x32_bf16 v[40:55], v[68:71], v[16:23], v7
    v_exp_f32 v26, v26
    s_waitcnt lgkmcnt(0)
    s_add_u32 m0, s53, 131072
    s_add_u32 s59, s54, 131072
    buffer_load_dwordx4 v3, s[16:19], s59 offen lds
    v_exp_f32 v27, v27
    v_exp_f32 v28, v28
    v_exp_f32_e64 v29, v29
    v_mfma_f32_32x32x16_bf16 v[8:23], v[60:63], v[56:59], 0
    v_exp_f32_e64 v30, v30
    s_add_u32 m0, s53, 132096
    s_add_u32 s59, s54, 147456
    buffer_load_dwordx4 v3, s[16:19], s59 offen lds
    v_exp_f32_e64 v31, v31
    ds_read_b128 v[72:75], v2 offset:59392
    v_exp_f32 v32, v32
    v_exp_f32 v33, v33
    v_exp_f32_e64 v34, v34
    v_smfmac_f32_32x32x32_bf16 v[40:55], v[76:79], v[24:31], v7
    s_add_u32 m0, s53, 133120
    s_add_u32 s59, s54, 163840
    buffer_load_dwordx4 v3, s[16:19], s59 offen lds
    v_exp_f32 v35, v35
    v_exp_f32_e64 v36, v36
    s_mov_b64 exec, s[62:63]
    ds_read_b128 v[64:67], v2 offset:58368
    ds_read_b128 v[68:71], v2 offset:58112
    s_mov_b64 exec, -1
    v_exp_f32 v37, v37
    v_exp_f32_e64 v38, v38
    s_add_u32 m0, s53, 134144
    s_add_u32 s59, s54, 180224
    buffer_load_dwordx4 v3, s[16:19], s59 offen lds
    v_exp_f32 v39, v39
    s_setprio 1
    v_exp_f32 v8, v8
    v_exp_f32 v9, v9
    v_smfmac_f32_32x32x32_bf16 v[40:55], v[80:83], v[32:39], v7
    v_exp_f32 v10, v10
    v_exp_f32 v11, v11
    v_exp_f32 v12, v12
    s_waitcnt lgkmcnt(0)
    v_exp_f32_e64 v13, v13
    v_mfma_f32_32x32x16_bf16 v[24:39], v[72:75], v[56:59], 0
    v_exp_f32 v14, v14
    v_exp_f32 v15, v15
    ds_read_b128 v[60:63], v2 offset:61440
    v_exp_f32 v16, v16
    v_exp_f32 v17, v17
    v_exp_f32_e64 v18, v18
    v_smfmac_f32_32x32x32_bf16 v[40:55], v[64:67], v[8:15], v7
    v_exp_f32 v19, v19
    v_exp_f32_e64 v20, v20
    s_mov_b64 exec, s[62:63]
    ds_read_b128 v[76:79], v2 offset:60416
    ds_read_b128 v[80:83], v2 offset:60160
    s_mov_b64 exec, -1
    v_exp_f32 v21, v21
    v_exp_f32 v22, v22
    s_and_b32 s59, s47, 1
    s_lshl_b32 s59, s59, 1
    s_add_u32 s59, s59, s45
    s_sub_u32 s59, s59, 1
    s_cmp_lt_u32 s59, 32
    s_cselect_b32 s59, s59, s45
    s_lshl_b32 s59, s59, 7
    s_add_u32 s59, s59, 0xe01000
    s_lshl_b32 s60, s45, 7
    s_nop 0
    s_add_u32 s60, s60, 0xe01000
    v_and_b32 v253, 7, v0
    v_lshlrev_b32 v253, 2, v253
    buffer_load_dword v254, v253, s[28:31], s60 offen sc1
    buffer_load_dword v255, v253, s[28:31], s59 offen sc1
    v_exp_f32 v23, v23
    v_exp_f32 v24, v24
    v_exp_f32_e64 v25, v25
    v_smfmac_f32_32x32x32_bf16 v[40:55], v[68:71], v[16:23], v7
    v_exp_f32 v26, v26
    v_exp_f32 v27, v27
    v_exp_f32 v28, v28
    s_waitcnt lgkmcnt(0)
    v_exp_f32_e64 v29, v29
    v_mfma_f32_32x32x16_bf16 v[8:23], v[60:63], v[56:59], 0
    v_exp_f32 v30, v30
    v_exp_f32 v31, v31
    ds_read_b128 v[72:75], v2 offset:63488
    v_exp_f32 v32, v32
    v_exp_f32 v33, v33
    v_exp_f32_e64 v34, v34
    v_smfmac_f32_32x32x32_bf16 v[40:55], v[76:79], v[24:31], v7
    v_exp_f32 v35, v35
    v_exp_f32_e64 v36, v36
    s_mov_b64 exec, s[62:63]
    ds_read_b128 v[64:67], v2 offset:62464
    ds_read_b128 v[68:71], v2 offset:62208
    s_mov_b64 exec, -1
    v_exp_f32 v37, v37
    v_exp_f32 v38, v38
    v_exp_f32 v39, v39
    v_exp_f32 v8, v8
    v_exp_f32 v9, v9
    v_smfmac_f32_32x32x32_bf16 v[40:55], v[80:83], v[32:39], v7
    v_exp_f32 v10, v10
    v_exp_f32 v11, v11
    v_exp_f32 v12, v12
    s_waitcnt lgkmcnt(0)
    v_exp_f32_e64 v13, v13
    v_mfma_f32_32x32x16_bf16 v[24:39], v[72:75], v[56:59], 0
    v_exp_f32 v14, v14
    v_exp_f32 v15, v15
    v_exp_f32 v16, v16
    v_exp_f32 v17, v17
    v_exp_f32_e64 v18, v18
    v_smfmac_f32_32x32x32_bf16 v[40:55], v[64:67], v[8:15], v7
    v_exp_f32 v19, v19
    v_exp_f32_e64 v20, v20
    s_mov_b64 exec, s[62:63]
    ds_read_b128 v[76:79], v2 offset:64512
    ds_read_b128 v[80:83], v2 offset:64256
    s_mov_b64 exec, -1
    v_exp_f32 v21, v21
    v_exp_f32 v22, v22
    v_exp_f32 v23, v23
    s_setprio 0
    v_exp_f32 v24, v24
    v_exp_f32_e64 v25, v25
    v_smfmac_f32_32x32x32_bf16 v[40:55], v[68:71], v[16:23], v7
    v_exp_f32 v26, v26
    v_exp_f32 v27, v27
    v_exp_f32 v28, v28
    s_waitcnt lgkmcnt(0)
    v_exp_f32 v29, v29
    v_exp_f32 v30, v30
    v_exp_f32 v31, v31
    v_exp_f32 v32, v32
    v_exp_f32 v33, v33
    v_exp_f32 v34, v34
    v_smfmac_f32_32x32x32_bf16 v[40:55], v[76:79], v[24:31], v7
    v_exp_f32 v35, v35
    v_exp_f32 v36, v36
    v_exp_f32 v37, v37
    v_exp_f32 v38, v38
    v_exp_f32 v39, v39
    s_nop 1
    v_smfmac_f32_32x32x32_bf16 v[40:55], v[80:83], v[32:39], v7
    s_mov_b32 s67, 0
    s_branch L_stat2
L_stat:
    s_and_b32 s59, s47, 1
    s_lshl_b32 s59, s59, 1
    s_add_u32 s59, s59, s45
    s_sub_u32 s59, s59, 1
    s_cmp_lt_u32 s59, 32
    s_cselect_b32 s59, s59, s45
    s_lshl_b32 s59, s59, 7
    s_nop 0
    s_add_u32 s59, s59, 0xe01000
    s_lshl_b32 s60, s45, 7
    s_nop 0
    s_add_u32 s60, s60, 0xe01000
    v_and_b32 v253, 7, v0
    v_lshlrev_b32 v253, 2, v253
    buffer_load_dword v254, v253, s[28:31], s60 offen sc1
    buffer_load_dword v255, v253, s[28:31], s59 offen sc1
L_stat2:
    s_add_u32 s67, s67, 1
    s_waitcnt vmcnt(0)
    v_xor_b32 v254, s66, v254
    v_xor_b32 v255, s66, v255
    v_or_b32_e64 v255, v254, v255
    v_cmp_lt_u32 vcc, 7, v255
    s_cbranch_vccz L_stat_ok
    s_cmp_lt_u32 s67, 1000000
    s_cbranch_scc1 L_stat
L_stat_ok:
    v_cmp_ne_u32 vcc, 0, v254
    s_cmp_eq_u64 vcc, 0
    s_cselect_b32 s64, 1, 0
    v_cmp_ne_u32 vcc, 0, v255
    s_cmp_eq_u64 vcc, 0
    s_cselect_b32 s65, 1, 0
    s_nop 0
    s_mov_b32 s59, 0x1f800000
    s_mov_b32 s60, 0x5f800000
    v_cmp_nge_f32 vcc, v40, s59
    s_cbranch_vccnz L_slow
    s_nop 0
    v_cmp_nle_f32 vcc, v40, s60
    s_cbranch_vccnz L_slow
L_attn_done:
    v_rcp_f32 v252, v40
    s_nop 0
    v_mul_f32 v48, v48, v252
    v_mul_f32 v49, v49, v252
    v_mul_f32 v50, v50, v252
    v_mul_f32 v51, v51, v252
    v_mul_f32 v52, v52, v252
    v_mul_f32 v53, v53, v252
    v_mul_f32 v54, v54, v252
    v_mul_f32_e64 v55, v55, v252
    v_cvt_pk_bf16_f32 v56, v48, v49
    v_cvt_pk_bf16_f32 v57, v50, v51
    v_cvt_pk_bf16_f32 v58, v52, v53
    v_cvt_pk_bf16_f32 v59, v54, v55
    v_min_u32_e64 v56, -2, v56
    s_cmp_eq_u32 s64, 1
    s_cbranch_scc1 Lp_1
    buffer_store_dwordx4 v[56:59], v1, s[28:31], s68 offen offset:0 sc1
    s_branch Lq_2
Lp_1:
    s_nop 0
    buffer_store_dwordx4 v[56:59], v1, s[28:31], s68 offen offset:0
Lq_2:
    s_barrier
    s_nop 0
    v_mov_b32 v7, 0x3f803f80
    s_cmp_lg_u32 s51, 0
    s_cbranch_scc1 L_fin
    v_add_u32_e64 v82, s53, v2
    ds_read_b64_tr_b16 v[24:25], v5 offset:0
    ds_read_b64_tr_b16 v[26:27], v5 offset:256
    ds_read_b64_tr_b16 v[28:29], v5 offset:1024
    ds_read_b64_tr_b16 v[30:31], v5 offset:1280
    ds_read_b64_tr_b16 v[32:33], v5 offset:2048
    ds_read_b64_tr_b16 v[34:35], v5 offset:2304
    ds_read_b64_tr_b16 v[36:37], v5 offset:3072
    ds_read_b64_tr_b16 v[38:39], v5 offset:3328
    ds_read_b64_tr_b16 v[40:41], v4 offset:0
    ds_read_b64_tr_b16 v[42:43], v4 offset:256
    ds_read_b64_tr_b16 v[44:45], v4 offset:1024
    ds_read_b64_tr_b16 v[46:47], v4 offset:1280
    ds_read_b64_tr_b16 v[48:49], v4 offset:2048
    ds_read_b64_tr_b16 v[50:51], v4 offset:2304
    ds_read_b64_tr_b16 v[52:53], v4 offset:3072
    ds_read_b64_tr_b16 v[54:55], v4 offset:3328
    v_dot2_f32_bf16 v83, v148, v7, 0
    v_dot2_f32_bf16 v83, v149, v7, v83
    v_dot2_f32_bf16 v83, v150, v7, v83
    v_dot2_f32_bf16 v83, v151, v7, v83
    v_dot2_f32_bf16 v83, v152, v7, v83
    v_dot2_f32_bf16 v83, v153, v7, v83
    v_dot2_f32_bf16 v83, v154, v7, v83
    v_dot2_f32_bf16 v83, v155, v7, v83
    v_dot2_f32_bf16 v83, v156, v7, v83
    v_dot2_f32_bf16 v83, v157, v7, v83
    v_dot2_f32_bf16 v83, v158, v7, v83
    v_dot2_f32_bf16 v83, v159, v7, v83
    v_dot2_f32_bf16 v83, v160, v7, v83
    v_dot2_f32_bf16 v83, v161, v7, v83
    v_dot2_f32_bf16 v83, v162, v7, v83
    v_dot2_f32_bf16 v83, v163, v7, v83
    v_dot2_f32_bf16 v83, v164, v7, v83
    v_dot2_f32_bf16 v83, v165, v7, v83
    v_dot2_f32_bf16 v83, v166, v7, v83
    v_dot2_f32_bf16 v83, v167, v7, v83
    v_dot2_f32_bf16 v83, v168, v7, v83
    v_dot2_f32_bf16 v83, v169, v7, v83
    v_dot2_f32_bf16 v83, v170, v7, v83
    v_dot2_f32_bf16 v83, v171, v7, v83
    v_dot2_f32_bf16 v83, v172, v7, v83
    v_dot2_f32_bf16 v83, v173, v7, v83
    v_dot2_f32_bf16 v83, v174, v7, v83
    v_dot2_f32_bf16 v83, v175, v7, v83
    v_dot2_f32_bf16 v83, v176, v7, v83
    v_dot2_f32_bf16 v83, v177, v7, v83
    v_dot2_f32_bf16 v83, v178, v7, v83
    v_dot2_f32_bf16 v83, v179, v7, v83
    v_dot2_f32_bf16 v83, v180, v7, v83
    v_dot2_f32_bf16 v83, v181, v7, v83
    v_dot2_f32_bf16 v83, v182, v7, v83
    v_dot2_f32_bf16 v83, v183, v7, v83
    v_dot2_f32_bf16 v83, v184, v7, v83
    v_dot2_f32_bf16 v83, v185, v7, v83
    v_dot2_f32_bf16 v83, v186, v7, v83
    v_dot2_f32_bf16 v83, v187, v7, v83
    v_dot2_f32_bf16 v83, v188, v7, v83
    v_dot2_f32_bf16 v83, v189, v7, v83
    v_dot2_f32_bf16 v83, v190, v7, v83
    v_dot2_f32_bf16 v83, v191, v7, v83
    v_dot2_f32_bf16 v83, v192, v7, v83
    v_dot2_f32_bf16 v83, v193, v7, v83
    v_dot2_f32_bf16 v83, v194, v7, v83
    v_dot2_f32_bf16 v83, v195, v7, v83
    v_dot2_f32_bf16 v83, v196, v7, v83
    v_dot2_f32_bf16 v83, v197, v7, v83
    v_dot2_f32_bf16 v83, v198, v7, v83
    v_dot2_f32_bf16 v83, v199, v7, v83
    v_dot2_f32_bf16 v83, v200, v7, v83
    v_dot2_f32_bf16 v83, v201, v7, v83
    v_dot2_f32_bf16 v83, v202, v7, v83
    v_dot2_f32_bf16 v83, v203, v7, v83
    v_dot2_f32_bf16 v83, v204, v7, v83
    v_dot2_f32_bf16 v83, v205, v7, v83
    v_dot2_f32_bf16 v83, v206, v7, v83
    v_dot2_f32_bf16 v83, v207, v7, v83
    v_dot2_f32_bf16 v83, v208, v7, v83
    v_dot2_f32_bf16 v83, v209, v7, v83
    v_dot2_f32_bf16 v83, v210, v7, v83
    v_dot2_f32_bf16 v83, v211, v7, v83
    s_waitcnt lgkmcnt(0)
    s_setprio 3
    s_barrier
    s_nop 0
    ds_read_b128 v[56:59], v2 offset:0
    ds_read_b128 v[60:63], v2 offset:1024
    ds_read_b128 v[64:67], v2 offset:2048
    ds_read_b128 v[68:71], v2 offset:3072
    ds_read_b128 v[72:75], v2 offset:4096
    ds_read_b128 v[76:79], v2 offset:5120
    s_waitcnt lgkmcnt(5)
    s_nop 0
    v_mfma_f32_32x32x16_bf16 v[8:23], v[84:87], v[56:59], 0
    ds_read_b128 v[56:59], v2 offset:6144
    s_waitcnt lgkmcnt(5)
    s_nop 0
    v_mfma_f32_32x32x16_bf16 v[8:23], v[88:91], v[60:63], v[8:23]
    ds_read_b128 v[60:63], v2 offset:7168
    s_waitcnt lgkmcnt(5)
    s_nop 0
    v_mfma_f32_32x32x16_bf16 v[8:23], v[92:95], v[64:67], v[8:23]
    ds_read_b128 v[64:67], v2 offset:8192
    s_waitcnt lgkmcnt(5)
    s_nop 0
    v_mfma_f32_32x32x16_bf16 v[8:23], v[96:99], v[68:71], v[8:23]
    ds_read_b128 v[68:71], v2 offset:9216
    s_waitcnt lgkmcnt(5)
    s_nop 0
    v_mfma_f32_32x32x16_bf16 v[8:23], v[100:103], v[72:75], v[8:23]
    ds_read_b128 v[72:75], v2 offset:10240
    s_waitcnt lgkmcnt(5)
    s_nop 0
    v_mfma_f32_32x32x16_bf16 v[8:23], v[104:107], v[76:79], v[8:23]
    ds_read_b128 v[76:79], v2 offset:11264
    s_waitcnt lgkmcnt(5)
    s_nop 0
    v_mfma_f32_32x32x16_bf16 v[8:23], v[108:111], v[56:59], v[8:23]
    ds_read_b128 v[56:59], v2 offset:12288
    s_waitcnt lgkmcnt(5)
    s_nop 0
    v_mfma_f32_32x32x16_bf16 v[8:23], v[112:115], v[60:63], v[8:23]
    ds_read_b128 v[60:63], v2 offset:13312
    s_waitcnt lgkmcnt(5)
    s_nop 0
    v_mfma_f32_32x32x16_bf16 v[8:23], v[116:119], v[64:67], v[8:23]
    ds_read_b128 v[64:67], v2 offset:14336
    s_waitcnt lgkmcnt(5)
    s_nop 0
    v_mfma_f32_32x32x16_bf16 v[8:23], v[120:123], v[68:71], v[8:23]
    ds_read_b128 v[68:71], v2 offset:15360
    s_waitcnt lgkmcnt(5)
    s_nop 0
    v_mfma_f32_32x32x16_bf16 v[8:23], v[124:127], v[72:75], v[8:23]
    s_waitcnt lgkmcnt(4)
    s_nop 0
    v_mfma_f32_32x32x16_bf16 v[8:23], v[128:131], v[76:79], v[8:23]
    s_waitcnt lgkmcnt(3)
    s_nop 0
    v_mfma_f32_32x32x16_bf16 v[8:23], v[132:135], v[56:59], v[8:23]
    s_waitcnt lgkmcnt(2)
    s_nop 0
    v_mfma_f32_32x32x16_bf16 v[8:23], v[136:139], v[60:63], v[8:23]
    s_waitcnt lgkmcnt(1)
    s_nop 0
    v_mfma_f32_32x32x16_bf16 v[8:23], v[140:143], v[64:67], v[8:23]
    s_waitcnt lgkmcnt(0)
    s_nop 0
    v_mfma_f32_32x32x16_bf16 v[8:23], v[144:147], v[68:71], v[8:23]
    s_nop 11
    s_nop 0
    ds_write_b128 v82, v[8:11] offset:32768
    ds_write_b128 v82, v[12:15] offset:33792
    ds_write_b128 v82, v[16:19] offset:34816
    ds_write_b128 v82, v[20:23] offset:35840
    s_setprio 0
    s_add_u32 s74, s43, 1
    s_and_b32 s74, s74, 7
    s_mul_i32 s74, s74, s71
    s_lshl_b32 s74, s74, 2
    s_add_u32 s74, s74, s55
    s_add_u32 m0, s53, 131072
    s_nop 0
    s_nop 0
    buffer_load_dwordx4 v6, s[20:23], s74 offen lds
    s_add_u32 m0, s53, 132096
    s_add_u32 s74, s74, s71
    s_nop 0
    buffer_load_dwordx4 v6, s[20:23], s74 offen lds
    s_add_u32 m0, s53, 133120
    s_add_u32 s74, s74, s71
    s_nop 0
    buffer_load_dwordx4 v6, s[20:23], s74 offen lds
    s_add_u32 m0, s53, 134144
    s_add_u32 s74, s74, s71
    s_nop 0
    buffer_load_dwordx4 v6, s[20:23], s74 offen lds
    s_waitcnt lgkmcnt(0)
    s_barrier
    s_add_u32 s74, s43, 2
    s_and_b32 s74, s74, 7
    s_mul_i32 s74, s74, s71
    s_lshl_b32 s74, s74, 2
    s_add_u32 s74, s74, s55
    s_add_u32 m0, s53, 0
    s_nop 0
    s_nop 0
    buffer_load_dwordx4 v6, s[20:23], s74 offen lds
    s_add_u32 m0, s53, 1024
    s_add_u32 s74, s74, s71
    s_nop 0
    buffer_load_dwordx4 v6, s[20:23], s74 offen lds
    s_add_u32 m0, s53, 2048
    s_add_u32 s74, s74, s71
    s_nop 0
    buffer_load_dwordx4 v6, s[20:23], s74 offen lds
    s_add_u32 m0, s53, 3072
    s_add_u32 s74, s74, s71
    s_nop 0
    buffer_load_dwordx4 v6, s[20:23], s74 offen lds
    ds_read_b64_tr_b16 v[132:133], v4 offset:32768
    ds_read_b64_tr_b16 v[134:135], v4 offset:33024
    ds_read_b64_tr_b16 v[136:137], v4 offset:33792
    ds_read_b64_tr_b16 v[138:139], v4 offset:34048
    ds_read_b64_tr_b16 v[140:141], v4 offset:34816
    ds_read_b64_tr_b16 v[142:143], v4 offset:35072
    ds_read_b64_tr_b16 v[144:145], v4 offset:35840
    ds_read_b64_tr_b16 v[146:147], v4 offset:36096
    s_waitcnt lgkmcnt(0)
    s_lshl_b32 s59, s50, 8
    s_add_u32 s59, s59, 114688
    v_lshlrev_b32 v253, 2, v0
    v_add_u32 v253, s59, v253
    ds_read_b32 v254, v253
    s_waitcnt lgkmcnt(0)
    v_add_f32 v83, v83, v254
    v_mov_b32_e64 v254, v83
    s_add_u32 s59, s53, 32768
    s_nop 0
    v_permlane32_swap_b32 v83, v254
    v_lshlrev_b32 v253, 2, v0
    v_add_f32 v83, v83, v254
    v_add_u32_e64 v253, s59, v253
    ds_write_b32 v253, v83
    v_lshrrev_b32 v253, 5, v0
    v_lshlrev_b32 v253, 4, v253
    v_add_u32 v253, s59, v253
    s_waitcnt lgkmcnt(0)
    ds_read_b128 v[116:119], v253 offset:0
    ds_read_b128 v[120:123], v253 offset:32
    ds_read_b128 v[124:127], v253 offset:64
    ds_read_b128 v[128:131], v253 offset:96
    s_waitcnt lgkmcnt(0)
    s_lshl_b32 s54, s47, 12
    s_lshl_b32 s59, s50, 10
    s_add_u32 s54, s54, s59
    s_add_u32 s54, s54, 0xd00000
    v_dot2_f32_bf16 v83, v132, v7, 0
    v_dot2_f32_bf16 v83, v133, v7, v83
    v_dot2_f32_bf16 v83, v134, v7, v83
    v_dot2_f32_bf16 v83, v135, v7, v83
    v_dot2_f32_bf16 v83, v136, v7, v83
    v_dot2_f32_bf16 v83, v137, v7, v83
    v_dot2_f32_bf16 v83, v138, v7, v83
    v_dot2_f32_bf16 v83, v139, v7, v83
    v_dot2_f32_bf16 v83, v140, v7, v83
    v_dot2_f32_bf16 v83, v141, v7, v83
    v_dot2_f32_bf16 v83, v142, v7, v83
    v_dot2_f32_bf16 v83, v143, v7, v83
    v_dot2_f32_bf16 v83, v144, v7, v83
    v_dot2_f32_bf16 v83, v145, v7, v83
    v_dot2_f32_bf16 v83, v146, v7, v83
    v_dot2_f32_bf16 v83, v147, v7, v83
    buffer_load_dwordx4 v[56:59], v1, s[28:31], s54 offen offset:0 sc1
    s_mov_b32 s67, 0
    s_waitcnt vmcnt(0)
    s_branch Lf_5
Lw_3:
    s_nop 0
    buffer_load_dwordx4 v[56:59], v1, s[28:31], s54 offen offset:0 sc1
    s_add_u32 s67, s67, 1
    s_waitcnt vmcnt(0)
Lf_5:
    v_max_u32_e64 v252, v56, v57
    v_max3_u32 v252, v252, v58, v59
    v_cmp_eq_u32 vcc, -1, v252
    s_cbranch_vccz Lg_4
    s_cmp_lt_u32 s67, 1000000
    s_cbranch_scc1 Lw_3
Lg_4:
    v_add_f32 v56, v56, v57
    v_add_f32 v58, v58, v59
    s_lshl_b32 s59, s50, 2
    v_add_f32 v56, v56, v58
    v_add_u32 v57, s59, v2
    ds_write_b32 v57, v56 offset:61440
    s_mul_i32 s59, s46, 7
    s_min_u32 s60, s49, 6
    s_add_u32 s59, s59, s60
    s_lshl_b32 s59, s59, 11
    s_add_u32 s59, s59, 0xe40000
    v_mov_b32 v254, v83
    s_lshl_b32 s60, s43, 8
    s_add_u32 s59, s59, s60
    v_permlane32_swap_b32 v83, v254
    v_lshlrev_b32 v253, 3, v0
    v_add_f32 v254, v83, v254
    v_mov_b32_e64 v255, s40
    s_mov_b32 exec_lo, s72
    s_mov_b32 exec_hi, 0
    buffer_store_dwordx2 v[254:255], v253, s[28:31], s59 offen sc1
    s_mov_b64 exec, -1
    s_waitcnt lgkmcnt(0)
    ds_read_b64_tr_b16 v[84:85], v5 offset:0
    ds_read_b64_tr_b16 v[86:87], v5 offset:256
    ds_read_b64_tr_b16 v[88:89], v5 offset:1024
    ds_read_b64_tr_b16 v[90:91], v5 offset:1280
    ds_read_b64_tr_b16 v[92:93], v5 offset:2048
    ds_read_b64_tr_b16 v[94:95], v5 offset:2304
    ds_read_b64_tr_b16 v[96:97], v5 offset:3072
    ds_read_b64_tr_b16 v[98:99], v5 offset:3328
    ds_read_b64_tr_b16 v[100:101], v4 offset:0
    ds_read_b64_tr_b16 v[102:103], v4 offset:256
    ds_read_b64_tr_b16 v[104:105], v4 offset:1024
    ds_read_b64_tr_b16 v[106:107], v4 offset:1280
    ds_read_b64_tr_b16 v[108:109], v4 offset:2048
    ds_read_b64_tr_b16 v[110:111], v4 offset:2304
    ds_read_b64_tr_b16 v[112:113], v4 offset:3072
    ds_read_b64_tr_b16 v[114:115], v4 offset:3328
    s_waitcnt lgkmcnt(0)
    s_setprio 3
    s_barrier
    s_nop 0
    ds_read_b128 v[56:59], v2 offset:0
    ds_read_b128 v[60:63], v2 offset:1024
    ds_read_b128 v[64:67], v2 offset:2048
    ds_read_b128 v[68:71], v2 offset:3072
    ds_read_b128 v[72:75], v2 offset:4096
    ds_read_b128 v[76:79], v2 offset:5120
    s_waitcnt lgkmcnt(5)
    s_nop 0
    v_mfma_f32_32x32x16_bf16 v[8:23], v[148:151], v[56:59], 0
    ds_read_b128 v[56:59], v2 offset:6144
    s_waitcnt lgkmcnt(5)
    s_nop 0
    v_mfma_f32_32x32x16_bf16 v[8:23], v[152:155], v[60:63], v[8:23]
    ds_read_b128 v[60:63], v2 offset:7168
    s_waitcnt lgkmcnt(5)
    s_nop 0
    v_mfma_f32_32x32x16_bf16 v[8:23], v[156:159], v[64:67], v[8:23]
    ds_read_b128 v[64:67], v2 offset:8192
    s_waitcnt lgkmcnt(5)
    s_nop 0
    v_mfma_f32_32x32x16_bf16 v[8:23], v[160:163], v[68:71], v[8:23]
    ds_read_b128 v[68:71], v2 offset:9216
    s_waitcnt lgkmcnt(5)
    s_nop 0
    v_mfma_f32_32x32x16_bf16 v[8:23], v[164:167], v[72:75], v[8:23]
    ds_read_b128 v[72:75], v2 offset:10240
    s_waitcnt lgkmcnt(5)
    s_nop 0
    v_mfma_f32_32x32x16_bf16 v[8:23], v[168:171], v[76:79], v[8:23]
    ds_read_b128 v[76:79], v2 offset:11264
    s_waitcnt lgkmcnt(5)
    s_nop 0
    v_mfma_f32_32x32x16_bf16 v[8:23], v[172:175], v[56:59], v[8:23]
    ds_read_b128 v[248:251], v2 offset:61440
    ds_read_b128 v[56:59], v2 offset:12288
    s_waitcnt lgkmcnt(6)
    s_nop 0
    v_mfma_f32_32x32x16_bf16 v[8:23], v[176:179], v[60:63], v[8:23]
    ds_read_b128 v[60:63], v2 offset:13312
    s_waitcnt lgkmcnt(6)
    s_nop 0
    v_mfma_f32_32x32x16_bf16 v[8:23], v[180:183], v[64:67], v[8:23]
    s_waitcnt lgkmcnt(2)
    v_add_f32 v248, v248, v249
    v_add_f32 v250, v250, v251
    v_add_f32 v248, v248, v250
    v_mul_f32 v248, 0x3b000000, v248
    v_mov_b32_e64 v249, v248
    ds_read_b128 v[64:67], v2 offset:14336
    v_mfma_f32_32x32x16_bf16 v[8:23], v[184:187], v[68:71], v[8:23]
    s_nop 1
    v_permlane32_swap_b32 v248, v249
    v_mov_b32_e64 v247, v248
    v_fma_f32 v249, -v248, v248, v249
    ds_read_b128 v[68:71], v2 offset:15360
    v_mfma_f32_32x32x16_bf16 v[8:23], v[188:191], v[72:75], v[8:23]
    v_max_f32_e64 v249, 0, v249
    v_add_f32 v250, 0x3727c5ac, v249
    v_rsq_f32 v250, v250
    s_nop 0
    v_mfma_f32_32x32x16_bf16 v[8:23], v[192:195], v[76:79], v[8:23]
    v_rcp_f32_e64 v246, v250
    v_mul_f32 v244, 0xc0135761, v250
    v_mul_f32 v249, v250, v250
    v_mul_f32 v249, v249, v250
    v_mul_f32 v245, 0xbdd2d3e8, v249
    s_waitcnt lgkmcnt(3)
    s_nop 0
    v_mfma_f32_32x32x16_bf16 v[8:23], v[196:199], v[56:59], v[8:23]
    s_waitcnt lgkmcnt(2)
    s_nop 0
    v_mfma_f32_32x32x16_bf16 v[8:23], v[200:203], v[60:63], v[8:23]
    s_waitcnt lgkmcnt(1)
    s_nop 0
    v_mfma_f32_32x32x16_bf16 v[8:23], v[204:207], v[64:67], v[8:23]
    s_waitcnt lgkmcnt(0)
    s_nop 0
    v_mfma_f32_32x32x16_bf16 v[8:23], v[208:211], v[68:71], v[8:23]
    s_nop 11
    s_nop 0
    v_fma_f32 v8, -v247, v116, v8
    v_fma_f32 v9, -v247, v117, v9
    v_fma_f32 v10, -v247, v118, v10
    v_fma_f32 v11, -v247, v119, v11
    v_fma_f32 v12, -v247, v120, v12
    v_fma_f32 v13, -v247, v121, v13
    v_fma_f32 v14, -v247, v122, v14
    v_fma_f32 v15, -v247, v123, v15
    v_fma_f32 v16, -v247, v124, v16
    v_fma_f32 v17, -v247, v125, v17
    v_fma_f32 v18, -v247, v126, v18
    v_fma_f32 v19, -v247, v127, v19
    v_fma_f32 v20, -v247, v128, v20
    v_fma_f32 v21, -v247, v129, v21
    v_fma_f32 v22, -v247, v130, v22
    v_fma_f32 v23, -v247, v131, v23
    ds_write_b128 v82, v[8:11] offset:32768
    ds_write_b128 v82, v[12:15] offset:33792
    ds_write_b128 v82, v[16:19] offset:34816
    ds_write_b128 v82, v[20:23] offset:35840
    s_setprio 0
    s_add_u32 s74, s43, 3
    s_and_b32 s74, s74, 7
    s_mul_i32 s74, s74, s71
    s_lshl_b32 s74, s74, 2
    s_add_u32 s74, s74, s55
    s_add_u32 m0, s53, 131072
    s_nop 0
    s_nop 0
    buffer_load_dwordx4 v6, s[20:23], s74 offen lds
    s_add_u32 m0, s53, 132096
    s_add_u32 s74, s74, s71
    s_nop 0
    buffer_load_dwordx4 v6, s[20:23], s74 offen lds
    s_add_u32 m0, s53, 133120
    s_add_u32 s74, s74, s71
    s_nop 0
    buffer_load_dwordx4 v6, s[20:23], s74 offen lds
    s_add_u32 m0, s53, 134144
    s_add_u32 s74, s74, s71
    s_nop 0
    buffer_load_dwordx4 v6, s[20:23], s74 offen lds
    s_waitcnt lgkmcnt(0)
    s_barrier
    s_add_u32 s74, s43, 4
    s_and_b32 s74, s74, 7
    s_mul_i32 s74, s74, s71
    s_lshl_b32 s74, s74, 2
    s_add_u32 s74, s74, s55
    s_add_u32 m0, s53, 0
    s_nop 0
    s_nop 0
    buffer_load_dwordx4 v6, s[20:23], s74 offen lds
    s_add_u32 m0, s53, 1024
    s_add_u32 s74, s74, s71
    s_nop 0
    buffer_load_dwordx4 v6, s[20:23], s74 offen lds
    s_add_u32 m0, s53, 2048
    s_add_u32 s74, s74, s71
    s_nop 0
    buffer_load_dwordx4 v6, s[20:23], s74 offen lds
    s_add_u32 m0, s53, 3072
    s_add_u32 s74, s74, s71
    s_nop 0
    buffer_load_dwordx4 v6, s[20:23], s74 offen lds
    s_add_u32 s74, s43, 5
    s_and_b32 s74, s74, 7
    s_mul_i32 s74, s74, s71
    s_lshl_b32 s74, s74, 2
    s_add_u32 s74, s74, s55
    s_nop 0
    s_add_u32 m0, s53, 32768
    s_nop 0
    s_nop 0
    buffer_load_dwordx4 v6, s[20:23], s74 offen lds
    s_add_u32 m0, s53, 33792
    s_add_u32 s74, s74, s71
    s_nop 0
    buffer_load_dwordx4 v6, s[20:23], s74 offen lds
    s_add_u32 m0, s53, 34816
    s_add_u32 s74, s74, s71
    s_nop 0
    buffer_load_dwordx4 v6, s[20:23], s74 offen lds
    s_add_u32 m0, s53, 35840
    s_add_u32 s74, s74, s71
    s_nop 0
    buffer_load_dwordx4 v6, s[20:23], s74 offen lds
    s_waitcnt vmcnt(0)
    s_nop 0
    ds_read_b64_tr_b16 v[148:149], v5 offset:0
    ds_read_b64_tr_b16 v[150:151], v5 offset:256
    ds_read_b64_tr_b16 v[152:153], v5 offset:1024
    ds_read_b64_tr_b16 v[154:155], v5 offset:1280
    ds_read_b64_tr_b16 v[156:157], v5 offset:2048
    ds_read_b64_tr_b16 v[158:159], v5 offset:2304
    ds_read_b64_tr_b16 v[160:161], v5 offset:3072
    ds_read_b64_tr_b16 v[162:163], v5 offset:3328
    ds_read_b64_tr_b16 v[164:165], v4 offset:0
    ds_read_b64_tr_b16 v[166:167], v4 offset:256
    ds_read_b64_tr_b16 v[168:169], v4 offset:1024
    ds_read_b64_tr_b16 v[170:171], v4 offset:1280
    ds_read_b64_tr_b16 v[172:173], v4 offset:2048
    ds_read_b64_tr_b16 v[174:175], v4 offset:2304
    ds_read_b64_tr_b16 v[176:177], v4 offset:3072
    ds_read_b64_tr_b16 v[178:179], v4 offset:3328
    ds_read_b64_tr_b16 v[180:181], v4 offset:32768
    ds_read_b64_tr_b16 v[182:183], v4 offset:33024
    ds_read_b64_tr_b16 v[184:185], v4 offset:33792
    ds_read_b64_tr_b16 v[186:187], v4 offset:34048
    ds_read_b64_tr_b16 v[188:189], v4 offset:34816
    ds_read_b64_tr_b16 v[190:191], v4 offset:35072
    ds_read_b64_tr_b16 v[192:193], v4 offset:35840
    ds_read_b64_tr_b16 v[194:195], v4 offset:36096
    s_waitcnt lgkmcnt(0)
    s_setprio 3
    s_barrier
    s_nop 0
    ds_read_b128 v[56:59], v2 offset:0
    ds_read_b128 v[60:63], v2 offset:1024
    ds_read_b128 v[64:67], v2 offset:2048
    ds_read_b128 v[68:71], v2 offset:3072
    ds_read_b128 v[72:75], v2 offset:4096
    s_mul_i32 s59, s46, 7
    s_min_u32 s60, s49, 6
    s_add_u32 s59, s59, s60
    s_lshl_b32 s59, s59, 11
    s_add_u32 s59, s59, 0xe40000
    buffer_load_dwordx4 v[244:247], v1, s[28:31], s59 offen offset:0 sc1
    buffer_load_dwordx4 v[248:251], v1, s[28:31], s59 offen offset:1024 sc1
    ds_read_b128 v[76:79], v2 offset:5120
    s_waitcnt lgkmcnt(5)
    s_nop 0
    v_mfma_f32_32x32x16_bf16 v[8:23], v[212:215], v[56:59], 0
    ds_read_b128 v[56:59], v2 offset:6144
    s_waitcnt lgkmcnt(5)
    s_nop 0
    v_mfma_f32_32x32x16_bf16 v[8:23], v[216:219], v[60:63], v[8:23]
    ds_read_b128 v[60:63], v2 offset:7168
    s_waitcnt lgkmcnt(5)
    s_nop 0
    v_mfma_f32_32x32x16_bf16 v[8:23], v[220:223], v[64:67], v[8:23]
    ds_read_b128 v[64:67], v2 offset:8192
    s_waitcnt lgkmcnt(5)
    s_nop 0
    v_mfma_f32_32x32x16_bf16 v[8:23], v[224:227], v[68:71], v[8:23]
    ds_read_b128 v[68:71], v2 offset:9216
    s_waitcnt lgkmcnt(5)
    s_nop 0
    v_mfma_f32_32x32x16_bf16 v[8:23], v[228:231], v[72:75], v[8:23]
    ds_read_b128 v[72:75], v2 offset:10240
    s_waitcnt lgkmcnt(5)
    s_nop 0
    v_mfma_f32_32x32x16_bf16 v[8:23], v[232:235], v[76:79], v[8:23]
    ds_read_b128 v[76:79], v2 offset:11264
    s_waitcnt lgkmcnt(5)
    s_nop 0
    v_mfma_f32_32x32x16_bf16 v[8:23], v[236:239], v[56:59], v[8:23]
    ds_read_b128 v[56:59], v2 offset:12288
    s_waitcnt lgkmcnt(5)
    s_nop 0
    v_mfma_f32_32x32x16_bf16 v[8:23], v[240:243], v[60:63], v[8:23]
    ds_read_b128 v[60:63], v2 offset:13312
    s_waitcnt lgkmcnt(5)
    s_nop 0
    v_mfma_f32_32x32x16_bf16 v[8:23], v[24:27], v[64:67], v[8:23]
    ds_read_b128 v[64:67], v2 offset:14336
    s_waitcnt lgkmcnt(5)
    s_nop 0
    v_mfma_f32_32x32x16_bf16 v[8:23], v[28:31], v[68:71], v[8:23]
    ds_read_b128 v[68:71], v2 offset:15360
    s_waitcnt lgkmcnt(5)
    s_nop 0
    v_mfma_f32_32x32x16_bf16 v[8:23], v[32:35], v[72:75], v[8:23]
    s_waitcnt lgkmcnt(4)
    s_nop 0
    v_mfma_f32_32x32x16_bf16 v[8:23], v[36:39], v[76:79], v[8:23]
    s_waitcnt lgkmcnt(3)
    s_nop 0
    v_mfma_f32_32x32x16_bf16 v[8:23], v[40:43], v[56:59], v[8:23]
    s_waitcnt lgkmcnt(2)
    s_nop 0
    v_mfma_f32_32x32x16_bf16 v[8:23], v[44:47], v[60:63], v[8:23]
    s_waitcnt lgkmcnt(1)
    s_nop 0
    v_mfma_f32_32x32x16_bf16 v[8:23], v[48:51], v[64:67], v[8:23]
    s_waitcnt lgkmcnt(0)
    s_nop 0
    v_mfma_f32_32x32x16_bf16 v[8:23], v[52:55], v[68:71], v[8:23]
    s_nop 11
    s_nop 0
    ds_write_b128 v82, v[8:11] offset:32768
    ds_write_b128 v82, v[12:15] offset:33792
    ds_write_b128 v82, v[16:19] offset:34816
    ds_write_b128 v82, v[20:23] offset:35840
    s_setprio 0
    s_add_u32 s74, s43, 6
    s_and_b32 s74, s74, 7
    s_mul_i32 s74, s74, s71
    s_lshl_b32 s74, s74, 2
    s_add_u32 s74, s74, s55
    s_add_u32 m0, s53, 131072
    s_nop 0
    s_nop 0
    buffer_load_dwordx4 v6, s[20:23], s74 offen lds
    s_add_u32 m0, s53, 132096
    s_add_u32 s74, s74, s71
    s_nop 0
    buffer_load_dwordx4 v6, s[20:23], s74 offen lds
    s_add_u32 m0, s53, 133120
    s_add_u32 s74, s74, s71
    s_nop 0
    buffer_load_dwordx4 v6, s[20:23], s74 offen lds
    s_add_u32 m0, s53, 134144
    s_add_u32 s74, s74, s71
    s_nop 0
    buffer_load_dwordx4 v6, s[20:23], s74 offen lds
    s_waitcnt lgkmcnt(0)
    s_barrier
    s_add_u32 s74, s43, 7
    s_and_b32 s74, s74, 7
    s_mul_i32 s74, s74, s71
    s_lshl_b32 s74, s74, 2
    s_add_u32 s74, s74, s55
    s_add_u32 m0, s53, 0
    s_nop 0
    s_nop 0
    buffer_load_dwordx4 v6, s[20:23], s74 offen lds
    s_add_u32 m0, s53, 1024
    s_add_u32 s74, s74, s71
    s_nop 0
    buffer_load_dwordx4 v6, s[20:23], s74 offen lds
    s_add_u32 m0, s53, 2048
    s_add_u32 s74, s74, s71
    s_nop 0
    buffer_load_dwordx4 v6, s[20:23], s74 offen lds
    s_add_u32 m0, s53, 3072
    s_add_u32 s74, s74, s71
    s_nop 0
    buffer_load_dwordx4 v6, s[20:23], s74 offen lds
    s_add_u32 m0, s53, 32768
    s_add_u32 s59, s56, 0
    s_nop 0
    buffer_load_dwordx4 v3, s[24:27], s59 offen lds
    s_add_u32 m0, s53, 33792
    s_add_u32 s59, s56, 16384
    buffer_load_dwordx4 v3, s[24:27], s59 offen lds
    s_add_u32 m0, s53, 34816
    s_add_u32 s59, s56, 32768
    buffer_load_dwordx4 v3, s[24:27], s59 offen lds
    s_add_u32 m0, s53, 35840
    s_add_u32 s59, s56, 49152
    buffer_load_dwordx4 v3, s[24:27], s59 offen lds
    s_mov_b32 s67, 0
    s_waitcnt vmcnt(12)
    s_branch Lf_8
Lw_6:
    s_mul_i32 s59, s46, 7
    s_min_u32 s60, s49, 6
    s_add_u32 s59, s59, s60
    s_lshl_b32 s59, s59, 11
    s_nop 0
    s_add_u32 s59, s59, 0xe40000
    buffer_load_dwordx4 v[244:247], v1, s[28:31], s59 offen offset:0 sc1
    buffer_load_dwordx4 v[248:251], v1, s[28:31], s59 offen offset:1024 sc1
    s_add_u32 s67, s67, 1
    s_waitcnt vmcnt(0)
Lf_8:
    v_xor_b32 v245, s40, v245
    v_xor_b32 v247, s40, v247
    v_xor_b32 v249, s40, v249
    v_xor_b32 v251, s40, v251
    v_or3_b32 v245, v245, v247, v249
    v_or_b32_e64 v245, v245, v251
    v_cmp_ne_u32 vcc, 0, v245
    s_cbranch_vccz Lg_7
    s_cmp_lt_u32 s67, 1000000
    s_cbranch_scc1 Lw_6
Lg_7:
    v_add_f32 v244, v244, v248
    v_add_f32 v245, v246, v250
    v_mov_b32 v246, v244
    v_mov_b32 v247, v245
    s_nop 1
    v_permlane32_swap_b32 v244, v246
    v_permlane32_swap_b32 v245, v247
    v_add_f32 v244, v244, v246
    v_add_f32 v245, v245, v247
    v_mov_b32 v246, v244
    v_mov_b32 v247, v245
    s_nop 1
    v_permlane16_swap_b32 v244, v246
    v_permlane16_swap_b32 v245, v247
    v_add_f32 v244, v244, v246
    v_add_f32 v245, v245, v247
    s_lshl_b32 s59, s49, 7
    s_add_u32 s59, s59, 129024
    v_and_b32 v246, 15, v0
    v_lshlrev_b32 v246, 3, v246
    v_add_u32_e64 v246, s59, v246
    ds_write_b64 v246, v[244:245]
    v_lshrrev_b32 v246, 5, v0
    v_lshlrev_b32 v246, 4, v246
    v_add_u32 v246, s59, v246
    s_waitcnt lgkmcnt(0)
    ds_read_b128 v[116:119], v246 offset:0
    ds_read_b128 v[120:123], v246 offset:32
    ds_read_b128 v[124:127], v246 offset:64
    ds_read_b128 v[128:131], v246 offset:96
    s_waitcnt lgkmcnt(0)
    s_waitcnt vmcnt(0)
    ds_read_b64_tr_b16 v[196:197], v5 offset:0
    ds_read_b64_tr_b16 v[198:199], v5 offset:256
    ds_read_b64_tr_b16 v[200:201], v5 offset:1024
    ds_read_b64_tr_b16 v[202:203], v5 offset:1280
    ds_read_b64_tr_b16 v[204:205], v5 offset:2048
    ds_read_b64_tr_b16 v[206:207], v5 offset:2304
    ds_read_b64_tr_b16 v[208:209], v5 offset:3072
    ds_read_b64_tr_b16 v[210:211], v5 offset:3328
    ds_read_b64_tr_b16 v[212:213], v4 offset:0
    ds_read_b64_tr_b16 v[214:215], v4 offset:256
    ds_read_b64_tr_b16 v[216:217], v4 offset:1024
    ds_read_b64_tr_b16 v[218:219], v4 offset:1280
    ds_read_b64_tr_b16 v[220:221], v4 offset:2048
    ds_read_b64_tr_b16 v[222:223], v4 offset:2304
    ds_read_b64_tr_b16 v[224:225], v4 offset:3072
    ds_read_b64_tr_b16 v[226:227], v4 offset:3328
    ds_read_b64_tr_b16 v[228:229], v4 offset:32768
    ds_read_b64_tr_b16 v[230:231], v4 offset:33024
    ds_read_b64_tr_b16 v[232:233], v4 offset:33792
    ds_read_b64_tr_b16 v[234:235], v4 offset:34048
    ds_read_b64_tr_b16 v[236:237], v4 offset:34816
    ds_read_b64_tr_b16 v[238:239], v4 offset:35072
    ds_read_b64_tr_b16 v[240:241], v4 offset:35840
    ds_read_b64_tr_b16 v[242:243], v4 offset:36096
    s_waitcnt lgkmcnt(0)
    s_add_u32 m0, s53, 0
    s_add_u32 s59, s56, 65536
    buffer_load_dwordx4 v3, s[24:27], s59 offen lds
    s_add_u32 m0, s53, 1024
    s_add_u32 s59, s56, 81920
    buffer_load_dwordx4 v3, s[24:27], s59 offen lds
    s_add_u32 m0, s53, 2048
    s_add_u32 s59, s56, 98304
    buffer_load_dwordx4 v3, s[24:27], s59 offen lds
    s_add_u32 m0, s53, 3072
    s_add_u32 s59, s56, 114688
    buffer_load_dwordx4 v3, s[24:27], s59 offen lds
    s_add_u32 m0, s53, 131072
    s_add_u32 s59, s56, 131072
    buffer_load_dwordx4 v3, s[24:27], s59 offen lds
    s_add_u32 m0, s53, 132096
    s_add_u32 s59, s56, 147456
    buffer_load_dwordx4 v3, s[24:27], s59 offen lds
    s_add_u32 m0, s53, 133120
    s_add_u32 s59, s56, 163840
    buffer_load_dwordx4 v3, s[24:27], s59 offen lds
    s_add_u32 m0, s53, 134144
    s_add_u32 s59, s56, 180224
    buffer_load_dwordx4 v3, s[24:27], s59 offen lds
    s_setprio 3
    s_barrier
    ds_read_b128 v[56:59], v2 offset:0
    ds_read_b128 v[60:63], v2 offset:1024
    ds_read_b128 v[64:67], v2 offset:2048
    ds_read_b128 v[68:71], v2 offset:3072
    ds_read_b128 v[24:27], v2 offset:4096
    ds_read_b128 v[28:31], v2 offset:5120
    ds_read_b128 v[32:35], v2 offset:6144
    ds_read_b128 v[36:39], v2 offset:7168
    s_waitcnt lgkmcnt(7)
    s_nop 0
    v_mfma_f32_32x32x16_bf16 v[8:23], v[132:135], v[56:59], 0
    ds_read_b128 v[56:59], v2 offset:8192
    s_waitcnt lgkmcnt(7)
    s_nop 0
    v_mfma_f32_32x32x16_bf16 v[8:23], v[136:139], v[60:63], v[8:23]
    ds_read_b128 v[60:63], v2 offset:9216
    s_waitcnt lgkmcnt(7)
    s_nop 0
    v_mfma_f32_32x32x16_bf16 v[8:23], v[140:143], v[64:67], v[8:23]
    s_mul_i32 s42, s44, 28672
    s_lshl_b32 s59, s49, 11
    s_add_u32 s42, s42, s59
    s_add_u32 s42, s42, 0x1200000
    ds_read_b128 v[64:67], v2 offset:10240
    s_waitcnt lgkmcnt(7)
    s_nop 0
    v_mfma_f32_32x32x16_bf16 v[8:23], v[144:147], v[68:71], v[8:23]
    ds_read_b128 v[68:71], v2 offset:11264
    s_waitcnt lgkmcnt(7)
    s_nop 0
    v_mfma_f32_32x32x16_bf16 v[8:23], v[84:87], v[24:27], v[8:23]
    ds_read_b128 v[24:27], v2 offset:12288
    s_waitcnt lgkmcnt(7)
    s_nop 0
    v_mfma_f32_32x32x16_bf16 v[8:23], v[88:91], v[28:31], v[8:23]
    ds_read_b128 v[28:31], v2 offset:13312
    s_waitcnt lgkmcnt(7)
    s_nop 0
    v_mfma_f32_32x32x16_bf16 v[8:23], v[92:95], v[32:35], v[8:23]
    ds_read_b128 v[32:35], v2 offset:14336
    s_waitcnt lgkmcnt(7)
    s_nop 0
    v_mfma_f32_32x32x16_bf16 v[8:23], v[96:99], v[36:39], v[8:23]
    ds_read_b128 v[36:39], v2 offset:15360
    s_waitcnt lgkmcnt(7)
    s_nop 0
    v_mfma_f32_32x32x16_bf16 v[8:23], v[100:103], v[56:59], v[8:23]
    ds_read_b128 v[56:59], v2 offset:16384
    s_waitcnt lgkmcnt(7)
    s_nop 0
    v_mfma_f32_32x32x16_bf16 v[8:23], v[104:107], v[60:63], v[8:23]
    ds_read_b128 v[60:63], v2 offset:17408
    s_waitcnt lgkmcnt(7)
    s_nop 0
    v_mfma_f32_32x32x16_bf16 v[8:23], v[108:111], v[64:67], v[8:23]
    s_waitcnt vmcnt(7)
    s_nop 0
    ds_read_b64_tr_b16 v[40:41], v4 offset:0
    ds_read_b64_tr_b16 v[42:43], v4 offset:256
    ds_read_b128 v[64:67], v2 offset:18432
    s_waitcnt lgkmcnt(9)
    s_nop 0
    v_mfma_f32_32x32x16_bf16 v[8:23], v[112:115], v[68:71], v[8:23]
    ds_read_b128 v[68:71], v2 offset:19456
    s_waitcnt lgkmcnt(9)
    s_nop 0
    v_mfma_f32_32x32x16_bf16 v[8:23], v[148:151], v[24:27], v[8:23]
    ds_read_b128 v[24:27], v2 offset:20480
    s_waitcnt lgkmcnt(9)
    s_nop 0
    v_mfma_f32_32x32x16_bf16 v[8:23], v[152:155], v[28:31], v[8:23]
    s_waitcnt lgkmcnt(3)
    s_add_u32 m0, s53, 0
    s_add_u32 s59, s56, 196608
    buffer_load_dwordx4 v3, s[24:27], s59 offen lds
    s_waitcnt vmcnt(7)
    s_nop 0
    ds_read_b64_tr_b16 v[44:45], v4 offset:1024
    ds_read_b64_tr_b16 v[46:47], v4 offset:1280
    ds_read_b128 v[28:31], v2 offset:21504
    v_mfma_f32_32x32x16_bf16 v[8:23], v[156:159], v[32:35], v[8:23]
    ds_read_b128 v[32:35], v2 offset:22528
    v_mfma_f32_32x32x16_bf16 v[8:23], v[160:163], v[36:39], v[8:23]
    ds_read_b128 v[36:39], v2 offset:23552
    v_mfma_f32_32x32x16_bf16 v[8:23], v[164:167], v[56:59], v[8:23]
    s_waitcnt lgkmcnt(3)
    s_nop 0
    s_add_u32 m0, s53, 1024
    s_add_u32 s59, s56, 212992
    buffer_load_dwordx4 v3, s[24:27], s59 offen lds
    s_waitcnt vmcnt(7)
    s_nop 0
    ds_read_b64_tr_b16 v[48:49], v4 offset:2048
    ds_read_b64_tr_b16 v[50:51], v4 offset:2304
    ds_read_b128 v[56:59], v2 offset:24576
    v_mfma_f32_32x32x16_bf16 v[8:23], v[168:171], v[60:63], v[8:23]
    ds_read_b128 v[60:63], v2 offset:25600
    v_mfma_f32_32x32x16_bf16 v[8:23], v[172:175], v[64:67], v[8:23]
    ds_read_b128 v[64:67], v2 offset:26624
    v_mfma_f32_32x32x16_bf16 v[8:23], v[176:179], v[68:71], v[8:23]
    s_waitcnt lgkmcnt(3)
    s_nop 0
    s_add_u32 m0, s53, 2048
    s_add_u32 s59, s69, 0
    s_nop 0
    buffer_load_dwordx4 v3, s[24:27], s59 offen lds
    s_waitcnt vmcnt(7)
    s_nop 0
    ds_read_b64_tr_b16 v[52:53], v4 offset:3072
    ds_read_b64_tr_b16 v[54:55], v4 offset:3328
    ds_read_b128 v[68:71], v2 offset:27648
    v_mfma_f32_32x32x16_bf16 v[8:23], v[180:183], v[24:27], v[8:23]
    ds_read_b128 v[24:27], v2 offset:28672
    v_mfma_f32_32x32x16_bf16 v[8:23], v[184:187], v[28:31], v[8:23]
    ds_read_b128 v[28:31], v2 offset:29696
    v_mfma_f32_32x32x16_bf16 v[8:23], v[188:191], v[32:35], v[8:23]
    s_waitcnt lgkmcnt(3)
    s_nop 0
    s_add_u32 m0, s53, 3072
    s_add_u32 s59, s69, 16384
    buffer_load_dwordx4 v3, s[24:27], s59 offen lds
    ds_read_b128 v[32:35], v2 offset:30720
    v_mfma_f32_32x32x16_bf16 v[8:23], v[192:195], v[36:39], v[8:23]
    ds_read_b128 v[36:39], v2 offset:31744
    v_mfma_f32_32x32x16_bf16 v[8:23], v[196:199], v[56:59], v[8:23]
    v_mfma_f32_32x32x16_bf16 v[8:23], v[200:203], v[60:63], v[8:23]
    v_mfma_f32_32x32x16_bf16 v[8:23], v[204:207], v[64:67], v[8:23]
    s_waitcnt lgkmcnt(4)
    s_nop 0
    v_mfma_f32_32x32x16_bf16 v[8:23], v[208:211], v[68:71], v[8:23]
    s_waitcnt lgkmcnt(3)
    s_nop 0
    v_mfma_f32_32x32x16_bf16 v[8:23], v[212:215], v[24:27], v[8:23]
    s_waitcnt lgkmcnt(2)
    s_nop 0
    v_mfma_f32_32x32x16_bf16 v[8:23], v[216:219], v[28:31], v[8:23]
    s_waitcnt lgkmcnt(1)
    s_nop 0
    v_mfma_f32_32x32x16_bf16 v[8:23], v[220:223], v[32:35], v[8:23]
    s_waitcnt lgkmcnt(0)
    s_nop 0
    v_mfma_f32_32x32x16_bf16 v[8:23], v[224:227], v[36:39], v[8:23]
    s_setprio 1
    s_barrier
    ds_read_b128 v[244:247], v2 offset:61440
    ds_read_b128 v[248:251], v2 offset:62464
    s_nop 6
    s_waitcnt lgkmcnt(0)
    v_fma_f32 v8, -v247, v116, v8
    v_fma_f32 v9, -v247, v117, v9
    v_fma_f32 v10, -v247, v118, v10
    v_fma_f32 v11, -v247, v119, v11
    v_fma_f32 v12, -v247, v120, v12
    v_fma_f32 v13, -v247, v121, v13
    v_fma_f32 v14, -v247, v122, v14
    v_fma_f32 v15, -v247, v123, v15
    v_fma_f32 v16, -v247, v124, v16
    v_fma_f32 v17, -v247, v125, v17
    v_fma_f32 v18, -v247, v126, v18
    v_fma_f32 v19, -v247, v127, v19
    v_fma_f32 v20, -v247, v128, v20
    v_fma_f32 v21, -v247, v129, v21
    v_fma_f32 v22, -v247, v130, v22
    v_fma_f32 v23, -v247, v131, v23
    v_mul_f32 v72, v8, v8
    v_mul_f32 v73, v9, v9
    v_mul_f32 v74, v10, v10
    v_mul_f32 v75, v11, v11
    v_mul_f32 v76, v12, v12
    v_mul_f32 v77, v13, v13
    v_mul_f32 v78, v14, v14
    v_mul_f32 v79, v15, v15
    v_fma_f32 v72, v72, v245, v244
    v_fma_f32 v73, v73, v245, v244
    v_fma_f32 v74, v74, v245, v244
    v_fma_f32 v75, v75, v245, v244
    v_fma_f32 v76, v76, v245, v244
    v_fma_f32 v77, v77, v245, v244
    v_fma_f32 v78, v78, v245, v244
    v_fma_f32 v79, v79, v245, v244
    v_mul_f32 v72, v72, v8
    v_mul_f32 v73, v73, v9
    v_mul_f32 v74, v74, v10
    v_mul_f32 v75, v75, v11
    v_mul_f32 v76, v76, v12
    v_mul_f32 v77, v77, v13
    v_mul_f32 v78, v78, v14
    v_mul_f32 v79, v79, v15
    v_exp_f32 v72, v72
    v_exp_f32 v73, v73
    v_exp_f32 v74, v74
    v_exp_f32 v75, v75
    v_exp_f32 v76, v76
    v_exp_f32 v77, v77
    v_exp_f32 v78, v78
    v_exp_f32 v79, v79
    v_fma_f32 v72, v72, v246, v246
    v_fma_f32 v73, v73, v246, v246
    v_fma_f32 v74, v74, v246, v246
    v_fma_f32 v75, v75, v246, v246
    v_fma_f32 v76, v76, v246, v246
    v_fma_f32 v77, v77, v246, v246
    v_fma_f32 v78, v78, v246, v246
    v_fma_f32 v79, v79, v246, v246
    v_rcp_f32 v72, v72
    v_rcp_f32 v73, v73
    v_rcp_f32 v74, v74
    v_rcp_f32 v75, v75
    v_rcp_f32 v76, v76
    v_rcp_f32 v77, v77
    v_rcp_f32 v78, v78
    v_rcp_f32 v79, v79
    v_mul_f32 v8, v8, v72
    v_mul_f32 v9, v9, v73
    v_mul_f32 v10, v10, v74
    v_mul_f32 v11, v11, v75
    v_mul_f32 v12, v12, v76
    v_mul_f32 v13, v13, v77
    v_mul_f32 v14, v14, v78
    v_mul_f32 v15, v15, v79
    v_cvt_pk_bf16_f32 v8, v8, v9
    v_cvt_pk_bf16_f32 v9, v10, v11
    v_cvt_pk_bf16_f32 v10, v12, v13
    v_cvt_pk_bf16_f32 v11, v14, v15
    v_min_u32 v8, -2, v8
    v_mul_f32 v72, v16, v16
    v_mul_f32 v73, v17, v17
    v_mul_f32 v74, v18, v18
    v_mul_f32 v75, v19, v19
    v_mul_f32 v76, v20, v20
    v_mul_f32 v77, v21, v21
    v_mul_f32 v78, v22, v22
    v_mul_f32_e64 v79, v23, v23
    v_fma_f32 v72, v72, v245, v244
    v_fma_f32 v73, v73, v245, v244
    v_fma_f32 v74, v74, v245, v244
    v_fma_f32 v75, v75, v245, v244
    v_fma_f32 v76, v76, v245, v244
    v_fma_f32 v77, v77, v245, v244
    v_fma_f32 v78, v78, v245, v244
    v_fma_f32 v79, v79, v245, v244
    v_mul_f32 v72, v72, v16
    v_mul_f32 v73, v73, v17
    v_mul_f32 v74, v74, v18
    v_mul_f32 v75, v75, v19
    v_mul_f32 v76, v76, v20
    v_mul_f32 v77, v77, v21
    v_mul_f32 v78, v78, v22
    v_mul_f32 v79, v79, v23
    v_exp_f32 v72, v72
    v_exp_f32 v73, v73
    v_exp_f32 v74, v74
    v_exp_f32 v75, v75
    v_exp_f32 v76, v76
    v_exp_f32 v77, v77
    v_exp_f32 v78, v78
    v_exp_f32 v79, v79
    v_fma_f32 v72, v72, v246, v246
    v_fma_f32 v73, v73, v246, v246
    v_fma_f32 v74, v74, v246, v246
    v_fma_f32 v75, v75, v246, v246
    v_fma_f32 v76, v76, v246, v246
    v_fma_f32 v77, v77, v246, v246
    v_fma_f32 v78, v78, v246, v246
    v_fma_f32 v79, v79, v246, v246
    v_rcp_f32 v72, v72
    v_rcp_f32 v73, v73
    v_rcp_f32 v74, v74
    v_rcp_f32 v75, v75
    v_rcp_f32 v76, v76
    v_rcp_f32 v77, v77
    v_rcp_f32 v78, v78
    v_rcp_f32 v79, v79
    v_mul_f32 v16, v16, v72
    v_mul_f32 v17, v17, v73
    v_mul_f32 v18, v18, v74
    v_mul_f32 v19, v19, v75
    v_mul_f32 v20, v20, v76
    v_mul_f32 v21, v21, v77
    v_mul_f32 v22, v22, v78
    v_mul_f32 v23, v23, v79
    v_cvt_pk_bf16_f32 v16, v16, v17
    v_cvt_pk_bf16_f32 v17, v18, v19
    v_cvt_pk_bf16_f32 v18, v20, v21
    v_cvt_pk_bf16_f32 v19, v22, v23
    v_min_u32 v16, -2, v16
    s_lshl_b32 s59, s49, 11
    v_add_u32_e64 v252, s59, v2
    ds_write_b128 v252, v[8:11] offset:32768
    ds_write_b128 v252, v[16:19] offset:33792
    ds_read_b128 v[56:59], v1 offset:32768
    ds_read_b128 v[60:63], v1 offset:33792
    ds_read_b128 v[64:67], v1 offset:34816
    ds_read_b128 v[68:71], v1 offset:35840
    ds_read_b128 v[12:15], v1 offset:36864
    ds_read_b128 v[20:23], v1 offset:37888
    s_waitcnt lgkmcnt(5)
    s_nop 0
    v_mfma_f32_32x32x16_bf16 v[24:39], v[132:135], v[56:59], 0
    s_add_u32 s60, s42, 0
    s_cmp_eq_u32 s64, 1
    s_cbranch_scc1 Lp_9
    s_nop 0
    buffer_store_dwordx4 v[8:11], v1, s[28:31], s60 offen offset:0 sc1
    buffer_store_dwordx4 v[16:19], v1, s[28:31], s60 offen offset:1024 sc1
    s_branch Lq_10
Lp_9:
    s_nop 0
    buffer_store_dwordx4 v[8:11], v1, s[28:31], s60 offen offset:0
    buffer_store_dwordx4 v[16:19], v1, s[28:31], s60 offen offset:1024
Lq_10:
    ds_read_b128 v[56:59], v1 offset:38912
    s_waitcnt lgkmcnt(5)
    s_nop 0
    v_mfma_f32_32x32x16_bf16 v[24:39], v[136:139], v[60:63], v[24:39]
    ds_read_b128 v[60:63], v1 offset:39936
    s_waitcnt lgkmcnt(5)
    s_nop 0
    v_mfma_f32_32x32x16_bf16 v[24:39], v[140:143], v[64:67], v[24:39]
    s_waitcnt vmcnt(9)
    s_nop 0
    ds_read_b64_tr_b16 v[132:133], v5 offset:0
    ds_read_b64_tr_b16 v[134:135], v5 offset:256
    ds_read_b128 v[64:67], v1 offset:40960
    s_waitcnt lgkmcnt(7)
    s_nop 0
    v_mfma_f32_32x32x16_bf16 v[24:39], v[144:147], v[68:71], v[24:39]
    ds_read_b128 v[68:71], v1 offset:41984
    s_waitcnt lgkmcnt(7)
    s_nop 0
    v_mfma_f32_32x32x16_bf16 v[24:39], v[84:87], v[12:15], v[24:39]
    ds_read_b128 v[12:15], v1 offset:43008
    s_waitcnt lgkmcnt(7)
    s_nop 0
    v_mfma_f32_32x32x16_bf16 v[24:39], v[88:91], v[20:23], v[24:39]
    s_waitcnt lgkmcnt(3)
    s_nop 0
    s_add_u32 m0, s53, 131072
    s_add_u32 s59, s69, 32768
    buffer_load_dwordx4 v3, s[24:27], s59 offen lds
    s_waitcnt vmcnt(9)
    s_nop 0
    ds_read_b64_tr_b16 v[136:137], v5 offset:1024
    ds_read_b64_tr_b16 v[138:139], v5 offset:1280
    ds_read_b128 v[20:23], v1 offset:44032
    v_mfma_f32_32x32x16_bf16 v[24:39], v[92:95], v[56:59], v[24:39]
    ds_read_b128 v[56:59], v1 offset:45056
    v_mfma_f32_32x32x16_bf16 v[24:39], v[96:99], v[60:63], v[24:39]
    ds_read_b128 v[60:63], v1 offset:46080
    s_waitcnt lgkmcnt(7)
    s_nop 0
    v_mfma_f32_32x32x16_bf16 v[24:39], v[100:103], v[64:67], v[24:39]
    s_waitcnt lgkmcnt(3)
    s_nop 0
    s_add_u32 m0, s53, 132096
    s_add_u32 s59, s69, 49152
    buffer_load_dwordx4 v3, s[24:27], s59 offen lds
    s_waitcnt vmcnt(9)
    s_nop 0
    ds_read_b64_tr_b16 v[140:141], v5 offset:2048
    ds_read_b64_tr_b16 v[142:143], v5 offset:2304
    ds_read_b128 v[64:67], v1 offset:47104
    v_mfma_f32_32x32x16_bf16 v[24:39], v[104:107], v[68:71], v[24:39]
    ds_read_b128 v[68:71], v1 offset:48128
    v_mfma_f32_32x32x16_bf16 v[24:39], v[108:111], v[12:15], v[24:39]
    ds_read_b128 v[12:15], v1 offset:49152
    s_waitcnt lgkmcnt(7)
    s_nop 0
    v_mfma_f32_32x32x16_bf16 v[24:39], v[112:115], v[20:23], v[24:39]
    s_waitcnt lgkmcnt(3)
    s_nop 0
    s_add_u32 m0, s53, 133120
    s_add_u32 s59, s69, 65536
    buffer_load_dwordx4 v3, s[24:27], s59 offen lds
    s_waitcnt vmcnt(9)
    s_nop 0
    ds_read_b64_tr_b16 v[144:145], v5 offset:3072
    ds_read_b64_tr_b16 v[146:147], v5 offset:3328
    ds_read_b128 v[20:23], v1 offset:50176
    v_mfma_f32_32x32x16_bf16 v[24:39], v[148:151], v[56:59], v[24:39]
    ds_read_b128 v[56:59], v1 offset:51200
    v_mfma_f32_32x32x16_bf16 v[24:39], v[152:155], v[60:63], v[24:39]
    ds_read_b128 v[60:63], v1 offset:52224
    s_waitcnt lgkmcnt(7)
    s_nop 0
    v_mfma_f32_32x32x16_bf16 v[24:39], v[156:159], v[64:67], v[24:39]
    s_waitcnt lgkmcnt(3)
    s_nop 0
    s_add_u32 m0, s53, 134144
    s_add_u32 s59, s69, 81920
    buffer_load_dwordx4 v3, s[24:27], s59 offen lds
    s_waitcnt vmcnt(9)
    s_nop 0
    ds_read_b64_tr_b16 v[84:85], v4 offset:0
    ds_read_b64_tr_b16 v[86:87], v4 offset:256
    ds_read_b128 v[64:67], v1 offset:53248
    v_mfma_f32_32x32x16_bf16 v[24:39], v[160:163], v[68:71], v[24:39]
    ds_read_b128 v[68:71], v1 offset:54272
    v_mfma_f32_32x32x16_bf16 v[24:39], v[164:167], v[12:15], v[24:39]
    ds_read_b128 v[12:15], v1 offset:55296
    s_waitcnt lgkmcnt(7)
    s_nop 0
    v_mfma_f32_32x32x16_bf16 v[24:39], v[168:171], v[20:23], v[24:39]
    s_waitcnt lgkmcnt(3)
    s_add_u32 m0, s53, 0
    s_add_u32 s59, s69, 98304
    buffer_load_dwordx4 v3, s[24:27], s59 offen lds
    s_waitcnt vmcnt(9)
    s_nop 0
    ds_read_b64_tr_b16 v[88:89], v4 offset:1024
    ds_read_b64_tr_b16 v[90:91], v4 offset:1280
    ds_read_b128 v[20:23], v1 offset:56320
    v_mfma_f32_32x32x16_bf16 v[24:39], v[172:175], v[56:59], v[24:39]
    ds_read_b128 v[56:59], v1 offset:57344
    v_mfma_f32_32x32x16_bf16 v[24:39], v[176:179], v[60:63], v[24:39]
    ds_read_b128 v[60:63], v1 offset:58368
    s_waitcnt lgkmcnt(7)
    s_nop 0
    v_mfma_f32_32x32x16_bf16 v[24:39], v[180:183], v[64:67], v[24:39]
    s_waitcnt lgkmcnt(3)
    s_nop 0
    s_add_u32 m0, s53, 1024
    s_add_u32 s59, s69, 114688
    buffer_load_dwordx4 v3, s[24:27], s59 offen lds
    s_waitcnt vmcnt(9)
    s_nop 0
    ds_read_b64_tr_b16 v[92:93], v4 offset:2048
    ds_read_b64_tr_b16 v[94:95], v4 offset:2304
    ds_read_b128 v[64:67], v1 offset:59392
    v_mfma_f32_32x32x16_bf16 v[24:39], v[184:187], v[68:71], v[24:39]
    ds_read_b128 v[68:71], v1 offset:60416
    v_mfma_f32_32x32x16_bf16 v[24:39], v[188:191], v[12:15], v[24:39]
    ds_read_b128 v[12:15], v1 offset:61440
    s_waitcnt lgkmcnt(7)
    s_nop 0
    v_mfma_f32_32x32x16_bf16 v[24:39], v[192:195], v[20:23], v[24:39]
    s_waitcnt lgkmcnt(3)
    s_nop 0
    s_add_u32 m0, s53, 2048
    s_add_u32 s59, s69, 131072
    buffer_load_dwordx4 v3, s[24:27], s59 offen lds
    s_waitcnt vmcnt(9)
    s_nop 0
    ds_read_b64_tr_b16 v[96:97], v4 offset:3072
    ds_read_b64_tr_b16 v[98:99], v4 offset:3328
    ds_read_b128 v[20:23], v1 offset:62464
    v_mfma_f32_32x32x16_bf16 v[24:39], v[196:199], v[56:59], v[24:39]
    ds_read_b128 v[56:59], v1 offset:63488
    v_mfma_f32_32x32x16_bf16 v[24:39], v[200:203], v[60:63], v[24:39]
    ds_read_b128 v[60:63], v1 offset:64512
    s_waitcnt lgkmcnt(7)
    s_nop 0
    v_mfma_f32_32x32x16_bf16 v[24:39], v[204:207], v[64:67], v[24:39]
    s_waitcnt lgkmcnt(3)
    s_nop 0
    s_add_u32 m0, s53, 3072
    s_add_u32 s59, s69, 147456
    buffer_load_dwordx4 v3, s[24:27], s59 offen lds
    s_waitcnt vmcnt(7)
    s_nop 0
    ds_read_b64_tr_b16 v[100:101], v5 offset:0
    ds_read_b64_tr_b16 v[102:103], v5 offset:256
    v_mfma_f32_32x32x16_bf16 v[24:39], v[208:211], v[68:71], v[24:39]
    v_mfma_f32_32x32x16_bf16 v[24:39], v[212:215], v[12:15], v[24:39]
    s_barrier
    s_waitcnt lgkmcnt(4)
    v_mfma_f32_32x32x16_bf16 v[24:39], v[216:219], v[20:23], v[24:39]
    s_waitcnt lgkmcnt(3)
    s_nop 0
    v_mfma_f32_32x32x16_bf16 v[24:39], v[220:223], v[56:59], v[24:39]
    s_waitcnt lgkmcnt(2)
    s_nop 0
    v_mfma_f32_32x32x16_bf16 v[24:39], v[224:227], v[60:63], v[24:39]
    s_nop 10
    s_nop 0
    v_fma_f32 v24, -v251, v116, v24
    v_fma_f32 v25, -v251, v117, v25
    v_fma_f32 v26, -v251, v118, v26
    v_fma_f32 v27, -v251, v119, v27
    v_fma_f32 v28, -v251, v120, v28
    v_fma_f32 v29, -v251, v121, v29
    v_fma_f32 v30, -v251, v122, v30
    v_fma_f32 v31, -v251, v123, v31
    v_fma_f32 v32, -v251, v124, v32
    v_fma_f32 v33, -v251, v125, v33
    v_fma_f32 v34, -v251, v126, v34
    v_fma_f32 v35, -v251, v127, v35
    v_fma_f32 v36, -v251, v128, v36
    v_fma_f32 v37, -v251, v129, v37
    v_fma_f32 v38, -v251, v130, v38
    v_fma_f32 v39, -v251, v131, v39
    s_waitcnt lgkmcnt(0)
    v_mul_f32 v72, v24, v24
    v_mul_f32 v73, v25, v25
    v_mul_f32 v74, v26, v26
    v_mul_f32 v75, v27, v27
    v_mul_f32 v76, v28, v28
    v_mul_f32 v77, v29, v29
    s_waitcnt vmcnt(6)
    ds_read_b64_tr_b16 v[104:105], v5 offset:1024
    ds_read_b64_tr_b16 v[106:107], v5 offset:1280
    v_mul_f32 v78, v30, v30
    v_mul_f32 v79, v31, v31
    v_fma_f32 v72, v72, v249, v248
    v_fma_f32 v73, v73, v249, v248
    v_fma_f32 v74, v74, v249, v248
    v_fma_f32 v75, v75, v249, v248
    v_fma_f32 v76, v76, v249, v248
    v_fma_f32 v77, v77, v249, v248
    v_fma_f32 v78, v78, v249, v248
    v_fma_f32 v79, v79, v249, v248
    v_mul_f32 v72, v72, v24
    v_mul_f32 v73, v73, v25
    v_mul_f32 v74, v74, v26
    v_mul_f32 v75, v75, v27
    v_mul_f32 v76, v76, v28
    v_mul_f32 v77, v77, v29
    v_mul_f32 v78, v78, v30
    v_mul_f32_e64 v79, v79, v31
    s_waitcnt vmcnt(5)
    ds_read_b64_tr_b16 v[108:109], v5 offset:2048
    ds_read_b64_tr_b16 v[110:111], v5 offset:2304
    v_exp_f32 v72, v72
    v_exp_f32 v73, v73
    v_exp_f32 v74, v74
    v_exp_f32 v75, v75
    v_exp_f32 v76, v76
    v_exp_f32 v77, v77
    v_exp_f32 v78, v78
    v_exp_f32 v79, v79
    v_fma_f32 v72, v72, v250, v250
    v_fma_f32 v73, v73, v250, v250
    s_waitcnt vmcnt(4)
    s_nop 0
    ds_read_b64_tr_b16 v[112:113], v5 offset:3072
    ds_read_b64_tr_b16 v[114:115], v5 offset:3328
    v_fma_f32 v74, v74, v250, v250
    v_fma_f32 v75, v75, v250, v250
    v_fma_f32 v76, v76, v250, v250
    v_fma_f32 v77, v77, v250, v250
    v_fma_f32 v78, v78, v250, v250
    v_fma_f32 v79, v79, v250, v250
    v_rcp_f32 v72, v72
    v_rcp_f32 v73, v73
    v_rcp_f32 v74, v74
    v_rcp_f32 v75, v75
    v_rcp_f32 v76, v76
    v_rcp_f32_e64 v77, v77
    s_waitcnt vmcnt(3)
    ds_read_b64_tr_b16 v[148:149], v4 offset:0
    ds_read_b64_tr_b16 v[150:151], v4 offset:256
    v_rcp_f32 v78, v78
    v_rcp_f32 v79, v79
    v_mul_f32 v24, v24, v72
    v_mul_f32 v25, v25, v73
    v_mul_f32 v26, v26, v74
    v_mul_f32 v27, v27, v75
    v_mul_f32 v28, v28, v76
    v_mul_f32 v29, v29, v77
    v_mul_f32 v30, v30, v78
    v_mul_f32_e64 v31, v31, v79
    s_waitcnt vmcnt(2)
    ds_read_b64_tr_b16 v[152:153], v4 offset:1024
    ds_read_b64_tr_b16 v[154:155], v4 offset:1280
    v_cvt_pk_bf16_f32 v24, v24, v25
    v_cvt_pk_bf16_f32 v25, v26, v27
    v_cvt_pk_bf16_f32 v26, v28, v29
    v_cvt_pk_bf16_f32 v27, v30, v31
    v_min_u32 v24, -2, v24
    v_mul_f32 v72, v32, v32
    v_mul_f32 v73, v33, v33
    v_mul_f32 v74, v34, v34
    v_mul_f32 v75, v35, v35
    v_mul_f32 v76, v36, v36
    v_mul_f32 v77, v37, v37
    v_mul_f32 v78, v38, v38
    v_mul_f32_e64 v79, v39, v39
    v_fma_f32 v72, v72, v249, v248
    v_fma_f32 v73, v73, v249, v248
    v_fma_f32 v74, v74, v249, v248
    v_fma_f32 v75, v75, v249, v248
    v_fma_f32 v76, v76, v249, v248
    v_fma_f32 v77, v77, v249, v248
    v_fma_f32 v78, v78, v249, v248
    v_fma_f32 v79, v79, v249, v248
    v_mul_f32 v72, v72, v32
    v_mul_f32 v73, v73, v33
    s_add_u32 m0, s53, 131072
    s_add_u32 s59, s69, 163840
    buffer_load_dwordx4 v3, s[24:27], s59 offen lds
    v_mul_f32 v74, v74, v34
    v_mul_f32 v75, v75, v35
    v_mul_f32 v76, v76, v36
    v_mul_f32 v77, v77, v37
    v_mul_f32 v78, v78, v38
    v_mul_f32 v79, v79, v39
    v_exp_f32 v72, v72
    v_exp_f32 v73, v73
    v_exp_f32 v74, v74
    v_exp_f32 v75, v75
    v_exp_f32 v76, v76
    v_exp_f32_e64 v77, v77
    s_waitcnt lgkmcnt(8)
    s_add_u32 m0, s53, 132096
    s_add_u32 s59, s69, 180224
    buffer_load_dwordx4 v3, s[24:27], s59 offen lds
    v_exp_f32 v78, v78
    v_exp_f32 v79, v79
    v_fma_f32 v72, v72, v250, v250
    v_fma_f32 v73, v73, v250, v250
    v_fma_f32 v74, v74, v250, v250
    v_fma_f32 v75, v75, v250, v250
    v_fma_f32 v76, v76, v250, v250
    v_fma_f32 v77, v77, v250, v250
    v_fma_f32 v78, v78, v250, v250
    v_fma_f32 v79, v79, v250, v250
    v_rcp_f32 v72, v72
    v_rcp_f32 v73, v73
    v_rcp_f32 v74, v74
    s_waitcnt lgkmcnt(6)
    s_add_u32 m0, s53, 133120
    s_add_u32 s59, s69, 196608
    buffer_load_dwordx4 v3, s[24:27], s59 offen lds
    v_rcp_f32 v75, v75
    v_rcp_f32 v76, v76
    v_rcp_f32 v77, v77
    v_rcp_f32 v78, v78
    v_rcp_f32 v79, v79
    v_mul_f32 v32, v32, v72
    v_mul_f32 v33, v33, v73
    v_mul_f32 v34, v34, v74
    v_mul_f32 v35, v35, v75
    v_mul_f32 v36, v36, v76
    v_mul_f32 v37, v37, v77
    v_mul_f32 v38, v38, v78
    v_mul_f32_e64 v39, v39, v79
    v_cvt_pk_bf16_f32 v32, v32, v33
    v_cvt_pk_bf16_f32 v33, v34, v35
    v_cvt_pk_bf16_f32 v34, v36, v37
    v_cvt_pk_bf16_f32 v35, v38, v39
    v_min_u32 v32, -2, v32
    s_lshl_b32 s59, s49, 11
    v_add_u32_e64 v252, s59, v2
    ds_write_b128 v252, v[24:27] offset:47104
    ds_write_b128 v252, v[32:35] offset:48128
    s_lshl_b32 s59, s50, 12
    v_add_u32 v72, s59, v1
    ds_read_b128 v[56:59], v2 offset:32768
    ds_read_b128 v[60:63], v2 offset:33792
    ds_read_b128 v[64:67], v2 offset:34816
    ds_read_b128 v[68:71], v2 offset:35840
    ds_read_b128 v[180:183], v2 offset:36864
    ds_read_b128 v[184:187], v2 offset:37888
    ds_read_b128 v[188:191], v2 offset:38912
    ds_read_b128 v[192:195], v2 offset:39936
    s_waitcnt lgkmcnt(7)
    s_nop 0
    v_mfma_f32_32x32x16_bf16 v[8:23], v[228:231], v[56:59], 0
    s_add_u32 m0, s53, 134144
    s_add_u32 s59, s69, 212992
    buffer_load_dwordx4 v3, s[24:27], s59 offen lds
    s_waitcnt vmcnt(5)
    s_nop 0
    ds_read_b64_tr_b16 v[156:157], v4 offset:2048
    ds_read_b64_tr_b16 v[158:159], v4 offset:2304
    ds_read_b128 v[56:59], v2 offset:40960
    s_waitcnt lgkmcnt(9)
    s_nop 0
    v_mfma_f32_32x32x16_bf16 v[8:23], v[232:235], v[60:63], v[8:23]
    s_add_u32 s60, s42, 14336
    s_cmp_eq_u32 s64, 1
    s_cbranch_scc1 Lp_11
    buffer_store_dwordx4 v[24:27], v1, s[28:31], s60 offen offset:0 sc1
    buffer_store_dwordx4 v[32:35], v1, s[28:31], s60 offen offset:1024 sc1
    s_branch Lq_12
Lp_11:
    s_nop 0
    buffer_store_dwordx4 v[24:27], v1, s[28:31], s60 offen offset:0
    buffer_store_dwordx4 v[32:35], v1, s[28:31], s60 offen offset:1024
Lq_12:
    ds_read_b128 v[60:63], v2 offset:41984
    s_waitcnt lgkmcnt(9)
    s_nop 0
    v_mfma_f32_32x32x16_bf16 v[8:23], v[236:239], v[64:67], v[8:23]
    s_waitcnt vmcnt(6)
    s_nop 0
    ds_read_b64_tr_b16 v[160:161], v4 offset:3072
    ds_read_b64_tr_b16 v[162:163], v4 offset:3328
    ds_read_b128 v[64:67], v2 offset:43008
    s_waitcnt lgkmcnt(11)
    s_nop 0
    v_mfma_f32_32x32x16_bf16 v[8:23], v[240:243], v[68:71], v[8:23]
    ds_read_b128 v[68:71], v2 offset:44032
    s_waitcnt lgkmcnt(11)
    s_nop 0
    v_mfma_f32_32x32x16_bf16 v[8:23], v[40:43], v[180:183], v[8:23]
    s_waitcnt vmcnt(5)
    s_nop 0
    ds_read_b64_tr_b16 v[164:165], v5 offset:0
    ds_read_b64_tr_b16 v[166:167], v5 offset:256
    ds_read_b128 v[180:183], v2 offset:45056
    s_waitcnt lgkmcnt(13)
    s_nop 0
    v_mfma_f32_32x32x16_bf16 v[8:23], v[44:47], v[184:187], v[8:23]
    ds_read_b128 v[184:187], v2 offset:46080
    s_waitcnt lgkmcnt(13)
    s_nop 0
    v_mfma_f32_32x32x16_bf16 v[8:23], v[48:51], v[188:191], v[8:23]
    s_waitcnt vmcnt(4)
    s_nop 0
    ds_read_b64_tr_b16 v[168:169], v5 offset:1024
    ds_read_b64_tr_b16 v[170:171], v5 offset:1280
    s_waitcnt lgkmcnt(14)
    s_nop 0
    v_mfma_f32_32x32x16_bf16 v[8:23], v[52:55], v[192:195], v[8:23]
    s_waitcnt lgkmcnt(11)
    s_nop 0
    v_mfma_f32_32x32x16_bf16 v[8:23], v[132:135], v[56:59], v[8:23]
    s_waitcnt vmcnt(3)
    s_nop 0
    ds_read_b64_tr_b16 v[172:173], v5 offset:2048
    ds_read_b64_tr_b16 v[174:175], v5 offset:2304
    s_waitcnt lgkmcnt(12)
    s_nop 0
    v_mfma_f32_32x32x16_bf16 v[8:23], v[136:139], v[60:63], v[8:23]
    s_waitcnt lgkmcnt(9)
    s_nop 0
    v_mfma_f32_32x32x16_bf16 v[8:23], v[140:143], v[64:67], v[8:23]
    s_waitcnt vmcnt(2)
    s_nop 0
    ds_read_b64_tr_b16 v[176:177], v5 offset:3072
    ds_read_b64_tr_b16 v[178:179], v5 offset:3328
    s_waitcnt lgkmcnt(10)
    s_nop 0
    v_mfma_f32_32x32x16_bf16 v[8:23], v[144:147], v[68:71], v[8:23]
    s_waitcnt lgkmcnt(7)
    s_nop 0
    v_mfma_f32_32x32x16_bf16 v[8:23], v[84:87], v[180:183], v[8:23]
    s_waitcnt lgkmcnt(6)
    s_nop 0
    v_mfma_f32_32x32x16_bf16 v[8:23], v[88:91], v[184:187], v[8:23]
    s_barrier
    s_setprio 3
    ds_read_b128 v[56:59], v2 offset:0
    ds_read_b128 v[60:63], v2 offset:1024
    ds_read_b128 v[64:67], v2 offset:2048
    ds_read_b128 v[68:71], v2 offset:3072
    ds_read_b128 v[180:183], v2 offset:4096
    ds_read_b128 v[184:187], v2 offset:5120
    ds_read_b128 v[188:191], v2 offset:6144
    ds_read_b128 v[192:195], v2 offset:7168
    s_waitcnt lgkmcnt(7)
    s_nop 0
    v_mfma_f32_32x32x16_bf16 v[8:23], v[92:95], v[56:59], v[8:23]
    ds_read_b128 v[56:59], v2 offset:8192
    s_waitcnt lgkmcnt(7)
    s_nop 0
    v_mfma_f32_32x32x16_bf16 v[8:23], v[96:99], v[60:63], v[8:23]
    ds_read_b128 v[60:63], v2 offset:9216
    s_waitcnt lgkmcnt(7)
    s_nop 0
    v_mfma_f32_32x32x16_bf16 v[8:23], v[100:103], v[64:67], v[8:23]
    ds_read_b128 v[64:67], v2 offset:10240
    s_waitcnt lgkmcnt(7)
    s_nop 0
    v_mfma_f32_32x32x16_bf16 v[8:23], v[104:107], v[68:71], v[8:23]
    ds_read_b128 v[68:71], v2 offset:11264
    s_waitcnt lgkmcnt(7)
    s_nop 0
    v_mfma_f32_32x32x16_bf16 v[8:23], v[108:111], v[180:183], v[8:23]
    ds_read_b128 v[180:183], v2 offset:12288
    s_waitcnt lgkmcnt(7)
    s_nop 0
    v_mfma_f32_32x32x16_bf16 v[8:23], v[112:115], v[184:187], v[8:23]
    ds_read_b128 v[184:187], v2 offset:13312
    s_waitcnt lgkmcnt(7)
    s_nop 0
    v_mfma_f32_32x32x16_bf16 v[8:23], v[148:151], v[188:191], v[8:23]
    s_waitcnt lgkmcnt(6)
    s_nop 0
    v_mfma_f32_32x32x16_bf16 v[8:23], v[152:155], v[192:195], v[8:23]
    s_xor_b32 s61, s44, 1
    s_nop 0
    s_mul_i32 s61, s61, 28672
    s_add_u32 s61, s61, s53
    s_nop 0
    s_add_u32 m0, s53, 98304
    s_add_u32 s59, s61, 0x1203800
    buffer_load_dwordx4 v1, s[28:31], s59 offen offset:0 sc1 lds
    buffer_load_dwordx4 v1, s[28:31], s59 offen offset:1024 sc1 lds
    s_cmp_lt_u32 s50, 3
    s_cselect_b64 exec, -1, 0
    buffer_load_dwordx4 v1, s[28:31], s59 offen offset:2048 sc1 lds
    buffer_load_dwordx4 v1, s[28:31], s59 offen offset:3072 sc1 lds
    s_mov_b64 exec, -1
    s_waitcnt lgkmcnt(5)
    v_mfma_f32_32x32x16_bf16 v[8:23], v[156:159], v[56:59], v[8:23]
    s_waitcnt lgkmcnt(4)
    s_nop 0
    v_mfma_f32_32x32x16_bf16 v[8:23], v[160:163], v[60:63], v[8:23]
    s_waitcnt lgkmcnt(3)
    s_nop 0
    v_mfma_f32_32x32x16_bf16 v[8:23], v[164:167], v[64:67], v[8:23]
    s_waitcnt lgkmcnt(2)
    s_nop 0
    v_mfma_f32_32x32x16_bf16 v[8:23], v[168:171], v[68:71], v[8:23]
    s_xor_b32 s61, s44, 2
    s_and_b32 s61, s61, -2
    s_mul_i32 s61, s61, 28672
    s_add_u32 s61, s61, s53
    s_nop 0
    s_add_u32 m0, s53, 32768
    s_add_u32 s59, s61, 0x1203800
    buffer_load_dwordx4 v1, s[28:31], s59 offen offset:0 sc1 lds
    buffer_load_dwordx4 v1, s[28:31], s59 offen offset:1024 sc1 lds
    s_cmp_lt_u32 s50, 3
    s_cselect_b64 exec, -1, 0
    buffer_load_dwordx4 v1, s[28:31], s59 offen offset:2048 sc1 lds
    buffer_load_dwordx4 v1, s[28:31], s59 offen offset:3072 sc1 lds
    s_mov_b64 exec, -1
    s_waitcnt lgkmcnt(1)
    v_mfma_f32_32x32x16_bf16 v[8:23], v[172:175], v[180:183], v[8:23]
    s_waitcnt lgkmcnt(0)
    s_nop 0
    v_mfma_f32_32x32x16_bf16 v[8:23], v[176:179], v[184:187], v[8:23]
    s_nop 11
    s_nop 0
    ds_write_b128 v72, v[8:11] offset:47104
    ds_write_b128 v72, v[12:15] offset:48128
    ds_write_b128 v72, v[16:19] offset:49152
    ds_write_b128 v72, v[20:23] offset:50176
    s_waitcnt lgkmcnt(0)
    s_barrier
    s_setprio 1
    s_xor_b32 s61, s44, 2
    s_and_b32 s61, s61, -2
    s_or_b32 s61, s61, 1
    s_mul_i32 s61, s61, 28672
    s_add_u32 s61, s61, s53
    s_nop 0
    s_add_u32 m0, s53, 65536
    s_add_u32 s59, s61, 0x1203800
    buffer_load_dwordx4 v1, s[28:31], s59 offen offset:0 sc1 lds
    buffer_load_dwordx4 v1, s[28:31], s59 offen offset:1024 sc1 lds
    s_cmp_lt_u32 s50, 3
    s_cselect_b64 exec, -1, 0
    buffer_load_dwordx4 v1, s[28:31], s59 offen offset:2048 sc1 lds
    buffer_load_dwordx4 v1, s[28:31], s59 offen offset:3072 sc1 lds
    s_mov_b64 exec, -1
    s_cmp_lt_u32 s50, 3
    s_cselect_b32 s59, 2048, 0
    v_mov_b32 v74, v72
    v_add_u32 v75, s59, v72
    v_add_u32 v76, 0x10000, v74
    v_add_u32 v77, 0x10000, v75
    s_mov_b32 s67, 0
    s_waitcnt vmcnt(4)
    s_branch Lf_15
Lw_13:
    s_xor_b32 s61, s44, 1
    s_mul_i32 s61, s61, 28672
    s_add_u32 s61, s61, s53
    s_nop 0
    s_add_u32 m0, s53, 98304
    s_add_u32 s59, s61, 0x1203800
    buffer_load_dwordx4 v1, s[28:31], s59 offen offset:0 sc1 lds
    buffer_load_dwordx4 v1, s[28:31], s59 offen offset:1024 sc1 lds
    s_cmp_lt_u32 s50, 3
    s_cselect_b64 exec, -1, 0
    buffer_load_dwordx4 v1, s[28:31], s59 offen offset:2048 sc1 lds
    buffer_load_dwordx4 v1, s[28:31], s59 offen offset:3072 sc1 lds
    s_mov_b64 exec, -1
    s_xor_b32 s61, s44, 2
    s_and_b32 s61, s61, -2
    s_nop 0
    s_mul_i32 s61, s61, 28672
    s_add_u32 s61, s61, s53
    s_nop 0
    s_add_u32 m0, s53, 32768
    s_add_u32 s59, s61, 0x1203800
    buffer_load_dwordx4 v1, s[28:31], s59 offen offset:0 sc1 lds
    buffer_load_dwordx4 v1, s[28:31], s59 offen offset:1024 sc1 lds
    s_cmp_lt_u32 s50, 3
    s_cselect_b64 exec, -1, 0
    buffer_load_dwordx4 v1, s[28:31], s59 offen offset:2048 sc1 lds
    buffer_load_dwordx4 v1, s[28:31], s59 offen offset:3072 sc1 lds
    s_mov_b64 exec, -1
    s_add_u32 s67, s67, 1
    s_waitcnt vmcnt(0)
Lf_15:
    s_nop 0
    ds_read_b32 v8, v76 offset:32768
    ds_read_b32 v9, v76 offset:33792
    ds_read_b32 v10, v77 offset:32768
    ds_read_b32 v11, v77 offset:33792
    ds_read_b32 v12, v74 offset:32768
    ds_read_b32 v13, v74 offset:33792
    ds_read_b32 v14, v75 offset:32768
    ds_read_b32 v15, v75 offset:33792
    s_waitcnt lgkmcnt(0)
    v_max_u32 v252, v8, v9
    v_max3_u32 v252, v252, v10, v11
    v_max3_u32 v252, v252, v12, v13
    v_max3_u32 v252, v252, v14, v15
    v_cmp_eq_u32 vcc, -1, v252
    s_cbranch_vccz Lg_14
    s_cmp_lt_u32 s67, 1000000
    s_cbranch_scc1 Lw_13
Lg_14:
    s_mov_b32 s67, 0
    s_waitcnt vmcnt(0)
    s_branch Lf_18
Lw_16:
    s_xor_b32 s61, s44, 2
    s_and_b32 s61, s61, -2
    s_or_b32 s61, s61, 1
    s_nop 0
    s_mul_i32 s61, s61, 28672
    s_add_u32 s61, s61, s53
    s_nop 0
    s_add_u32 m0, s53, 65536
    s_add_u32 s59, s61, 0x1203800
    buffer_load_dwordx4 v1, s[28:31], s59 offen offset:0 sc1 lds
    buffer_load_dwordx4 v1, s[28:31], s59 offen offset:1024 sc1 lds
    s_cmp_lt_u32 s50, 3
    s_cselect_b64 exec, -1, 0
    buffer_load_dwordx4 v1, s[28:31], s59 offen offset:2048 sc1 lds
    buffer_load_dwordx4 v1, s[28:31], s59 offen offset:3072 sc1 lds
    s_mov_b64 exec, -1
    s_add_u32 s67, s67, 1
    s_waitcnt vmcnt(0)
Lf_18:
    s_nop 0
    ds_read_b32 v8, v76 offset:0
    ds_read_b32 v9, v76 offset:1024
    ds_read_b32 v10, v77 offset:0
    ds_read_b32 v11, v77 offset:1024
    s_waitcnt lgkmcnt(0)
    v_max_u32 v252, v8, v9
    v_max3_u32 v252, v252, v10, v11
    v_cmp_eq_u32 vcc, -1, v252
    s_cbranch_vccz Lg_17
    s_cmp_lt_u32 s67, 1000000
    s_cbranch_scc1 Lw_16
Lg_17:
    s_nop 0
    ds_read_b128 v[56:59], v2 offset:47104
    ds_read_b128 v[60:63], v2 offset:48128
    ds_read_b128 v[64:67], v2 offset:49152
    ds_read_b128 v[68:71], v2 offset:50176
    ds_read_b128 v[180:183], v2 offset:51200
    ds_read_b128 v[184:187], v2 offset:52224
    ds_read_b128 v[188:191], v2 offset:53248
    ds_read_b128 v[192:195], v2 offset:54272
    s_waitcnt lgkmcnt(7)
    s_nop 0
    v_mfma_f32_32x32x16_bf16 v[24:39], v[228:231], v[56:59], 0
    ds_read_b128 v[56:59], v2 offset:55296
    s_waitcnt lgkmcnt(7)
    s_nop 0
    v_mfma_f32_32x32x16_bf16 v[24:39], v[232:235], v[60:63], v[24:39]
    ds_read_b128 v[60:63], v2 offset:56320
    s_waitcnt lgkmcnt(7)
    s_nop 0
    v_mfma_f32_32x32x16_bf16 v[24:39], v[236:239], v[64:67], v[24:39]
    s_barrier
    s_nop 0
    ds_read_b128 v[64:67], v2 offset:57344
    s_waitcnt lgkmcnt(7)
    s_nop 0
    v_mfma_f32_32x32x16_bf16 v[24:39], v[240:243], v[68:71], v[24:39]
    ds_read_b128 v[68:71], v2 offset:58368
    s_waitcnt lgkmcnt(7)
    s_nop 0
    v_mfma_f32_32x32x16_bf16 v[24:39], v[40:43], v[180:183], v[24:39]
    ds_read_b128 v[180:183], v2 offset:59392
    s_waitcnt lgkmcnt(7)
    s_nop 0
    v_mfma_f32_32x32x16_bf16 v[24:39], v[44:47], v[184:187], v[24:39]
    ds_read_b128 v[184:187], v2 offset:60416
    s_waitcnt lgkmcnt(7)
    s_nop 0
    v_mfma_f32_32x32x16_bf16 v[24:39], v[48:51], v[188:191], v[24:39]
    s_waitcnt lgkmcnt(6)
    s_nop 0
    v_mfma_f32_32x32x16_bf16 v[24:39], v[52:55], v[192:195], v[24:39]
    s_waitcnt lgkmcnt(5)
    s_nop 0
    v_mfma_f32_32x32x16_bf16 v[24:39], v[132:135], v[56:59], v[24:39]
    s_waitcnt lgkmcnt(4)
    s_nop 0
    v_mfma_f32_32x32x16_bf16 v[24:39], v[136:139], v[60:63], v[24:39]
    s_waitcnt lgkmcnt(3)
    s_nop 0
    v_mfma_f32_32x32x16_bf16 v[24:39], v[140:143], v[64:67], v[24:39]
    s_waitcnt lgkmcnt(2)
    s_nop 0
    v_mfma_f32_32x32x16_bf16 v[24:39], v[144:147], v[68:71], v[24:39]
    s_waitcnt lgkmcnt(1)
    s_nop 0
    v_mfma_f32_32x32x16_bf16 v[24:39], v[84:87], v[180:183], v[24:39]
    s_waitcnt lgkmcnt(0)
    s_nop 0
    v_mfma_f32_32x32x16_bf16 v[24:39], v[88:91], v[184:187], v[24:39]
    ds_read_b128 v[56:59], v2 offset:32768
    ds_read_b128 v[60:63], v2 offset:33792
    ds_read_b128 v[64:67], v2 offset:34816
    ds_read_b128 v[68:71], v2 offset:35840
    ds_read_b128 v[180:183], v2 offset:36864
    ds_read_b128 v[184:187], v2 offset:37888
    ds_read_b128 v[188:191], v2 offset:38912
    ds_read_b128 v[192:195], v2 offset:39936
    s_waitcnt lgkmcnt(7)
    s_nop 0
    v_mfma_f32_32x32x16_bf16 v[24:39], v[92:95], v[56:59], v[24:39]
    ds_read_b128 v[56:59], v2 offset:40960
    s_waitcnt lgkmcnt(7)
    s_nop 0
    v_mfma_f32_32x32x16_bf16 v[24:39], v[96:99], v[60:63], v[24:39]
    ds_read_b128 v[60:63], v2 offset:41984
    s_waitcnt lgkmcnt(7)
    s_nop 0
    v_mfma_f32_32x32x16_bf16 v[24:39], v[100:103], v[64:67], v[24:39]
    ds_read_b128 v[64:67], v2 offset:43008
    s_waitcnt lgkmcnt(7)
    s_nop 0
    v_mfma_f32_32x32x16_bf16 v[24:39], v[104:107], v[68:71], v[24:39]
    ds_read_b128 v[68:71], v2 offset:44032
    s_waitcnt lgkmcnt(7)
    s_nop 0
    v_mfma_f32_32x32x16_bf16 v[24:39], v[108:111], v[180:183], v[24:39]
    ds_read_b128 v[180:183], v2 offset:45056
    s_waitcnt lgkmcnt(7)
    s_nop 0
    v_mfma_f32_32x32x16_bf16 v[24:39], v[112:115], v[184:187], v[24:39]
    ds_read_b128 v[184:187], v2 offset:46080
    s_waitcnt lgkmcnt(7)
    s_nop 0
    v_mfma_f32_32x32x16_bf16 v[24:39], v[148:151], v[188:191], v[24:39]
    s_waitcnt lgkmcnt(6)
    s_nop 0
    v_mfma_f32_32x32x16_bf16 v[24:39], v[152:155], v[192:195], v[24:39]
    s_waitcnt lgkmcnt(5)
    s_nop 0
    v_mfma_f32_32x32x16_bf16 v[24:39], v[156:159], v[56:59], v[24:39]
    s_waitcnt lgkmcnt(4)
    s_nop 0
    v_mfma_f32_32x32x16_bf16 v[24:39], v[160:163], v[60:63], v[24:39]
    s_waitcnt lgkmcnt(3)
    s_nop 0
    v_mfma_f32_32x32x16_bf16 v[24:39], v[164:167], v[64:67], v[24:39]
    s_waitcnt lgkmcnt(2)
    s_nop 0
    v_mfma_f32_32x32x16_bf16 v[24:39], v[168:171], v[68:71], v[24:39]
    s_waitcnt lgkmcnt(1)
    s_nop 0
    v_mfma_f32_32x32x16_bf16 v[24:39], v[172:175], v[180:183], v[24:39]
    s_waitcnt lgkmcnt(0)
    s_nop 0
    v_mfma_f32_32x32x16_bf16 v[24:39], v[176:179], v[184:187], v[24:39]
    s_nop 11
    s_nop 0
    ds_write_b128 v72, v[24:27] offset:47104
    ds_write_b128 v72, v[28:31] offset:48128
    ds_write_b128 v72, v[32:35] offset:49152
    ds_write_b128 v72, v[36:39] offset:50176
    s_waitcnt lgkmcnt(0)
    s_barrier
    s_branch L_join
L_fin:
    s_lshl_b32 s75, s50, 13
    s_add_u32 s59, s75, 0x8000
    v_add_u32 v82, s59, v1
    s_lshl_b32 s57, s47, 15
    s_add_u32 s57, s57, s75
    v_lshlrev_b32 v8, 16, v244
    v_and_b32 v9, 0xffff0000, v244
    v_lshlrev_b32_e64 v10, 16, v245
    v_and_b32 v11, 0xffff0000, v245
    v_lshlrev_b32_e64 v12, 16, v246
    v_and_b32 v13, 0xffff0000, v246
    v_lshlrev_b32_e64 v14, 16, v247
    v_and_b32 v15, 0xffff0000, v247
    v_lshlrev_b32_e64 v16, 16, v248
    v_and_b32 v17, 0xffff0000, v248
    v_lshlrev_b32_e64 v18, 16, v249
    v_and_b32 v19, 0xffff0000, v249
    v_lshlrev_b32_e64 v20, 16, v250
    v_and_b32 v21, 0xffff0000, v250
    v_lshlrev_b32_e64 v22, 16, v251
    v_and_b32 v23, 0xffff0000, v251
    v_lshlrev_b32_e64 v249, 7, v0
    s_add_u32 s68, s57, 0x400000
    s_add_u32 s41, s68, 4096
    s_waitcnt vmcnt(0)
    s_nop 0
    s_add_u32 m0, s75, 65536
    s_nop 0
    s_nop 0
    buffer_load_dwordx4 v1, s[28:31], s68 offen offset:0 sc1 lds
    buffer_load_dwordx4 v1, s[28:31], s68 offen offset:1024 sc1 lds
    buffer_load_dwordx4 v1, s[28:31], s68 offen offset:2048 sc1 lds
    buffer_load_dwordx4 v1, s[28:31], s68 offen offset:3072 sc1 lds
    s_add_u32 m0, s75, 69632
    s_nop 0
    s_nop 0
    buffer_load_dwordx4 v1, s[28:31], s41 offen offset:0 sc1 lds
    buffer_load_dwordx4 v1, s[28:31], s41 offen offset:1024 sc1 lds
    buffer_load_dwordx4 v1, s[28:31], s41 offen offset:2048 sc1 lds
    buffer_load_dwordx4 v1, s[28:31], s41 offen offset:3072 sc1 lds
    ds_read_b64_tr_b16 v[40:41], v5 offset:0
    ds_read_b64_tr_b16 v[42:43], v5 offset:256
    ds_read_b64_tr_b16 v[44:45], v5 offset:1024
    ds_read_b64_tr_b16 v[46:47], v5 offset:1280
    ds_read_b64_tr_b16 v[48:49], v5 offset:2048
    ds_read_b64_tr_b16 v[50:51], v5 offset:2304
    ds_read_b64_tr_b16 v[52:53], v5 offset:3072
    ds_read_b64_tr_b16 v[54:55], v5 offset:3328
    v_dot2_f32_bf16 v83, v148, v7, 0
    v_dot2_f32_bf16 v83, v149, v7, v83
    v_dot2_f32_bf16 v83, v150, v7, v83
    v_dot2_f32_bf16 v83, v151, v7, v83
    v_dot2_f32_bf16 v83, v152, v7, v83
    v_dot2_f32_bf16 v83, v153, v7, v83
    v_dot2_f32_bf16 v83, v154, v7, v83
    v_dot2_f32_bf16 v83, v155, v7, v83
    v_dot2_f32_bf16 v83, v156, v7, v83
    v_dot2_f32_bf16 v83, v157, v7, v83
    v_dot2_f32_bf16 v83, v158, v7, v83
    v_dot2_f32_bf16 v83, v159, v7, v83
    v_dot2_f32_bf16 v83, v160, v7, v83
    v_dot2_f32_bf16 v83, v161, v7, v83
    v_dot2_f32_bf16 v83, v162, v7, v83
    v_dot2_f32_bf16 v83, v163, v7, v83
    v_dot2_f32_bf16 v83, v164, v7, v83
    v_dot2_f32_bf16 v83, v165, v7, v83
    v_dot2_f32_bf16 v83, v166, v7, v83
    v_dot2_f32_bf16 v83, v167, v7, v83
    v_dot2_f32_bf16 v83, v168, v7, v83
    v_dot2_f32_bf16 v83, v169, v7, v83
    v_dot2_f32_bf16 v83, v170, v7, v83
    v_dot2_f32_bf16 v83, v171, v7, v83
    v_dot2_f32_bf16 v83, v172, v7, v83
    v_dot2_f32_bf16 v83, v173, v7, v83
    v_dot2_f32_bf16 v83, v174, v7, v83
    v_dot2_f32_bf16 v83, v175, v7, v83
    v_dot2_f32_bf16 v83, v176, v7, v83
    v_dot2_f32_bf16 v83, v177, v7, v83
    v_dot2_f32_bf16 v83, v178, v7, v83
    v_dot2_f32_bf16 v83, v179, v7, v83
    v_dot2_f32_bf16 v83, v180, v7, v83
    v_dot2_f32_bf16 v83, v181, v7, v83
    v_dot2_f32_bf16 v83, v182, v7, v83
    v_dot2_f32_bf16 v83, v183, v7, v83
    v_dot2_f32_bf16 v83, v184, v7, v83
    v_dot2_f32_bf16 v83, v185, v7, v83
    v_dot2_f32_bf16 v83, v186, v7, v83
    v_dot2_f32_bf16 v83, v187, v7, v83
    v_dot2_f32_bf16 v83, v188, v7, v83
    v_dot2_f32_bf16 v83, v189, v7, v83
    v_dot2_f32_bf16 v83, v190, v7, v83
    v_dot2_f32_bf16 v83, v191, v7, v83
    v_dot2_f32_bf16 v83, v192, v7, v83
    v_dot2_f32_bf16 v83, v193, v7, v83
    v_dot2_f32_bf16 v83, v194, v7, v83
    v_dot2_f32_bf16 v83, v195, v7, v83
    v_dot2_f32_bf16 v83, v196, v7, v83
    v_dot2_f32_bf16 v83, v197, v7, v83
    v_dot2_f32_bf16 v83, v198, v7, v83
    v_dot2_f32_bf16 v83, v199, v7, v83
    v_dot2_f32_bf16 v83, v200, v7, v83
    v_dot2_f32_bf16 v83, v201, v7, v83
    v_dot2_f32_bf16 v83, v202, v7, v83
    v_dot2_f32_bf16 v83, v203, v7, v83
    v_dot2_f32_bf16 v83, v204, v7, v83
    v_dot2_f32_bf16 v83, v205, v7, v83
    v_dot2_f32_bf16 v83, v206, v7, v83
    v_dot2_f32_bf16 v83, v207, v7, v83
    v_dot2_f32_bf16 v83, v208, v7, v83
    v_dot2_f32_bf16 v83, v209, v7, v83
    v_dot2_f32_bf16 v83, v210, v7, v83
    v_dot2_f32_bf16 v83, v211, v7, v83
    s_lshr_b32 s59, s50, 1
    s_add_u32 s59, s59, 1
    s_sub_u32 s60, 0, s59
    s_bitcmp1_b32 s50, 0
    s_cselect_b32 s59, s59, s60
    s_lshl_b32 s60, s47, 5
    s_add_u32 s59, s59, s60
    v_and_b32 v251, 31, v0
    v_add_u32 v251, s59, v251
    v_ashrrev_i32 v254, 5, v251
    v_lshlrev_b32 v254, 15, v254
    v_and_b32 v251, 31, v251
    v_lshl_add_u32 v251, v251, 4, v254
    v_and_b32_e64 v254, 32, v0
    v_lshl_add_u32 v251, v254, 4, v251
    v_min_u32 v251, 0x7fff0000, v251
    s_bitcmp1_b32 s50, 0
    s_cselect_b32 s59, 31, 0
    s_nop 3
    s_nop 0
    v_readlane_b32 s60, v251, s59
    v_and_b32 v250, 60, v0
    v_lshlrev_b32 v250, 7, v250
    v_add_u32 v250, s60, v250
    s_lshl_b32 s59, s50, 8
    s_add_u32 s59, s59, 114688
    v_lshlrev_b32 v253, 2, v0
    v_add_u32 v253, s59, v253
    ds_write_b32 v253, v83
    s_mov_b32 s67, 0
    s_waitcnt vmcnt(0) lgkmcnt(0)
    s_branch Lf_21
Lw_19:
    s_nop 0
    s_add_u32 m0, s75, 65536
    s_nop 0
    s_nop 0
    buffer_load_dwordx4 v1, s[28:31], s68 offen offset:0 sc1 lds
    buffer_load_dwordx4 v1, s[28:31], s68 offen offset:1024 sc1 lds
    buffer_load_dwordx4 v1, s[28:31], s68 offen offset:2048 sc1 lds
    buffer_load_dwordx4 v1, s[28:31], s68 offen offset:3072 sc1 lds
    s_add_u32 m0, s75, 69632
    s_nop 0
    s_nop 0
    buffer_load_dwordx4 v1, s[28:31], s41 offen offset:0 sc1 lds
    buffer_load_dwordx4 v1, s[28:31], s41 offen offset:1024 sc1 lds
    buffer_load_dwordx4 v1, s[28:31], s41 offen offset:2048 sc1 lds
    buffer_load_dwordx4 v1, s[28:31], s41 offen offset:3072 sc1 lds
    s_add_u32 s67, s67, 1
    s_waitcnt vmcnt(0)
Lf_21:
    ds_read_b32 v24, v82 offset:32768
    ds_read_b32 v25, v82 offset:33792
    ds_read_b32 v26, v82 offset:34816
    ds_read_b32 v27, v82 offset:35840
    ds_read_b32 v28, v82 offset:36864
    ds_read_b32 v29, v82 offset:37888
    ds_read_b32 v30, v82 offset:38912
    ds_read_b32 v31, v82 offset:39936
    s_waitcnt lgkmcnt(0)
    v_max_u32 v252, v24, v25
    v_max3_u32 v252, v252, v26, v27
    v_max3_u32 v252, v252, v28, v29
    v_max3_u32 v252, v252, v30, v31
    v_cmp_eq_u32 vcc, -1, v252
    s_cbranch_vccz Lg_20
    s_cmp_lt_u32 s67, 1000000
    s_cbranch_scc1 Lw_19
Lg_20:
    s_setprio 2
    s_barrier
    s_add_u32 s74, s43, 1
    s_and_b32 s74, s74, 7
    s_mul_i32 s74, s74, s71
    s_lshl_b32 s74, s74, 2
    s_add_u32 s74, s74, s55
    s_add_u32 m0, s53, 131072
    s_nop 0
    s_nop 0
    buffer_load_dwordx4 v6, s[20:23], s74 offen lds
    s_add_u32 m0, s53, 132096
    s_add_u32 s74, s74, s71
    s_nop 0
    buffer_load_dwordx4 v6, s[20:23], s74 offen lds
    s_add_u32 m0, s53, 133120
    s_add_u32 s74, s74, s71
    s_nop 0
    buffer_load_dwordx4 v6, s[20:23], s74 offen lds
    s_add_u32 m0, s53, 134144
    s_add_u32 s74, s74, s71
    s_nop 0
    buffer_load_dwordx4 v6, s[20:23], s74 offen lds
    ds_read_b128 v[56:59], v2 offset:16384
    ds_read_b128 v[60:63], v2 offset:17408
    ds_read_b128 v[64:67], v2 offset:18432
    ds_read_b128 v[68:71], v2 offset:19456
    ds_read_b128 v[24:27], v2 offset:20480
    ds_read_b128 v[28:31], v2 offset:21504
    ds_read_b128 v[32:35], v2 offset:22528
    ds_read_b128 v[36:39], v2 offset:23552
    s_waitcnt lgkmcnt(7)
    s_nop 0
    v_mfma_f32_32x32x16_bf16 v[8:23], v[84:87], v[56:59], v[8:23]
    ds_read_b128 v[56:59], v2 offset:24576
    s_waitcnt lgkmcnt(7)
    s_nop 0
    v_mfma_f32_32x32x16_bf16 v[8:23], v[88:91], v[60:63], v[8:23]
    ds_read_b128 v[60:63], v2 offset:25600
    s_waitcnt lgkmcnt(7)
    s_nop 0
    v_mfma_f32_32x32x16_bf16 v[8:23], v[92:95], v[64:67], v[8:23]
    ds_read_b128 v[64:67], v2 offset:26624
    s_waitcnt lgkmcnt(7)
    s_nop 0
    v_mfma_f32_32x32x16_bf16 v[8:23], v[96:99], v[68:71], v[8:23]
    ds_read_b128 v[68:71], v2 offset:27648
    s_waitcnt lgkmcnt(7)
    s_nop 0
    v_mfma_f32_32x32x16_bf16 v[8:23], v[100:103], v[24:27], v[8:23]
    ds_read_b128 v[24:27], v2 offset:28672
    s_waitcnt lgkmcnt(7)
    s_nop 0
    v_mfma_f32_32x32x16_bf16 v[8:23], v[104:107], v[28:31], v[8:23]
    ds_read_b128 v[28:31], v2 offset:29696
    s_waitcnt lgkmcnt(7)
    s_nop 0
    v_mfma_f32_32x32x16_bf16 v[8:23], v[108:111], v[32:35], v[8:23]
    ds_read_b128 v[32:35], v2 offset:30720
    s_waitcnt lgkmcnt(7)
    s_nop 0
    v_mfma_f32_32x32x16_bf16 v[8:23], v[112:115], v[36:39], v[8:23]
    ds_read_b128 v[36:39], v2 offset:31744
    s_waitcnt lgkmcnt(7)
    s_nop 0
    v_mfma_f32_32x32x16_bf16 v[8:23], v[116:119], v[56:59], v[8:23]
    s_waitcnt lgkmcnt(6)
    s_nop 0
    v_mfma_f32_32x32x16_bf16 v[8:23], v[120:123], v[60:63], v[8:23]
    s_waitcnt lgkmcnt(5)
    s_nop 0
    v_mfma_f32_32x32x16_bf16 v[8:23], v[124:127], v[64:67], v[8:23]
    s_waitcnt lgkmcnt(4)
    s_nop 0
    v_mfma_f32_32x32x16_bf16 v[8:23], v[128:131], v[68:71], v[8:23]
    s_waitcnt lgkmcnt(3)
    s_nop 0
    v_mfma_f32_32x32x16_bf16 v[8:23], v[132:135], v[24:27], v[8:23]
    s_lshl_b32 s59, s50, 12
    v_add_u32 v253, s59, v2
    s_waitcnt lgkmcnt(0)
    s_barrier
    ds_read_b128 v[56:59], v253 offset:32768
    ds_read_b128 v[60:63], v253 offset:33792
    ds_read_b128 v[64:67], v253 offset:34816
    ds_read_b128 v[68:71], v253 offset:35840
    v_mfma_f32_32x32x16_bf16 v[8:23], v[136:139], v[28:31], v[8:23]
    v_mfma_f32_32x32x16_bf16 v[8:23], v[140:143], v[32:35], v[8:23]
    v_mfma_f32_32x32x16_bf16 v[8:23], v[144:147], v[36:39], v[8:23]
    s_waitcnt lgkmcnt(0)
    s_nop 10
    v_pk_add_f32 v[8:9], v[8:9], v[56:57]
    v_pk_add_f32 v[10:11], v[10:11], v[58:59]
    v_pk_add_f32 v[12:13], v[12:13], v[60:61]
    v_pk_add_f32 v[14:15], v[14:15], v[62:63]
    v_pk_add_f32 v[16:17], v[16:17], v[64:65]
    v_pk_add_f32 v[18:19], v[18:19], v[66:67]
    v_pk_add_f32 v[20:21], v[20:21], v[68:69]
    v_pk_add_f32 v[22:23], v[22:23], v[70:71]
    v_cvt_pk_bf16_f32 v72, v8, v9
    v_cvt_pk_bf16_f32 v73, v10, v11
    v_cvt_pk_bf16_f32 v74, v12, v13
    v_cvt_pk_bf16_f32 v75, v14, v15
    v_min_u32_e64 v72, -2, v72
    v_cvt_pk_bf16_f32 v76, v16, v17
    v_cvt_pk_bf16_f32 v77, v18, v19
    v_cvt_pk_bf16_f32 v78, v20, v21
    v_cvt_pk_bf16_f32 v79, v22, v23
    v_min_u32_e64 v76, -2, v76
    s_add_u32 s60, s58, 0x600000
    s_cmp_eq_u32 s64, 1
    s_cbranch_scc1 Lp_22
    buffer_store_dwordx4 v[72:75], v1, s[28:31], s60 offen offset:0 sc1
    buffer_store_dwordx4 v[76:79], v1, s[28:31], s60 offen offset:1024 sc1
    s_branch Lq_23
Lp_22:
    s_nop 0
    buffer_store_dwordx4 v[72:75], v1, s[28:31], s60 offen offset:0
    buffer_store_dwordx4 v[76:79], v1, s[28:31], s60 offen offset:1024
Lq_23:
    s_add_u32 s68, s57, 0x600000
    s_add_u32 s41, s68, 4096
    v_mul_f32 v255, v8, v8
    v_add_f32 v254, v8, v9
    v_fmac_f32 v255, v9, v9
    v_fmac_f32 v255, v10, v10
    v_add_f32 v254, v254, v10
    v_fmac_f32 v255, v11, v11
    v_add_f32 v254, v254, v11
    v_fmac_f32 v255, v12, v12
    v_add_f32 v254, v254, v12
    v_fmac_f32 v255, v13, v13
    v_add_f32 v254, v254, v13
    v_fmac_f32 v255, v14, v14
    v_add_f32 v254, v254, v14
    v_fmac_f32 v255, v15, v15
    v_add_f32 v254, v254, v15
    v_fmac_f32 v255, v16, v16
    v_add_f32 v254, v254, v16
    v_fmac_f32 v255, v17, v17
    v_add_f32 v254, v254, v17
    v_fmac_f32 v255, v18, v18
    v_add_f32 v254, v254, v18
    v_fmac_f32 v255, v19, v19
    v_add_f32 v254, v254, v19
    v_fmac_f32 v255, v20, v20
    v_add_f32 v254, v254, v20
    v_fmac_f32 v255, v21, v21
    v_add_f32 v254, v254, v21
    v_fmac_f32 v255, v22, v22
    v_add_f32 v254, v254, v22
    v_fmac_f32 v255, v23, v23
    v_add_f32 v254, v254, v23
    s_lshl_b32 s59, s50, 2
    s_add_u32 s59, s59, s42
    v_permlane32_swap_b32 v254, v255
    s_add_u32 s59, s59, 0xd00000
    v_add_f32 v254, v254, v255
    v_min_u32 v254, -2, v254
    s_cmp_eq_u32 s64, 1
    s_cbranch_scc1 Lp_24
    buffer_store_dword v254, v1, s[28:31], s59 offen sc1
    s_branch Lq_25
Lp_24:
    s_nop 0
    buffer_store_dword v254, v1, s[28:31], s59 offen
Lq_25:
    s_waitcnt vmcnt(1)
    s_nop 0
    s_add_u32 m0, s75, 65536
    s_nop 0
    s_nop 0
    buffer_load_dwordx4 v1, s[28:31], s68 offen offset:0 sc1 lds
    buffer_load_dwordx4 v1, s[28:31], s68 offen offset:1024 sc1 lds
    buffer_load_dwordx4 v1, s[28:31], s68 offen offset:2048 sc1 lds
    buffer_load_dwordx4 v1, s[28:31], s68 offen offset:3072 sc1 lds
    s_add_u32 m0, s75, 69632
    s_nop 0
    s_nop 0
    buffer_load_dwordx4 v1, s[28:31], s41 offen offset:0 sc1 lds
    buffer_load_dwordx4 v1, s[28:31], s41 offen offset:1024 sc1 lds
    buffer_load_dwordx4 v1, s[28:31], s41 offen offset:2048 sc1 lds
    buffer_load_dwordx4 v1, s[28:31], s41 offen offset:3072 sc1 lds
    ds_read_b64_tr_b16 v[100:101], v5 offset:0
    ds_read_b64_tr_b16 v[102:103], v5 offset:256
    ds_read_b64_tr_b16 v[104:105], v5 offset:1024
    ds_read_b64_tr_b16 v[106:107], v5 offset:1280
    ds_read_b64_tr_b16 v[108:109], v5 offset:2048
    ds_read_b64_tr_b16 v[110:111], v5 offset:2304
    ds_read_b64_tr_b16 v[112:113], v5 offset:3072
    ds_read_b64_tr_b16 v[114:115], v5 offset:3328
    ds_read_b64_tr_b16 v[84:85], v4 offset:0
    ds_read_b64_tr_b16 v[86:87], v4 offset:256
    ds_read_b64_tr_b16 v[88:89], v4 offset:1024
    ds_read_b64_tr_b16 v[90:91], v4 offset:1280
    ds_read_b64_tr_b16 v[92:93], v4 offset:2048
    ds_read_b64_tr_b16 v[94:95], v4 offset:2304
    ds_read_b64_tr_b16 v[96:97], v4 offset:3072
    ds_read_b64_tr_b16 v[98:99], v4 offset:3328
    ds_read_b64_tr_b16 v[132:133], v4 offset:32768
    ds_read_b64_tr_b16 v[134:135], v4 offset:33024
    ds_read_b64_tr_b16 v[136:137], v4 offset:33792
    ds_read_b64_tr_b16 v[138:139], v4 offset:34048
    ds_read_b64_tr_b16 v[140:141], v4 offset:34816
    ds_read_b64_tr_b16 v[142:143], v4 offset:35072
    ds_read_b64_tr_b16 v[144:145], v4 offset:35840
    ds_read_b64_tr_b16 v[146:147], v4 offset:36096
    s_waitcnt lgkmcnt(0)
    s_add_u32 s74, s43, 2
    s_and_b32 s74, s74, 7
    s_mul_i32 s74, s74, s71
    s_lshl_b32 s74, s74, 2
    s_add_u32 s74, s74, s55
    s_add_u32 m0, s53, 131072
    s_nop 0
    s_nop 0
    buffer_load_dwordx4 v6, s[20:23], s74 offen lds
    s_add_u32 m0, s53, 132096
    s_add_u32 s74, s74, s71
    s_nop 0
    buffer_load_dwordx4 v6, s[20:23], s74 offen lds
    s_add_u32 m0, s53, 133120
    s_add_u32 s74, s74, s71
    s_nop 0
    buffer_load_dwordx4 v6, s[20:23], s74 offen lds
    s_add_u32 m0, s53, 134144
    s_add_u32 s74, s74, s71
    s_nop 0
    buffer_load_dwordx4 v6, s[20:23], s74 offen lds
    s_mov_b32 s67, 0
    s_waitcnt vmcnt(4)
    s_branch Lf_28
Lw_26:
    s_nop 0
    s_add_u32 m0, s75, 65536
    s_nop 0
    s_nop 0
    buffer_load_dwordx4 v1, s[28:31], s68 offen offset:0 sc1 lds
    buffer_load_dwordx4 v1, s[28:31], s68 offen offset:1024 sc1 lds
    buffer_load_dwordx4 v1, s[28:31], s68 offen offset:2048 sc1 lds
    buffer_load_dwordx4 v1, s[28:31], s68 offen offset:3072 sc1 lds
    s_add_u32 m0, s75, 69632
    s_nop 0
    s_nop 0
    buffer_load_dwordx4 v1, s[28:31], s41 offen offset:0 sc1 lds
    buffer_load_dwordx4 v1, s[28:31], s41 offen offset:1024 sc1 lds
    buffer_load_dwordx4 v1, s[28:31], s41 offen offset:2048 sc1 lds
    buffer_load_dwordx4 v1, s[28:31], s41 offen offset:3072 sc1 lds
    s_add_u32 s67, s67, 1
    s_waitcnt vmcnt(0)
Lf_28:
    ds_read_b32 v24, v82 offset:32768
    ds_read_b32 v25, v82 offset:33792
    ds_read_b32 v26, v82 offset:34816
    ds_read_b32 v27, v82 offset:35840
    ds_read_b32 v28, v82 offset:36864
    ds_read_b32 v29, v82 offset:37888
    ds_read_b32 v30, v82 offset:38912
    ds_read_b32 v31, v82 offset:39936
    s_waitcnt lgkmcnt(0)
    v_max_u32 v252, v24, v25
    v_max3_u32 v252, v252, v26, v27
    v_max3_u32 v252, v252, v28, v29
    v_max3_u32 v252, v252, v30, v31
    v_cmp_eq_u32 vcc, -1, v252
    s_cbranch_vccz Lg_27
    s_cmp_lt_u32 s67, 1000000
    s_cbranch_scc1 Lw_26
Lg_27:
    s_setprio 2
    s_barrier
    s_add_u32 s74, s43, 3
    s_and_b32 s74, s74, 7
    s_mul_i32 s74, s74, s71
    s_lshl_b32 s74, s74, 2
    s_add_u32 s74, s74, s55
    s_add_u32 m0, s53, 0
    s_nop 0
    buffer_load_dwordx4 v6, s[20:23], s74 offen lds
    s_add_u32 m0, s53, 1024
    s_add_u32 s74, s74, s71
    s_nop 0
    buffer_load_dwordx4 v6, s[20:23], s74 offen lds
    s_add_u32 m0, s53, 2048
    s_add_u32 s74, s74, s71
    s_nop 0
    buffer_load_dwordx4 v6, s[20:23], s74 offen lds
    s_add_u32 m0, s53, 3072
    s_add_u32 s74, s74, s71
    s_nop 0
    buffer_load_dwordx4 v6, s[20:23], s74 offen lds
    s_add_u32 s74, s43, 4
    s_and_b32 s74, s74, 7
    s_mul_i32 s74, s74, s71
    s_lshl_b32 s74, s74, 2
    s_add_u32 s74, s74, s55
    s_nop 0
    s_add_u32 m0, s53, 32768
    s_nop 0
    s_nop 0
    buffer_load_dwordx4 v6, s[20:23], s74 offen lds
    s_add_u32 m0, s53, 33792
    s_add_u32 s74, s74, s71
    s_nop 0
    buffer_load_dwordx4 v6, s[20:23], s74 offen lds
    s_add_u32 m0, s53, 34816
    s_add_u32 s74, s74, s71
    s_nop 0
    buffer_load_dwordx4 v6, s[20:23], s74 offen lds
    s_add_u32 m0, s53, 35840
    s_add_u32 s74, s74, s71
    s_nop 0
    buffer_load_dwordx4 v6, s[20:23], s74 offen lds
    ds_read_b128 v[56:59], v2 offset:16384
    ds_read_b128 v[60:63], v2 offset:17408
    ds_read_b128 v[64:67], v2 offset:18432
    ds_read_b128 v[68:71], v2 offset:19456
    ds_read_b128 v[24:27], v2 offset:20480
    ds_read_b128 v[28:31], v2 offset:21504
    ds_read_b128 v[32:35], v2 offset:22528
    ds_read_b128 v[36:39], v2 offset:23552
    s_waitcnt lgkmcnt(7)
    s_nop 0
    v_mfma_f32_32x32x16_bf16 v[8:23], v[148:151], v[56:59], 0
    ds_read_b128 v[56:59], v2 offset:24576
    s_waitcnt lgkmcnt(7)
    s_nop 0
    v_mfma_f32_32x32x16_bf16 v[8:23], v[152:155], v[60:63], v[8:23]
    ds_read_b128 v[60:63], v2 offset:25600
    s_waitcnt lgkmcnt(7)
    s_nop 0
    v_mfma_f32_32x32x16_bf16 v[8:23], v[156:159], v[64:67], v[8:23]
    ds_read_b128 v[64:67], v2 offset:26624
    ds_read_b128 v[116:119], v2 offset:61440
    s_waitcnt lgkmcnt(8)
    s_nop 0
    v_mfma_f32_32x32x16_bf16 v[8:23], v[160:163], v[68:71], v[8:23]
    ds_read_b128 v[68:71], v2 offset:27648
    s_waitcnt lgkmcnt(8)
    s_nop 0
    v_mfma_f32_32x32x16_bf16 v[8:23], v[164:167], v[24:27], v[8:23]
    ds_read_b128 v[24:27], v2 offset:28672
    s_waitcnt lgkmcnt(2)
    v_add_f32 v116, v116, v117
    v_add_f32 v118, v118, v119
    v_add_f32 v116, v116, v118
    v_mul_f32 v116, 0x3b000000, v116
    v_mov_b32_e64 v117, v116
    v_mfma_f32_32x32x16_bf16 v[8:23], v[168:171], v[28:31], v[8:23]
    ds_read_b128 v[28:31], v2 offset:29696
    s_nop 1
    v_permlane32_swap_b32 v116, v117
    v_mov_b32_e64 v247, v116
    v_fma_f32 v117, -v116, v116, v117
    v_mfma_f32_32x32x16_bf16 v[8:23], v[172:175], v[32:35], v[8:23]
    ds_read_b128 v[32:35], v2 offset:30720
    v_max_f32_e64 v117, 0, v117
    v_add_f32 v118, 0x3727c5ac, v117
    v_rsq_f32 v118, v118
    s_nop 0
    v_mov_b32 v80, v116
    v_mov_b32 v81, v118
    v_mul_f32 v117, v117, v118
    v_mul_f32 v117, v117, v118
    v_add_f32 v117, 0x3727c5ac, v117
    v_rsq_f32 v117, v117
    s_nop 0
    v_mul_f32_e64 v118, v118, v117
    v_mfma_f32_32x32x16_bf16 v[8:23], v[176:179], v[36:39], v[8:23]
    ds_read_b128 v[36:39], v2 offset:31744
    v_rcp_f32_e64 v246, v118
    v_mul_f32 v244, 0xc0135761, v118
    v_mul_f32 v117, v118, v118
    v_mul_f32 v117, v117, v118
    v_mul_f32 v245, 0xbdd2d3e8, v117
    v_mfma_f32_32x32x16_bf16 v[8:23], v[180:183], v[56:59], v[8:23]
    v_mfma_f32_32x32x16_bf16 v[8:23], v[184:187], v[60:63], v[8:23]
    v_mfma_f32_32x32x16_bf16 v[8:23], v[188:191], v[64:67], v[8:23]
    s_waitcnt lgkmcnt(4)
    s_nop 0
    v_mfma_f32_32x32x16_bf16 v[8:23], v[192:195], v[68:71], v[8:23]
    s_waitcnt lgkmcnt(3)
    s_nop 0
    v_mfma_f32_32x32x16_bf16 v[8:23], v[196:199], v[24:27], v[8:23]
    s_lshl_b32 s59, s50, 12
    v_add_u32 v253, s59, v2
    s_waitcnt lgkmcnt(0)
    s_barrier
    ds_read_b128 v[56:59], v253 offset:32768
    ds_read_b128 v[60:63], v253 offset:33792
    ds_read_b128 v[64:67], v253 offset:34816
    ds_read_b128 v[68:71], v253 offset:35840
    v_mfma_f32_32x32x16_bf16 v[8:23], v[200:203], v[28:31], v[8:23]
    v_mfma_f32_32x32x16_bf16 v[8:23], v[204:207], v[32:35], v[8:23]
    v_mfma_f32_32x32x16_bf16 v[8:23], v[208:211], v[36:39], v[8:23]
    s_waitcnt lgkmcnt(0)
    s_nop 10
    v_pk_add_f32 v[8:9], v[8:9], v[56:57]
    v_pk_add_f32 v[10:11], v[10:11], v[58:59]
    v_pk_add_f32 v[12:13], v[12:13], v[60:61]
    v_pk_add_f32 v[14:15], v[14:15], v[62:63]
    v_pk_add_f32 v[16:17], v[16:17], v[64:65]
    v_pk_add_f32 v[18:19], v[18:19], v[66:67]
    v_pk_add_f32 v[20:21], v[20:21], v[68:69]
    v_pk_add_f32 v[22:23], v[22:23], v[70:71]
    v_pk_mul_f32 v[56:57], v[8:9], v[8:9]
    v_pk_mul_f32 v[58:59], v[10:11], v[10:11]
    v_pk_mul_f32 v[60:61], v[12:13], v[12:13]
    v_pk_mul_f32 v[62:63], v[14:15], v[14:15]
    v_pk_mul_f32 v[64:65], v[16:17], v[16:17]
    v_pk_mul_f32 v[66:67], v[18:19], v[18:19]
    v_pk_mul_f32 v[68:69], v[20:21], v[20:21]
    v_pk_mul_f32 v[70:71], v[22:23], v[22:23]
    v_pk_fma_f32 v[56:57], v[56:57], v[244:245], v[244:245] op_sel:[0,1,0] op_sel_hi:[1,1,0]
    v_pk_fma_f32 v[58:59], v[58:59], v[244:245], v[244:245] op_sel:[0,1,0] op_sel_hi:[1,1,0]
    v_pk_fma_f32 v[60:61], v[60:61], v[244:245], v[244:245] op_sel:[0,1,0] op_sel_hi:[1,1,0]
    v_pk_fma_f32 v[62:63], v[62:63], v[244:245], v[244:245] op_sel:[0,1,0] op_sel_hi:[1,1,0]
    v_pk_fma_f32 v[64:65], v[64:65], v[244:245], v[244:245] op_sel:[0,1,0] op_sel_hi:[1,1,0]
    v_pk_fma_f32 v[66:67], v[66:67], v[244:245], v[244:245] op_sel:[0,1,0] op_sel_hi:[1,1,0]
    v_pk_fma_f32 v[68:69], v[68:69], v[244:245], v[244:245] op_sel:[0,1,0] op_sel_hi:[1,1,0]
    v_pk_fma_f32 v[70:71], v[70:71], v[244:245], v[244:245] op_sel:[0,1,0] op_sel_hi:[1,1,0]
    v_pk_mul_f32 v[56:57], v[56:57], v[8:9]
    v_pk_mul_f32 v[58:59], v[58:59], v[10:11]
    v_pk_mul_f32 v[60:61], v[60:61], v[12:13]
    v_pk_mul_f32 v[62:63], v[62:63], v[14:15]
    v_pk_mul_f32 v[64:65], v[64:65], v[16:17]
    v_pk_mul_f32 v[66:67], v[66:67], v[18:19]
    v_pk_mul_f32 v[68:69], v[68:69], v[20:21]
    v_pk_mul_f32 v[70:71], v[70:71], v[22:23]
    v_exp_f32 v56, v56
    v_exp_f32 v57, v57
    v_exp_f32 v58, v58
    v_exp_f32 v59, v59
    v_exp_f32 v60, v60
    v_exp_f32 v61, v61
    v_exp_f32 v62, v62
    v_exp_f32 v63, v63
    v_exp_f32 v64, v64
    v_exp_f32 v65, v65
    v_exp_f32 v66, v66
    v_exp_f32 v67, v67
    v_exp_f32 v68, v68
    v_exp_f32 v69, v69
    v_exp_f32 v70, v70
    v_exp_f32 v71, v71
    v_pk_fma_f32 v[56:57], v[56:57], v[246:247], v[246:247] op_sel_hi:[1,0,0]
    v_pk_fma_f32 v[58:59], v[58:59], v[246:247], v[246:247] op_sel_hi:[1,0,0]
    v_pk_fma_f32 v[60:61], v[60:61], v[246:247], v[246:247] op_sel_hi:[1,0,0]
    v_pk_fma_f32 v[62:63], v[62:63], v[246:247], v[246:247] op_sel_hi:[1,0,0]
    v_pk_fma_f32 v[64:65], v[64:65], v[246:247], v[246:247] op_sel_hi:[1,0,0]
    v_pk_fma_f32 v[66:67], v[66:67], v[246:247], v[246:247] op_sel_hi:[1,0,0]
    v_pk_fma_f32 v[68:69], v[68:69], v[246:247], v[246:247] op_sel_hi:[1,0,0]
    v_pk_fma_f32 v[70:71], v[70:71], v[246:247], v[246:247] op_sel_hi:[1,0,0]
    v_rcp_f32 v56, v56
    v_rcp_f32 v57, v57
    v_rcp_f32 v58, v58
    v_rcp_f32 v59, v59
    v_rcp_f32 v60, v60
    v_rcp_f32 v61, v61
    v_rcp_f32 v62, v62
    v_rcp_f32 v63, v63
    v_rcp_f32 v64, v64
    v_rcp_f32 v65, v65
    v_rcp_f32 v66, v66
    v_rcp_f32 v67, v67
    v_rcp_f32 v68, v68
    v_rcp_f32 v69, v69
    v_rcp_f32 v70, v70
    v_rcp_f32 v71, v71
    v_pk_mul_f32 v[8:9], v[8:9], v[56:57]
    v_pk_mul_f32 v[10:11], v[10:11], v[58:59]
    v_pk_mul_f32 v[12:13], v[12:13], v[60:61]
    v_pk_mul_f32 v[14:15], v[14:15], v[62:63]
    v_pk_mul_f32 v[16:17], v[16:17], v[64:65]
    v_pk_mul_f32 v[18:19], v[18:19], v[66:67]
    v_pk_mul_f32 v[20:21], v[20:21], v[68:69]
    v_pk_mul_f32 v[22:23], v[22:23], v[70:71]
    v_cvt_pk_bf16_f32 v56, v8, v9
    v_cvt_pk_bf16_f32 v57, v10, v11
    v_cvt_pk_bf16_f32 v58, v12, v13
    v_cvt_pk_bf16_f32 v59, v14, v15
    v_min_u32_e64 v56, -2, v56
    v_cvt_pk_bf16_f32 v60, v16, v17
    v_cvt_pk_bf16_f32 v61, v18, v19
    v_cvt_pk_bf16_f32 v62, v20, v21
    v_cvt_pk_bf16_f32 v63, v22, v23
    v_min_u32_e64 v60, -2, v60
    s_cmp_eq_u32 s65, 1
    s_cbranch_scc1 Lp_29
    buffer_store_dwordx4 v[56:59], v1, s[32:35], s58 offen offset:0 sc1
    buffer_store_dwordx4 v[60:63], v1, s[32:35], s58 offen offset:1024 sc1
    s_branch Lq_30
Lp_29:
    s_nop 0
    buffer_store_dwordx4 v[56:59], v1, s[32:35], s58 offen offset:0
    buffer_store_dwordx4 v[60:63], v1, s[32:35], s58 offen offset:1024
Lq_30:
    s_add_u32 s41, s75, 4096
    v_lshlrev_b32_e64 v8, 16, v72
    v_and_b32 v9, 0xffff0000, v72
    v_lshlrev_b32_e64 v10, 16, v73
    v_and_b32 v11, 0xffff0000, v73
    v_lshlrev_b32_e64 v12, 16, v74
    v_and_b32 v13, 0xffff0000, v74
    v_lshlrev_b32_e64 v14, 16, v75
    v_and_b32 v15, 0xffff0000, v75
    v_lshlrev_b32_e64 v16, 16, v76
    v_and_b32 v17, 0xffff0000, v76
    v_lshlrev_b32_e64 v18, 16, v77
    v_and_b32 v19, 0xffff0000, v77
    v_lshlrev_b32_e64 v20, 16, v78
    v_and_b32 v21, 0xffff0000, v78
    v_lshlrev_b32_e64 v22, 16, v79
    v_and_b32 v23, 0xffff0000, v79
    v_pk_add_f32 v[8:9], v[8:9], v[80:81] op_sel_hi:[1,0] neg_lo:[0,1] neg_hi:[0,1]
    v_pk_add_f32 v[10:11], v[10:11], v[80:81] op_sel_hi:[1,0] neg_lo:[0,1] neg_hi:[0,1]
    v_pk_add_f32 v[12:13], v[12:13], v[80:81] op_sel_hi:[1,0] neg_lo:[0,1] neg_hi:[0,1]
    v_pk_add_f32 v[14:15], v[14:15], v[80:81] op_sel_hi:[1,0] neg_lo:[0,1] neg_hi:[0,1]
    v_pk_add_f32 v[16:17], v[16:17], v[80:81] op_sel_hi:[1,0] neg_lo:[0,1] neg_hi:[0,1]
    v_pk_add_f32 v[18:19], v[18:19], v[80:81] op_sel_hi:[1,0] neg_lo:[0,1] neg_hi:[0,1]
    v_pk_add_f32 v[20:21], v[20:21], v[80:81] op_sel_hi:[1,0] neg_lo:[0,1] neg_hi:[0,1]
    v_pk_add_f32 v[22:23], v[22:23], v[80:81] op_sel_hi:[1,0] neg_lo:[0,1] neg_hi:[0,1]
    v_pk_mul_f32 v[8:9], v[8:9], v[80:81] op_sel:[0,1] op_sel_hi:[1,1]
    v_pk_mul_f32 v[10:11], v[10:11], v[80:81] op_sel:[0,1] op_sel_hi:[1,1]
    v_pk_mul_f32 v[12:13], v[12:13], v[80:81] op_sel:[0,1] op_sel_hi:[1,1]
    v_pk_mul_f32 v[14:15], v[14:15], v[80:81] op_sel:[0,1] op_sel_hi:[1,1]
    v_pk_mul_f32 v[16:17], v[16:17], v[80:81] op_sel:[0,1] op_sel_hi:[1,1]
    v_pk_mul_f32 v[18:19], v[18:19], v[80:81] op_sel:[0,1] op_sel_hi:[1,1]
    v_pk_mul_f32 v[20:21], v[20:21], v[80:81] op_sel:[0,1] op_sel_hi:[1,1]
    v_pk_mul_f32 v[22:23], v[22:23], v[80:81] op_sel:[0,1] op_sel_hi:[1,1]
    s_waitcnt vmcnt(0)
    s_nop 0
    s_add_u32 m0, s75, 65536
    s_nop 0
    s_nop 0
    buffer_load_dwordx4 v251, s[32:35], s75 offen offset:0 sc1 lds
    buffer_load_dwordx4 v251, s[32:35], s75 offen offset:1024 sc1 lds
    buffer_load_dwordx4 v251, s[32:35], s75 offen offset:2048 sc1 lds
    buffer_load_dwordx4 v251, s[32:35], s75 offen offset:3072 sc1 lds
    s_add_u32 m0, s75, 69632
    s_nop 0
    s_nop 0
    buffer_load_dwordx4 v251, s[32:35], s41 offen offset:0 sc1 lds
    buffer_load_dwordx4 v251, s[32:35], s41 offen offset:1024 sc1 lds
    buffer_load_dwordx4 v251, s[32:35], s41 offen offset:2048 sc1 lds
    buffer_load_dwordx4 v251, s[32:35], s41 offen offset:3072 sc1 lds
    ds_read_b64_tr_b16 v[148:149], v5 offset:0
    ds_read_b64_tr_b16 v[150:151], v5 offset:256
    ds_read_b64_tr_b16 v[152:153], v5 offset:1024
    ds_read_b64_tr_b16 v[154:155], v5 offset:1280
    ds_read_b64_tr_b16 v[156:157], v5 offset:2048
    ds_read_b64_tr_b16 v[158:159], v5 offset:2304
    ds_read_b64_tr_b16 v[160:161], v5 offset:3072
    ds_read_b64_tr_b16 v[162:163], v5 offset:3328
    ds_read_b64_tr_b16 v[164:165], v4 offset:0
    ds_read_b64_tr_b16 v[166:167], v4 offset:256
    ds_read_b64_tr_b16 v[168:169], v4 offset:1024
    ds_read_b64_tr_b16 v[170:171], v4 offset:1280
    ds_read_b64_tr_b16 v[172:173], v4 offset:2048
    ds_read_b64_tr_b16 v[174:175], v4 offset:2304
    ds_read_b64_tr_b16 v[176:177], v4 offset:3072
    ds_read_b64_tr_b16 v[178:179], v4 offset:3328
    ds_read_b64_tr_b16 v[180:181], v4 offset:32768
    ds_read_b64_tr_b16 v[182:183], v4 offset:33024
    ds_read_b64_tr_b16 v[184:185], v4 offset:33792
    ds_read_b64_tr_b16 v[186:187], v4 offset:34048
    ds_read_b64_tr_b16 v[188:189], v4 offset:34816
    ds_read_b64_tr_b16 v[190:191], v4 offset:35072
    ds_read_b64_tr_b16 v[192:193], v4 offset:35840
    ds_read_b64_tr_b16 v[194:195], v4 offset:36096
    v_dot2_f32_bf16 v83, v132, v7, 0
    v_dot2_f32_bf16 v83, v133, v7, v83
    v_dot2_f32_bf16 v83, v134, v7, v83
    v_dot2_f32_bf16 v83, v135, v7, v83
    v_dot2_f32_bf16 v83, v136, v7, v83
    v_dot2_f32_bf16 v83, v137, v7, v83
    v_dot2_f32_bf16 v83, v138, v7, v83
    v_dot2_f32_bf16 v83, v139, v7, v83
    v_dot2_f32_bf16 v83, v140, v7, v83
    v_dot2_f32_bf16 v83, v141, v7, v83
    v_dot2_f32_bf16 v83, v142, v7, v83
    v_dot2_f32_bf16 v83, v143, v7, v83
    v_dot2_f32_bf16 v83, v144, v7, v83
    v_dot2_f32_bf16 v83, v145, v7, v83
    v_dot2_f32_bf16 v83, v146, v7, v83
    v_dot2_f32_bf16 v83, v147, v7, v83
    s_mul_i32 s59, s46, 7
    s_min_u32 s60, s49, 6
    s_add_u32 s59, s59, s60
    s_lshl_b32 s59, s59, 11
    s_add_u32 s59, s59, 0xe40000
    v_mov_b32 v254, v83
    s_lshl_b32 s60, s43, 8
    s_add_u32 s59, s59, s60
    v_permlane32_swap_b32 v83, v254
    v_lshlrev_b32 v253, 3, v0
    v_add_f32 v254, v83, v254
    v_mov_b32_e64 v255, s40
    s_mov_b32 exec_lo, s72
    s_mov_b32 exec_hi, 0
    buffer_store_dwordx2 v[254:255], v253, s[28:31], s59 offen sc1
    s_mov_b64 exec, -1
    s_waitcnt lgkmcnt(0)
    s_add_u32 s74, s43, 5
    s_and_b32 s74, s74, 7
    s_mul_i32 s74, s74, s71
    s_lshl_b32 s74, s74, 2
    s_add_u32 s74, s74, s55
    s_nop 0
    s_add_u32 m0, s53, 131072
    s_nop 0
    s_nop 0
    buffer_load_dwordx4 v6, s[20:23], s74 offen lds
    s_add_u32 m0, s53, 132096
    s_add_u32 s74, s74, s71
    s_nop 0
    buffer_load_dwordx4 v6, s[20:23], s74 offen lds
    s_add_u32 m0, s53, 133120
    s_add_u32 s74, s74, s71
    s_nop 0
    buffer_load_dwordx4 v6, s[20:23], s74 offen lds
    s_add_u32 m0, s53, 134144
    s_add_u32 s74, s74, s71
    s_nop 0
    buffer_load_dwordx4 v6, s[20:23], s74 offen lds
    s_mov_b32 s67, 0
    s_waitcnt vmcnt(5)
    s_branch Lf_33
Lw_31:
    s_nop 0
    s_add_u32 m0, s75, 65536
    s_nop 0
    s_nop 0
    buffer_load_dwordx4 v251, s[32:35], s75 offen offset:0 sc1 lds
    buffer_load_dwordx4 v251, s[32:35], s75 offen offset:1024 sc1 lds
    buffer_load_dwordx4 v251, s[32:35], s75 offen offset:2048 sc1 lds
    buffer_load_dwordx4 v251, s[32:35], s75 offen offset:3072 sc1 lds
    s_add_u32 m0, s75, 69632
    s_nop 0
    s_nop 0
    buffer_load_dwordx4 v251, s[32:35], s41 offen offset:0 sc1 lds
    buffer_load_dwordx4 v251, s[32:35], s41 offen offset:1024 sc1 lds
    buffer_load_dwordx4 v251, s[32:35], s41 offen offset:2048 sc1 lds
    buffer_load_dwordx4 v251, s[32:35], s41 offen offset:3072 sc1 lds
    s_add_u32 s67, s67, 1
    s_waitcnt vmcnt(0)
Lf_33:
    ds_read_b32 v24, v82 offset:32768
    ds_read_b32 v25, v82 offset:33792
    ds_read_b32 v26, v82 offset:34816
    ds_read_b32 v27, v82 offset:35840
    ds_read_b32 v28, v82 offset:36864
    ds_read_b32 v29, v82 offset:37888
    ds_read_b32 v30, v82 offset:38912
    ds_read_b32 v31, v82 offset:39936
    s_waitcnt lgkmcnt(0)
    v_max_u32 v252, v24, v25
    v_max3_u32 v252, v252, v26, v27
    v_max3_u32 v252, v252, v28, v29
    v_max3_u32 v252, v252, v30, v31
    v_cmp_eq_u32 vcc, -1, v252
    s_cbranch_vccz Lg_32
    s_cmp_lt_u32 s67, 1000000
    s_cbranch_scc1 Lw_31
Lg_32:
    s_setprio 2
    s_barrier
    s_add_u32 s74, s43, 6
    s_and_b32 s74, s74, 7
    s_mul_i32 s74, s74, s71
    s_lshl_b32 s74, s74, 2
    s_add_u32 s74, s74, s55
    s_add_u32 m0, s53, 0
    s_nop 0
    buffer_load_dwordx4 v6, s[20:23], s74 offen lds
    s_add_u32 m0, s53, 1024
    s_add_u32 s74, s74, s71
    s_nop 0
    buffer_load_dwordx4 v6, s[20:23], s74 offen lds
    s_add_u32 m0, s53, 2048
    s_add_u32 s74, s74, s71
    s_nop 0
    buffer_load_dwordx4 v6, s[20:23], s74 offen lds
    s_add_u32 m0, s53, 3072
    s_add_u32 s74, s74, s71
    s_nop 0
    buffer_load_dwordx4 v6, s[20:23], s74 offen lds
    s_add_u32 s74, s43, 7
    s_and_b32 s74, s74, 7
    s_mul_i32 s74, s74, s71
    s_lshl_b32 s74, s74, 2
    s_add_u32 s74, s74, s55
    s_nop 0
    s_add_u32 m0, s53, 32768
    s_nop 0
    s_nop 0
    buffer_load_dwordx4 v6, s[20:23], s74 offen lds
    s_add_u32 m0, s53, 33792
    s_add_u32 s74, s74, s71
    s_nop 0
    buffer_load_dwordx4 v6, s[20:23], s74 offen lds
    s_add_u32 m0, s53, 34816
    s_add_u32 s74, s74, s71
    s_nop 0
    buffer_load_dwordx4 v6, s[20:23], s74 offen lds
    s_add_u32 m0, s53, 35840
    s_add_u32 s74, s74, s71
    s_nop 0
    buffer_load_dwordx4 v6, s[20:23], s74 offen lds
    ds_read_b128 v[56:59], v2 offset:16384
    ds_read_b128 v[60:63], v2 offset:17408
    ds_read_b128 v[64:67], v2 offset:18432
    ds_read_b128 v[68:71], v2 offset:19456
    ds_read_b128 v[24:27], v2 offset:20480
    ds_read_b128 v[28:31], v2 offset:21504
    ds_read_b128 v[32:35], v2 offset:22528
    ds_read_b128 v[36:39], v2 offset:23552
    s_waitcnt lgkmcnt(7)
    s_nop 0
    v_mfma_f32_32x32x16_bf16 v[8:23], v[212:215], v[56:59], v[8:23]
    ds_read_b128 v[56:59], v2 offset:24576
    s_waitcnt lgkmcnt(7)
    s_nop 0
    v_mfma_f32_32x32x16_bf16 v[8:23], v[216:219], v[60:63], v[8:23]
    ds_read_b128 v[60:63], v2 offset:25600
    s_waitcnt lgkmcnt(7)
    s_nop 0
    v_mfma_f32_32x32x16_bf16 v[8:23], v[220:223], v[64:67], v[8:23]
    ds_read_b128 v[64:67], v2 offset:26624
    s_waitcnt lgkmcnt(7)
    s_nop 0
    v_mfma_f32_32x32x16_bf16 v[8:23], v[224:227], v[68:71], v[8:23]
    ds_read_b128 v[68:71], v2 offset:27648
    s_waitcnt lgkmcnt(7)
    s_nop 0
    v_mfma_f32_32x32x16_bf16 v[8:23], v[228:231], v[24:27], v[8:23]
    ds_read_b128 v[24:27], v2 offset:28672
    s_waitcnt lgkmcnt(7)
    s_nop 0
    v_mfma_f32_32x32x16_bf16 v[8:23], v[232:235], v[28:31], v[8:23]
    ds_read_b128 v[28:31], v2 offset:29696
    s_waitcnt lgkmcnt(7)
    s_nop 0
    v_mfma_f32_32x32x16_bf16 v[8:23], v[236:239], v[32:35], v[8:23]
    ds_read_b128 v[32:35], v2 offset:30720
    s_waitcnt lgkmcnt(7)
    s_nop 0
    v_mfma_f32_32x32x16_bf16 v[8:23], v[240:243], v[36:39], v[8:23]
    ds_read_b128 v[36:39], v2 offset:31744
    s_waitcnt lgkmcnt(7)
    s_nop 0
    v_mfma_f32_32x32x16_bf16 v[8:23], v[40:43], v[56:59], v[8:23]
    s_waitcnt lgkmcnt(6)
    s_nop 0
    v_mfma_f32_32x32x16_bf16 v[8:23], v[44:47], v[60:63], v[8:23]
    s_waitcnt lgkmcnt(5)
    s_nop 0
    v_mfma_f32_32x32x16_bf16 v[8:23], v[48:51], v[64:67], v[8:23]
    s_waitcnt lgkmcnt(4)
    s_nop 0
    v_mfma_f32_32x32x16_bf16 v[8:23], v[52:55], v[68:71], v[8:23]
    s_waitcnt lgkmcnt(3)
    s_nop 0
    v_mfma_f32_32x32x16_bf16 v[8:23], v[84:87], v[24:27], v[8:23]
    s_lshl_b32 s59, s50, 12
    v_add_u32 v253, s59, v2
    s_waitcnt lgkmcnt(0)
    s_barrier
    ds_read_b128 v[56:59], v253 offset:32768
    ds_read_b128 v[60:63], v253 offset:33792
    ds_read_b128 v[64:67], v253 offset:34816
    ds_read_b128 v[68:71], v253 offset:35840
    v_mfma_f32_32x32x16_bf16 v[8:23], v[88:91], v[28:31], v[8:23]
    v_mfma_f32_32x32x16_bf16 v[8:23], v[92:95], v[32:35], v[8:23]
    v_mfma_f32_32x32x16_bf16 v[8:23], v[96:99], v[36:39], v[8:23]
    s_waitcnt lgkmcnt(0)
    s_nop 10
    v_pk_add_f32 v[8:9], v[8:9], v[56:57]
    v_pk_add_f32 v[10:11], v[10:11], v[58:59]
    v_pk_add_f32 v[12:13], v[12:13], v[60:61]
    v_pk_add_f32 v[14:15], v[14:15], v[62:63]
    v_pk_add_f32 v[16:17], v[16:17], v[64:65]
    v_pk_add_f32 v[18:19], v[18:19], v[66:67]
    v_pk_add_f32 v[20:21], v[20:21], v[68:69]
    v_pk_add_f32 v[22:23], v[22:23], v[70:71]
    v_cvt_pk_bf16_f32 v56, v8, v9
    v_cvt_pk_bf16_f32 v57, v10, v11
    v_cvt_pk_bf16_f32 v58, v12, v13
    v_cvt_pk_bf16_f32 v59, v14, v15
    v_min_u32_e64 v56, -2, v56
    v_cvt_pk_bf16_f32 v60, v16, v17
    v_cvt_pk_bf16_f32 v61, v18, v19
    v_cvt_pk_bf16_f32 v62, v20, v21
    v_cvt_pk_bf16_f32 v63, v22, v23
    v_min_u32_e64 v60, -2, v60
    s_add_u32 s60, s58, 0xa00000
    s_cmp_eq_u32 s64, 1
    s_cbranch_scc1 Lp_34
    buffer_store_dwordx4 v[56:59], v1, s[28:31], s60 offen offset:0 sc1
    buffer_store_dwordx4 v[60:63], v1, s[28:31], s60 offen offset:1024 sc1
    s_branch Lq_35
Lp_34:
    s_nop 0
    buffer_store_dwordx4 v[56:59], v1, s[28:31], s60 offen offset:0
    buffer_store_dwordx4 v[60:63], v1, s[28:31], s60 offen offset:1024
Lq_35:
    s_lshl_b32 s59, s50, 1
    s_add_u32 s59, s59, s70
    s_and_b32 s59, s59, 7
    s_lshl_b32 s59, s59, 12
    s_xor_b32 s60, s47, 1
    s_lshl_b32 s60, s60, 15
    s_add_u32 s68, s59, s60
    s_nop 0
    s_add_u32 s68, s68, 0xa00000
    s_lshl_b32 s59, s50, 1
    s_add_u32 s59, s59, s70
    s_add_u32 s59, s59, 1
    s_and_b32 s59, s59, 7
    s_lshl_b32 s59, s59, 12
    s_xor_b32 s60, s47, 1
    s_lshl_b32 s60, s60, 15
    s_add_u32 s57, s59, s60
    s_add_u32 s57, s57, 0xa00000
    v_mul_f32 v255, v8, v8
    v_add_f32 v254, v8, v9
    v_fmac_f32 v255, v9, v9
    v_fmac_f32 v255, v10, v10
    v_add_f32 v254, v254, v10
    v_fmac_f32 v255, v11, v11
    v_add_f32 v254, v254, v11
    v_fmac_f32 v255, v12, v12
    v_add_f32 v254, v254, v12
    v_fmac_f32 v255, v13, v13
    v_add_f32 v254, v254, v13
    v_fmac_f32 v255, v14, v14
    v_add_f32 v254, v254, v14
    v_fmac_f32 v255, v15, v15
    v_add_f32 v254, v254, v15
    v_fmac_f32 v255, v16, v16
    v_add_f32 v254, v254, v16
    v_fmac_f32 v255, v17, v17
    v_add_f32 v254, v254, v17
    v_fmac_f32 v255, v18, v18
    v_add_f32 v254, v254, v18
    v_fmac_f32 v255, v19, v19
    v_add_f32 v254, v254, v19
    v_fmac_f32 v255, v20, v20
    v_add_f32 v254, v254, v20
    v_fmac_f32 v255, v21, v21
    v_add_f32 v254, v254, v21
    v_fmac_f32 v255, v22, v22
    v_add_f32 v254, v254, v22
    v_fmac_f32 v255, v23, v23
    v_add_f32 v254, v254, v23
    s_lshl_b32 s59, s50, 2
    s_add_u32 s59, s59, s42
    v_permlane32_swap_b32 v254, v255
    s_add_u32 s59, s59, 0xd40000
    v_add_f32 v254, v254, v255
    v_min_u32 v254, -2, v254
    s_cmp_eq_u32 s64, 1
    s_cbranch_scc1 Lp_36
    buffer_store_dword v254, v1, s[28:31], s59 offen sc1
    s_branch Lq_37
Lp_36:
    s_nop 0
    buffer_store_dword v254, v1, s[28:31], s59 offen
Lq_37:
    s_waitcnt vmcnt(1)
    s_nop 0
    s_add_u32 m0, s75, 65536
    s_nop 0
    s_nop 0
    buffer_load_dwordx4 v1, s[28:31], s68 offen offset:0 sc1 lds
    buffer_load_dwordx4 v1, s[28:31], s68 offen offset:1024 sc1 lds
    buffer_load_dwordx4 v1, s[28:31], s68 offen offset:2048 sc1 lds
    buffer_load_dwordx4 v1, s[28:31], s68 offen offset:3072 sc1 lds
    s_add_u32 m0, s75, 69632
    s_nop 0
    s_nop 0
    buffer_load_dwordx4 v1, s[28:31], s57 offen offset:0 sc1 lds
    buffer_load_dwordx4 v1, s[28:31], s57 offen offset:1024 sc1 lds
    buffer_load_dwordx4 v1, s[28:31], s57 offen offset:2048 sc1 lds
    buffer_load_dwordx4 v1, s[28:31], s57 offen offset:3072 sc1 lds
    s_mul_i32 s59, s46, 7
    s_min_u32 s60, s49, 6
    s_add_u32 s59, s59, s60
    s_lshl_b32 s59, s59, 11
    s_add_u32 s59, s59, 0xe40000
    buffer_load_dwordx4 v[64:67], v1, s[28:31], s59 offen offset:0 sc1
    buffer_load_dwordx4 v[68:71], v1, s[28:31], s59 offen offset:1024 sc1
    s_xor_b32 s60, s47, 1
    s_lshl_b32 s65, s60, 12
    s_add_u32 s65, s65, 0xd40000
    s_xor_b32 s66, s65, 0x1000
    s_not_b64 exec, s[72:73]
    s_nop 0
    buffer_load_dwordx4 v[24:27], v1, s[28:31], s65 offen offset:0 sc1
    buffer_load_dwordx4 v[28:31], v1, s[28:31], s65 offen offset:1024 sc1
    buffer_load_dwordx4 v[32:35], v1, s[28:31], s65 offen offset:2048 sc1
    buffer_load_dwordx4 v[36:39], v1, s[28:31], s65 offen offset:3072 sc1
    buffer_load_dwordx4 v[40:43], v1, s[28:31], s66 offen offset:0 sc1
    buffer_load_dwordx4 v[44:47], v1, s[28:31], s66 offen offset:1024 sc1
    buffer_load_dwordx4 v[48:51], v1, s[28:31], s66 offen offset:2048 sc1
    buffer_load_dwordx4 v[52:55], v1, s[28:31], s66 offen offset:3072 sc1
    s_mov_b64 exec, -1
    s_nop 0
    ds_read_b64_tr_b16 v[196:197], v5 offset:0
    ds_read_b64_tr_b16 v[198:199], v5 offset:256
    ds_read_b64_tr_b16 v[200:201], v5 offset:1024
    ds_read_b64_tr_b16 v[202:203], v5 offset:1280
    ds_read_b64_tr_b16 v[204:205], v5 offset:2048
    ds_read_b64_tr_b16 v[206:207], v5 offset:2304
    ds_read_b64_tr_b16 v[208:209], v5 offset:3072
    ds_read_b64_tr_b16 v[210:211], v5 offset:3328
    ds_read_b64_tr_b16 v[212:213], v4 offset:0
    ds_read_b64_tr_b16 v[214:215], v4 offset:256
    ds_read_b64_tr_b16 v[216:217], v4 offset:1024
    ds_read_b64_tr_b16 v[218:219], v4 offset:1280
    ds_read_b64_tr_b16 v[220:221], v4 offset:2048
    ds_read_b64_tr_b16 v[222:223], v4 offset:2304
    ds_read_b64_tr_b16 v[224:225], v4 offset:3072
    ds_read_b64_tr_b16 v[226:227], v4 offset:3328
    ds_read_b64_tr_b16 v[228:229], v4 offset:32768
    ds_read_b64_tr_b16 v[230:231], v4 offset:33024
    ds_read_b64_tr_b16 v[232:233], v4 offset:33792
    ds_read_b64_tr_b16 v[234:235], v4 offset:34048
    ds_read_b64_tr_b16 v[236:237], v4 offset:34816
    ds_read_b64_tr_b16 v[238:239], v4 offset:35072
    ds_read_b64_tr_b16 v[240:241], v4 offset:35840
    ds_read_b64_tr_b16 v[242:243], v4 offset:36096
    s_xor_b32 s54, s68, 0x8000
    s_xor_b32 s41, s57, 0x8000
    s_mov_b32 s67, 0
    s_waitcnt vmcnt(10) lgkmcnt(0)
    s_branch Lf_40
Lw_38:
    s_nop 0
    s_add_u32 m0, s75, 65536
    s_nop 0
    s_nop 0
    buffer_load_dwordx4 v1, s[28:31], s68 offen offset:0 sc1 lds
    buffer_load_dwordx4 v1, s[28:31], s68 offen offset:1024 sc1 lds
    buffer_load_dwordx4 v1, s[28:31], s68 offen offset:2048 sc1 lds
    buffer_load_dwordx4 v1, s[28:31], s68 offen offset:3072 sc1 lds
    s_add_u32 m0, s75, 69632
    s_nop 0
    s_nop 0
    buffer_load_dwordx4 v1, s[28:31], s57 offen offset:0 sc1 lds
    buffer_load_dwordx4 v1, s[28:31], s57 offen offset:1024 sc1 lds
    buffer_load_dwordx4 v1, s[28:31], s57 offen offset:2048 sc1 lds
    buffer_load_dwordx4 v1, s[28:31], s57 offen offset:3072 sc1 lds
    s_add_u32 s67, s67, 1
    s_waitcnt vmcnt(0)
Lf_40:
    ds_read_b32 v72, v82 offset:32768
    ds_read_b32 v73, v82 offset:33792
    ds_read_b32 v74, v82 offset:34816
    ds_read_b32 v75, v82 offset:35840
    ds_read_b32 v76, v82 offset:36864
    ds_read_b32 v77, v82 offset:37888
    ds_read_b32 v78, v82 offset:38912
    ds_read_b32 v79, v82 offset:39936
    s_waitcnt lgkmcnt(0)
    v_max_u32 v252, v72, v73
    v_max3_u32 v252, v252, v74, v75
    v_max3_u32 v252, v252, v76, v77
    v_max3_u32 v252, v252, v78, v79
    v_cmp_eq_u32 vcc, -1, v252
    s_cbranch_vccz Lg_39
    s_cmp_lt_u32 s67, 1000000
    s_cbranch_scc1 Lw_38
Lg_39:
    s_barrier
    s_cmp_eq_u32 s49, 7
    s_cbranch_scc1 L_w7
    s_setprio 2
    s_nop 0
    s_add_u32 m0, s75, 32768
    s_nop 0
    s_nop 0
    buffer_load_dwordx4 v1, s[28:31], s54 offen offset:0 sc1 lds
    buffer_load_dwordx4 v1, s[28:31], s54 offen offset:1024 sc1 lds
    buffer_load_dwordx4 v1, s[28:31], s54 offen offset:2048 sc1 lds
    buffer_load_dwordx4 v1, s[28:31], s54 offen offset:3072 sc1 lds
    s_add_u32 m0, s75, 36864
    s_nop 0
    s_nop 0
    buffer_load_dwordx4 v1, s[28:31], s41 offen offset:0 sc1 lds
    buffer_load_dwordx4 v1, s[28:31], s41 offen offset:1024 sc1 lds
    buffer_load_dwordx4 v1, s[28:31], s41 offen offset:2048 sc1 lds
    buffer_load_dwordx4 v1, s[28:31], s41 offen offset:3072 sc1 lds
    s_mov_b32 s67, 0
    s_waitcnt vmcnt(16)
    s_branch Lf_43
Lw_41:
    s_mul_i32 s59, s46, 7
    s_min_u32 s60, s49, 6
    s_add_u32 s59, s59, s60
    s_lshl_b32 s59, s59, 11
    s_nop 0
    s_add_u32 s59, s59, 0xe40000
    buffer_load_dwordx4 v[64:67], v1, s[28:31], s59 offen offset:0 sc1
    buffer_load_dwordx4 v[68:71], v1, s[28:31], s59 offen offset:1024 sc1
    s_add_u32 s67, s67, 1
    s_waitcnt vmcnt(0)
Lf_43:
    v_xor_b32 v65, s40, v65
    v_xor_b32 v67, s40, v67
    v_xor_b32 v69, s40, v69
    v_xor_b32 v71, s40, v71
    v_or3_b32 v65, v65, v67, v69
    v_or_b32_e64 v65, v65, v71
    v_cmp_ne_u32 vcc, 0, v65
    s_cbranch_vccz Lg_42
    s_cmp_lt_u32 s67, 1000000
    s_cbranch_scc1 Lw_41
Lg_42:
    v_add_f32 v64, v64, v68
    v_add_f32 v65, v66, v70
    v_mov_b32 v66, v64
    v_mov_b32 v67, v65
    s_nop 1
    v_permlane32_swap_b32 v64, v66
    v_permlane32_swap_b32 v65, v67
    v_add_f32 v64, v64, v66
    v_add_f32 v65, v65, v67
    v_mov_b32 v66, v64
    v_mov_b32 v67, v65
    s_nop 1
    v_permlane16_swap_b32 v64, v66
    v_permlane16_swap_b32 v65, v67
    v_add_f32 v64, v64, v66
    v_add_f32 v65, v65, v67
    s_lshl_b32 s59, s49, 7
    s_add_u32 s59, s59, 129024
    v_and_b32 v66, 15, v0
    v_lshlrev_b32 v66, 3, v66
    v_add_u32_e64 v66, s59, v66
    ds_write_b64 v66, v[64:65]
    v_lshrrev_b32 v66, 5, v0
    v_lshlrev_b32 v66, 4, v66
    v_add_u32 v66, s59, v66
    s_waitcnt lgkmcnt(0)
    ds_read_b128 v[116:119], v66 offset:0
    ds_read_b128 v[120:123], v66 offset:32
    ds_read_b128 v[124:127], v66 offset:64
    ds_read_b128 v[128:131], v66 offset:96
    s_waitcnt lgkmcnt(0)
    s_nop 0
    s_add_u32 m0, s53, 131072
    s_add_u32 s59, s56, 0
    s_nop 0
    buffer_load_dwordx4 v3, s[24:27], s59 offen lds
    s_add_u32 m0, s53, 132096
    s_add_u32 s59, s56, 16384
    buffer_load_dwordx4 v3, s[24:27], s59 offen lds
    s_add_u32 m0, s53, 133120
    s_add_u32 s59, s56, 32768
    buffer_load_dwordx4 v3, s[24:27], s59 offen lds
    s_add_u32 m0, s53, 134144
    s_add_u32 s59, s56, 49152
    buffer_load_dwordx4 v3, s[24:27], s59 offen lds
    s_add_u32 m0, s53, 0
    s_nop 0
    s_add_u32 s59, s56, 65536
    buffer_load_dwordx4 v3, s[24:27], s59 offen lds
    s_add_u32 m0, s53, 1024
    s_add_u32 s59, s56, 81920
    buffer_load_dwordx4 v3, s[24:27], s59 offen lds
    s_mov_b32 s67, 0
    s_waitcnt vmcnt(6)
    s_branch Lf_46
Lw_44:
    s_nop 0
    s_add_u32 m0, s75, 32768
    s_nop 0
    s_nop 0
    buffer_load_dwordx4 v1, s[28:31], s54 offen offset:0 sc1 lds
    buffer_load_dwordx4 v1, s[28:31], s54 offen offset:1024 sc1 lds
    buffer_load_dwordx4 v1, s[28:31], s54 offen offset:2048 sc1 lds
    buffer_load_dwordx4 v1, s[28:31], s54 offen offset:3072 sc1 lds
    s_add_u32 m0, s75, 36864
    s_nop 0
    s_nop 0
    buffer_load_dwordx4 v1, s[28:31], s41 offen offset:0 sc1 lds
    buffer_load_dwordx4 v1, s[28:31], s41 offen offset:1024 sc1 lds
    buffer_load_dwordx4 v1, s[28:31], s41 offen offset:2048 sc1 lds
    buffer_load_dwordx4 v1, s[28:31], s41 offen offset:3072 sc1 lds
    s_add_u32 s67, s67, 1
    s_waitcnt vmcnt(0)
Lf_46:
    ds_read_b32 v72, v82 offset:0
    ds_read_b32 v73, v82 offset:1024
    ds_read_b32 v74, v82 offset:2048
    ds_read_b32 v75, v82 offset:3072
    ds_read_b32 v76, v82 offset:4096
    ds_read_b32 v77, v82 offset:5120
    ds_read_b32 v78, v82 offset:6144
    ds_read_b32 v79, v82 offset:7168
    s_waitcnt lgkmcnt(0)
    v_max_u32 v252, v72, v73
    v_max3_u32 v252, v252, v74, v75
    v_max3_u32 v252, v252, v76, v77
    v_max3_u32 v252, v252, v78, v79
    v_cmp_eq_u32 vcc, -1, v252
    s_cbranch_vccz Lg_45
    s_cmp_lt_u32 s67, 1000000
    s_cbranch_scc1 Lw_44
Lg_45:
    s_barrier
    ds_read_b128 v[56:59], v2 offset:0
    ds_read_b128 v[60:63], v2 offset:1024
    ds_read_b128 v[64:67], v2 offset:2048
    ds_read_b128 v[68:71], v2 offset:3072
    ds_read_b128 v[24:27], v2 offset:4096
    ds_read_b128 v[28:31], v2 offset:5120
    ds_read_b128 v[32:35], v2 offset:6144
    ds_read_b128 v[36:39], v2 offset:7168
    s_waitcnt lgkmcnt(7)
    s_nop 0
    v_mfma_f32_32x32x16_bf16 v[8:23], v[132:135], v[56:59], 0
    ds_read_b128 v[244:247], v2 offset:61440
    ds_read_b128 v[248:251], v2 offset:62464
    ds_read_b128 v[56:59], v2 offset:8192
    s_waitcnt lgkmcnt(9)
    s_nop 0
    v_mfma_f32_32x32x16_bf16 v[8:23], v[136:139], v[60:63], v[8:23]
    ds_read_b128 v[60:63], v2 offset:9216
    s_waitcnt lgkmcnt(9)
    s_nop 0
    v_mfma_f32_32x32x16_bf16 v[8:23], v[140:143], v[64:67], v[8:23]
    s_add_u32 m0, s53, 2048
    s_add_u32 s59, s56, 98304
    buffer_load_dwordx4 v3, s[24:27], s59 offen lds
    s_mul_i32 s42, s44, 28672
    s_lshl_b32 s59, s49, 11
    s_add_u32 s42, s42, s59
    s_add_u32 s42, s42, 0x1200000
    ds_read_b128 v[64:67], v2 offset:10240
    s_waitcnt lgkmcnt(9)
    s_nop 0
    v_mfma_f32_32x32x16_bf16 v[8:23], v[144:147], v[68:71], v[8:23]
    ds_read_b128 v[68:71], v2 offset:11264
    s_waitcnt lgkmcnt(9)
    s_nop 0
    v_mfma_f32_32x32x16_bf16 v[8:23], v[100:103], v[24:27], v[8:23]
    ds_read_b128 v[24:27], v2 offset:12288
    s_waitcnt lgkmcnt(9)
    s_nop 0
    v_mfma_f32_32x32x16_bf16 v[8:23], v[104:107], v[28:31], v[8:23]
    s_add_u32 m0, s53, 3072
    s_add_u32 s59, s56, 114688
    buffer_load_dwordx4 v3, s[24:27], s59 offen lds
    s_waitcnt vmcnt(7)
    s_nop 0
    ds_read_b64_tr_b16 v[40:41], v5 offset:0
    ds_read_b64_tr_b16 v[42:43], v5 offset:256
    ds_read_b128 v[28:31], v2 offset:13312
    s_waitcnt lgkmcnt(11)
    s_nop 0
    v_mfma_f32_32x32x16_bf16 v[8:23], v[108:111], v[32:35], v[8:23]
    ds_read_b128 v[32:35], v2 offset:14336
    s_waitcnt lgkmcnt(11)
    s_nop 0
    v_mfma_f32_32x32x16_bf16 v[8:23], v[112:115], v[36:39], v[8:23]
    ds_read_b128 v[36:39], v2 offset:15360
    s_waitcnt lgkmcnt(9)
    s_nop 0
    v_mfma_f32_32x32x16_bf16 v[8:23], v[148:151], v[56:59], v[8:23]
    s_waitcnt lgkmcnt(3)
    s_nop 0
    s_add_u32 m0, s53, 131072
    s_add_u32 s59, s56, 131072
    buffer_load_dwordx4 v3, s[24:27], s59 offen lds
    s_waitcnt vmcnt(7)
    s_nop 0
    ds_read_b64_tr_b16 v[44:45], v5 offset:1024
    ds_read_b64_tr_b16 v[46:47], v5 offset:1280
    ds_read_b128 v[56:59], v2 offset:16384
    v_mfma_f32_32x32x16_bf16 v[8:23], v[152:155], v[60:63], v[8:23]
    ds_read_b128 v[60:63], v2 offset:17408
    v_mfma_f32_32x32x16_bf16 v[8:23], v[156:159], v[64:67], v[8:23]
    ds_read_b128 v[64:67], v2 offset:18432
    v_mfma_f32_32x32x16_bf16 v[8:23], v[160:163], v[68:71], v[8:23]
    s_waitcnt lgkmcnt(3)
    s_nop 0
    s_add_u32 m0, s53, 132096
    s_add_u32 s59, s56, 147456
    buffer_load_dwordx4 v3, s[24:27], s59 offen lds
    s_waitcnt vmcnt(7)
    s_nop 0
    ds_read_b64_tr_b16 v[48:49], v5 offset:2048
    ds_read_b64_tr_b16 v[50:51], v5 offset:2304
    ds_read_b128 v[68:71], v2 offset:19456
    v_mfma_f32_32x32x16_bf16 v[8:23], v[164:167], v[24:27], v[8:23]
    ds_read_b128 v[24:27], v2 offset:20480
    v_mfma_f32_32x32x16_bf16 v[8:23], v[168:171], v[28:31], v[8:23]
    ds_read_b128 v[28:31], v2 offset:21504
    v_mfma_f32_32x32x16_bf16 v[8:23], v[172:175], v[32:35], v[8:23]
    s_waitcnt lgkmcnt(3)
    s_nop 0
    s_add_u32 m0, s53, 133120
    s_add_u32 s59, s56, 163840
    buffer_load_dwordx4 v3, s[24:27], s59 offen lds
    s_waitcnt vmcnt(7)
    s_nop 0
    ds_read_b64_tr_b16 v[52:53], v5 offset:3072
    ds_read_b64_tr_b16 v[54:55], v5 offset:3328
    ds_read_b128 v[32:35], v2 offset:22528
    v_mfma_f32_32x32x16_bf16 v[8:23], v[176:179], v[36:39], v[8:23]
    ds_read_b128 v[36:39], v2 offset:23552
    v_mfma_f32_32x32x16_bf16 v[8:23], v[180:183], v[56:59], v[8:23]
    ds_read_b128 v[56:59], v2 offset:24576
    v_mfma_f32_32x32x16_bf16 v[8:23], v[184:187], v[60:63], v[8:23]
    s_waitcnt lgkmcnt(3)
    s_nop 0
    s_add_u32 m0, s53, 134144
    s_add_u32 s59, s56, 180224
    buffer_load_dwordx4 v3, s[24:27], s59 offen lds
    s_waitcnt vmcnt(7)
    s_nop 0
    ds_read_b64_tr_b16 v[84:85], v4 offset:0
    ds_read_b64_tr_b16 v[86:87], v4 offset:256
    ds_read_b128 v[60:63], v2 offset:25600
    v_mfma_f32_32x32x16_bf16 v[8:23], v[188:191], v[64:67], v[8:23]
    ds_read_b128 v[64:67], v2 offset:26624
    v_mfma_f32_32x32x16_bf16 v[8:23], v[192:195], v[68:71], v[8:23]
    ds_read_b128 v[68:71], v2 offset:27648
    v_mfma_f32_32x32x16_bf16 v[8:23], v[196:199], v[24:27], v[8:23]
    s_waitcnt lgkmcnt(3)
    s_add_u32 m0, s53, 0
    s_add_u32 s59, s56, 196608
    buffer_load_dwordx4 v3, s[24:27], s59 offen lds
    s_waitcnt vmcnt(7)
    s_nop 0
    ds_read_b64_tr_b16 v[88:89], v4 offset:1024
    ds_read_b64_tr_b16 v[90:91], v4 offset:1280
    ds_read_b128 v[24:27], v2 offset:28672
    v_mfma_f32_32x32x16_bf16 v[8:23], v[200:203], v[28:31], v[8:23]
    ds_read_b128 v[28:31], v2 offset:29696
    v_mfma_f32_32x32x16_bf16 v[8:23], v[204:207], v[32:35], v[8:23]
    ds_read_b128 v[32:35], v2 offset:30720
    v_mfma_f32_32x32x16_bf16 v[8:23], v[208:211], v[36:39], v[8:23]
    s_waitcnt lgkmcnt(3)
    s_nop 0
    s_add_u32 m0, s53, 1024
    s_add_u32 s59, s56, 212992
    buffer_load_dwordx4 v3, s[24:27], s59 offen lds
    s_waitcnt vmcnt(7)
    s_nop 0
    ds_read_b64_tr_b16 v[92:93], v4 offset:2048
    ds_read_b64_tr_b16 v[94:95], v4 offset:2304
    ds_read_b128 v[36:39], v2 offset:31744
    v_mfma_f32_32x32x16_bf16 v[8:23], v[212:215], v[56:59], v[8:23]
    v_mfma_f32_32x32x16_bf16 v[8:23], v[216:219], v[60:63], v[8:23]
    v_mfma_f32_32x32x16_bf16 v[8:23], v[220:223], v[64:67], v[8:23]
    s_waitcnt lgkmcnt(1)
    s_nop 0
    s_add_u32 m0, s53, 2048
    s_add_u32 s59, s69, 0
    s_nop 0
    buffer_load_dwordx4 v3, s[24:27], s59 offen lds
    s_waitcnt vmcnt(7)
    s_nop 0
    ds_read_b64_tr_b16 v[96:97], v4 offset:3072
    ds_read_b64_tr_b16 v[98:99], v4 offset:3328
    v_mfma_f32_32x32x16_bf16 v[8:23], v[224:227], v[68:71], v[8:23]
    v_mfma_f32_32x32x16_bf16 v[8:23], v[228:231], v[24:27], v[8:23]
    v_mfma_f32_32x32x16_bf16 v[8:23], v[232:235], v[28:31], v[8:23]
    s_waitcnt lgkmcnt(0)
    s_nop 0
    s_add_u32 m0, s53, 3072
    s_add_u32 s59, s69, 16384
    buffer_load_dwordx4 v3, s[24:27], s59 offen lds
    v_mfma_f32_32x32x16_bf16 v[8:23], v[236:239], v[32:35], v[8:23]
    v_mfma_f32_32x32x16_bf16 v[8:23], v[240:243], v[36:39], v[8:23]
    s_setprio 0
    s_nop 10
    v_fma_f32 v8, -v247, v116, v8
    v_fma_f32 v9, -v247, v117, v9
    v_fma_f32 v10, -v247, v118, v10
    v_fma_f32 v11, -v247, v119, v11
    v_fma_f32 v12, -v247, v120, v12
    v_fma_f32 v13, -v247, v121, v13
    v_fma_f32 v14, -v247, v122, v14
    v_fma_f32 v15, -v247, v123, v15
    v_fma_f32 v16, -v247, v124, v16
    v_fma_f32 v17, -v247, v125, v17
    v_fma_f32 v18, -v247, v126, v18
    v_fma_f32 v19, -v247, v127, v19
    v_fma_f32 v20, -v247, v128, v20
    v_fma_f32 v21, -v247, v129, v21
    v_fma_f32 v22, -v247, v130, v22
    v_fma_f32 v23, -v247, v131, v23
    v_mul_f32 v72, v8, v8
    v_mul_f32 v73, v9, v9
    v_mul_f32 v74, v10, v10
    v_mul_f32 v75, v11, v11
    v_mul_f32 v76, v12, v12
    v_mul_f32 v77, v13, v13
    v_mul_f32 v78, v14, v14
    v_mul_f32 v79, v15, v15
    v_fma_f32 v72, v72, v245, v244
    v_fma_f32 v73, v73, v245, v244
    v_fma_f32 v74, v74, v245, v244
    v_fma_f32 v75, v75, v245, v244
    v_fma_f32 v76, v76, v245, v244
    v_fma_f32 v77, v77, v245, v244
    v_fma_f32 v78, v78, v245, v244
    v_fma_f32 v79, v79, v245, v244
    v_mul_f32 v72, v72, v8
    v_mul_f32 v73, v73, v9
    v_mul_f32 v74, v74, v10
    v_mul_f32 v75, v75, v11
    v_mul_f32 v76, v76, v12
    v_mul_f32 v77, v77, v13
    v_mul_f32 v78, v78, v14
    v_mul_f32 v79, v79, v15
    v_exp_f32 v72, v72
    v_exp_f32 v73, v73
    v_exp_f32 v74, v74
    v_exp_f32 v75, v75
    v_exp_f32 v76, v76
    v_exp_f32 v77, v77
    v_exp_f32 v78, v78
    v_exp_f32 v79, v79
    v_fma_f32 v72, v72, v246, v246
    v_fma_f32 v73, v73, v246, v246
    v_fma_f32 v74, v74, v246, v246
    v_fma_f32 v75, v75, v246, v246
    v_fma_f32 v76, v76, v246, v246
    v_fma_f32 v77, v77, v246, v246
    v_fma_f32 v78, v78, v246, v246
    v_fma_f32 v79, v79, v246, v246
    v_rcp_f32 v72, v72
    v_rcp_f32 v73, v73
    v_rcp_f32 v74, v74
    v_rcp_f32 v75, v75
    v_rcp_f32 v76, v76
    v_rcp_f32 v77, v77
    v_rcp_f32 v78, v78
    v_rcp_f32 v79, v79
    v_mul_f32 v8, v8, v72
    v_mul_f32 v9, v9, v73
    v_mul_f32 v10, v10, v74
    v_mul_f32 v11, v11, v75
    v_mul_f32 v12, v12, v76
    v_mul_f32 v13, v13, v77
    v_mul_f32 v14, v14, v78
    v_mul_f32 v15, v15, v79
    v_cvt_pk_bf16_f32 v8, v8, v9
    v_cvt_pk_bf16_f32 v9, v10, v11
    v_cvt_pk_bf16_f32 v10, v12, v13
    v_cvt_pk_bf16_f32 v11, v14, v15
    v_min_u32 v8, -2, v8
    v_mul_f32 v72, v16, v16
    v_mul_f32 v73, v17, v17
    v_mul_f32 v74, v18, v18
    v_mul_f32 v75, v19, v19
    v_mul_f32 v76, v20, v20
    v_mul_f32 v77, v21, v21
    v_mul_f32 v78, v22, v22
    v_mul_f32_e64 v79, v23, v23
    v_fma_f32 v72, v72, v245, v244
    v_fma_f32 v73, v73, v245, v244
    v_fma_f32 v74, v74, v245, v244
    v_fma_f32 v75, v75, v245, v244
    v_fma_f32 v76, v76, v245, v244
    v_fma_f32 v77, v77, v245, v244
    v_fma_f32 v78, v78, v245, v244
    v_fma_f32 v79, v79, v245, v244
    v_mul_f32 v72, v72, v16
    v_mul_f32 v73, v73, v17
    v_mul_f32 v74, v74, v18
    v_mul_f32 v75, v75, v19
    v_mul_f32 v76, v76, v20
    v_mul_f32 v77, v77, v21
    v_mul_f32 v78, v78, v22
    v_mul_f32 v79, v79, v23
    v_exp_f32 v72, v72
    v_exp_f32 v73, v73
    v_exp_f32 v74, v74
    v_exp_f32 v75, v75
    v_exp_f32 v76, v76
    v_exp_f32 v77, v77
    v_exp_f32 v78, v78
    v_exp_f32 v79, v79
    v_fma_f32 v72, v72, v246, v246
    v_fma_f32 v73, v73, v246, v246
    v_fma_f32 v74, v74, v246, v246
    v_fma_f32 v75, v75, v246, v246
    v_fma_f32 v76, v76, v246, v246
    v_fma_f32 v77, v77, v246, v246
    v_fma_f32 v78, v78, v246, v246
    v_fma_f32 v79, v79, v246, v246
    v_rcp_f32 v72, v72
    v_rcp_f32 v73, v73
    v_rcp_f32 v74, v74
    v_rcp_f32 v75, v75
    v_rcp_f32 v76, v76
    v_rcp_f32 v77, v77
    v_rcp_f32 v78, v78
    v_rcp_f32 v79, v79
    v_mul_f32 v16, v16, v72
    v_mul_f32 v17, v17, v73
    v_mul_f32 v18, v18, v74
    v_mul_f32 v19, v19, v75
    v_mul_f32 v20, v20, v76
    v_mul_f32 v21, v21, v77
    v_mul_f32 v22, v22, v78
    v_mul_f32 v23, v23, v79
    v_cvt_pk_bf16_f32 v16, v16, v17
    v_cvt_pk_bf16_f32 v17, v18, v19
    v_cvt_pk_bf16_f32 v18, v20, v21
    v_cvt_pk_bf16_f32 v19, v22, v23
    v_min_u32 v16, -2, v16
    s_lshl_b32 s59, s49, 11
    v_add_u32 v252, s59, v2
    s_add_u32 s60, s42, 0
    s_cmp_eq_u32 s64, 1
    s_cbranch_scc1 Lp_47
    buffer_store_dwordx4 v[8:11], v1, s[28:31], s60 offen offset:0 sc1
    buffer_store_dwordx4 v[16:19], v1, s[28:31], s60 offen offset:1024 sc1
    s_branch Lq_48
Lp_47:
    s_nop 0
    buffer_store_dwordx4 v[8:11], v1, s[28:31], s60 offen offset:0
    buffer_store_dwordx4 v[16:19], v1, s[28:31], s60 offen offset:1024
Lq_48:
    ds_write_b128 v252, v[8:11] offset:32768
    ds_write_b128 v252, v[16:19] offset:33792
    s_waitcnt lgkmcnt(0)
    s_barrier
    s_setprio 2
    s_nop 0
    ds_read_b128 v[56:59], v1 offset:32768
    ds_read_b128 v[60:63], v1 offset:33792
    ds_read_b128 v[64:67], v1 offset:34816
    ds_read_b128 v[68:71], v1 offset:35840
    ds_read_b128 v[12:15], v1 offset:36864
    ds_read_b128 v[20:23], v1 offset:37888
    s_waitcnt lgkmcnt(5)
    s_nop 0
    v_mfma_f32_32x32x16_bf16 v[24:39], v[132:135], v[56:59], 0
    ds_read_b128 v[56:59], v1 offset:38912
    s_waitcnt lgkmcnt(5)
    s_nop 0
    v_mfma_f32_32x32x16_bf16 v[24:39], v[136:139], v[60:63], v[24:39]
    s_waitcnt vmcnt(9)
    s_nop 0
    ds_read_b64_tr_b16 v[132:133], v5 offset:0
    ds_read_b64_tr_b16 v[134:135], v5 offset:256
    ds_read_b128 v[60:63], v1 offset:39936
    s_waitcnt lgkmcnt(7)
    s_nop 0
    v_mfma_f32_32x32x16_bf16 v[24:39], v[140:143], v[64:67], v[24:39]
    ds_read_b128 v[64:67], v1 offset:40960
    s_waitcnt lgkmcnt(7)
    s_nop 0
    v_mfma_f32_32x32x16_bf16 v[24:39], v[144:147], v[68:71], v[24:39]
    s_waitcnt vmcnt(8)
    s_nop 0
    ds_read_b64_tr_b16 v[136:137], v5 offset:1024
    ds_read_b64_tr_b16 v[138:139], v5 offset:1280
    ds_read_b128 v[68:71], v1 offset:41984
    s_waitcnt lgkmcnt(9)
    s_nop 0
    v_mfma_f32_32x32x16_bf16 v[24:39], v[100:103], v[12:15], v[24:39]
    ds_read_b128 v[12:15], v1 offset:43008
    s_waitcnt lgkmcnt(9)
    s_nop 0
    v_mfma_f32_32x32x16_bf16 v[24:39], v[104:107], v[20:23], v[24:39]
    s_waitcnt vmcnt(7)
    s_nop 0
    ds_read_b64_tr_b16 v[140:141], v5 offset:2048
    ds_read_b64_tr_b16 v[142:143], v5 offset:2304
    ds_read_b128 v[20:23], v1 offset:44032
    s_waitcnt lgkmcnt(11)
    s_nop 0
    v_mfma_f32_32x32x16_bf16 v[24:39], v[108:111], v[56:59], v[24:39]
    ds_read_b128 v[56:59], v1 offset:45056
    s_waitcnt lgkmcnt(9)
    s_nop 0
    v_mfma_f32_32x32x16_bf16 v[24:39], v[112:115], v[60:63], v[24:39]
    s_waitcnt vmcnt(6)
    s_nop 0
    ds_read_b64_tr_b16 v[144:145], v5 offset:3072
    ds_read_b64_tr_b16 v[146:147], v5 offset:3328
    ds_read_b128 v[60:63], v1 offset:46080
    s_waitcnt lgkmcnt(11)
    s_nop 0
    v_mfma_f32_32x32x16_bf16 v[24:39], v[148:151], v[64:67], v[24:39]
    ds_read_b128 v[64:67], v1 offset:47104
    s_waitcnt lgkmcnt(9)
    s_nop 0
    v_mfma_f32_32x32x16_bf16 v[24:39], v[152:155], v[68:71], v[24:39]
    s_waitcnt vmcnt(5)
    s_nop 0
    ds_read_b64_tr_b16 v[100:101], v4 offset:0
    ds_read_b64_tr_b16 v[102:103], v4 offset:256
    ds_read_b128 v[68:71], v1 offset:48128
    s_waitcnt lgkmcnt(11)
    s_nop 0
    v_mfma_f32_32x32x16_bf16 v[24:39], v[156:159], v[12:15], v[24:39]
    ds_read_b128 v[12:15], v1 offset:49152
    s_waitcnt lgkmcnt(9)
    s_nop 0
    v_mfma_f32_32x32x16_bf16 v[24:39], v[160:163], v[20:23], v[24:39]
    s_waitcnt vmcnt(4)
    s_nop 0
    ds_read_b64_tr_b16 v[104:105], v4 offset:1024
    ds_read_b64_tr_b16 v[106:107], v4 offset:1280
    ds_read_b128 v[20:23], v1 offset:50176
    s_waitcnt lgkmcnt(11)
    s_nop 0
    v_mfma_f32_32x32x16_bf16 v[24:39], v[164:167], v[56:59], v[24:39]
    ds_read_b128 v[56:59], v1 offset:51200
    s_waitcnt lgkmcnt(9)
    s_nop 0
    v_mfma_f32_32x32x16_bf16 v[24:39], v[168:171], v[60:63], v[24:39]
    s_waitcnt vmcnt(3)
    s_nop 0
    ds_read_b64_tr_b16 v[108:109], v4 offset:2048
    ds_read_b64_tr_b16 v[110:111], v4 offset:2304
    ds_read_b128 v[60:63], v1 offset:52224
    s_waitcnt lgkmcnt(11)
    s_nop 0
    v_mfma_f32_32x32x16_bf16 v[24:39], v[172:175], v[64:67], v[24:39]
    ds_read_b128 v[64:67], v1 offset:53248
    s_waitcnt lgkmcnt(9)
    s_nop 0
    v_mfma_f32_32x32x16_bf16 v[24:39], v[176:179], v[68:71], v[24:39]
    s_waitcnt vmcnt(2)
    s_nop 0
    ds_read_b64_tr_b16 v[112:113], v4 offset:3072
    ds_read_b64_tr_b16 v[114:115], v4 offset:3328
    ds_read_b128 v[68:71], v1 offset:54272
    s_waitcnt lgkmcnt(11)
    s_nop 0
    v_mfma_f32_32x32x16_bf16 v[24:39], v[180:183], v[12:15], v[24:39]
    ds_read_b128 v[12:15], v1 offset:55296
    s_waitcnt lgkmcnt(9)
    s_nop 0
    v_mfma_f32_32x32x16_bf16 v[24:39], v[184:187], v[20:23], v[24:39]
    ds_read_b128 v[20:23], v1 offset:56320
    s_waitcnt lgkmcnt(9)
    s_nop 0
    v_mfma_f32_32x32x16_bf16 v[24:39], v[188:191], v[56:59], v[24:39]
    ds_read_b128 v[56:59], v1 offset:57344
    s_waitcnt lgkmcnt(7)
    s_nop 0
    v_mfma_f32_32x32x16_bf16 v[24:39], v[192:195], v[60:63], v[24:39]
    ds_read_b128 v[60:63], v1 offset:58368
    s_waitcnt lgkmcnt(7)
    s_nop 0
    v_mfma_f32_32x32x16_bf16 v[24:39], v[196:199], v[64:67], v[24:39]
    s_add_u32 m0, s53, 131072
    s_add_u32 s59, s69, 32768
    buffer_load_dwordx4 v3, s[24:27], s59 offen lds
    ds_read_b128 v[64:67], v1 offset:59392
    s_waitcnt lgkmcnt(5)
    s_nop 0
    v_mfma_f32_32x32x16_bf16 v[24:39], v[200:203], v[68:71], v[24:39]
    ds_read_b128 v[68:71], v1 offset:60416
    s_waitcnt lgkmcnt(5)
    s_nop 0
    v_mfma_f32_32x32x16_bf16 v[24:39], v[204:207], v[12:15], v[24:39]
    s_add_u32 m0, s53, 132096
    s_add_u32 s59, s69, 49152
    buffer_load_dwordx4 v3, s[24:27], s59 offen lds
    ds_read_b128 v[12:15], v1 offset:61440
    s_waitcnt lgkmcnt(5)
    s_nop 0
    v_mfma_f32_32x32x16_bf16 v[24:39], v[208:211], v[20:23], v[24:39]
    ds_read_b128 v[20:23], v1 offset:62464
    s_waitcnt lgkmcnt(5)
    s_nop 0
    v_mfma_f32_32x32x16_bf16 v[24:39], v[212:215], v[56:59], v[24:39]
    s_add_u32 m0, s53, 133120
    s_add_u32 s59, s69, 65536
    buffer_load_dwordx4 v3, s[24:27], s59 offen lds
    ds_read_b128 v[56:59], v1 offset:63488
    s_waitcnt lgkmcnt(5)
    s_nop 0
    v_mfma_f32_32x32x16_bf16 v[24:39], v[216:219], v[60:63], v[24:39]
    ds_read_b128 v[60:63], v1 offset:64512
    s_waitcnt lgkmcnt(5)
    s_nop 0
    v_mfma_f32_32x32x16_bf16 v[24:39], v[220:223], v[64:67], v[24:39]
    s_add_u32 m0, s53, 134144
    s_add_u32 s59, s69, 81920
    buffer_load_dwordx4 v3, s[24:27], s59 offen lds
    s_waitcnt lgkmcnt(4)
    s_nop 0
    v_mfma_f32_32x32x16_bf16 v[24:39], v[224:227], v[68:71], v[24:39]
    s_waitcnt lgkmcnt(3)
    s_nop 0
    v_mfma_f32_32x32x16_bf16 v[24:39], v[228:231], v[12:15], v[24:39]
    s_add_u32 m0, s53, 0
    s_nop 0
    s_add_u32 s59, s69, 98304
    buffer_load_dwordx4 v3, s[24:27], s59 offen lds
    s_waitcnt lgkmcnt(2)
    s_nop 0
    v_mfma_f32_32x32x16_bf16 v[24:39], v[232:235], v[20:23], v[24:39]
    s_waitcnt lgkmcnt(1)
    s_nop 0
    v_mfma_f32_32x32x16_bf16 v[24:39], v[236:239], v[56:59], v[24:39]
    s_add_u32 m0, s53, 1024
    s_add_u32 s59, s69, 114688
    buffer_load_dwordx4 v3, s[24:27], s59 offen lds
    s_waitcnt lgkmcnt(0)
    s_nop 0
    v_mfma_f32_32x32x16_bf16 v[24:39], v[240:243], v[60:63], v[24:39]
    s_nop 10
    s_nop 0
    v_fma_f32 v24, -v251, v116, v24
    v_fma_f32 v25, -v251, v117, v25
    v_fma_f32 v26, -v251, v118, v26
    v_fma_f32 v27, -v251, v119, v27
    v_fma_f32 v28, -v251, v120, v28
    v_fma_f32 v29, -v251, v121, v29
    v_fma_f32 v30, -v251, v122, v30
    v_fma_f32 v31, -v251, v123, v31
    v_fma_f32 v32, -v251, v124, v32
    v_fma_f32 v33, -v251, v125, v33
    v_fma_f32 v34, -v251, v126, v34
    v_fma_f32 v35, -v251, v127, v35
    v_fma_f32 v36, -v251, v128, v36
    v_fma_f32 v37, -v251, v129, v37
    v_fma_f32 v38, -v251, v130, v38
    v_fma_f32 v39, -v251, v131, v39
    v_mul_f32 v72, v24, v24
    v_mul_f32 v73, v25, v25
    v_mul_f32 v74, v26, v26
    v_mul_f32 v75, v27, v27
    v_mul_f32 v76, v28, v28
    v_mul_f32 v77, v29, v29
    s_add_u32 m0, s53, 2048
    s_add_u32 s59, s69, 131072
    buffer_load_dwordx4 v3, s[24:27], s59 offen lds
    v_mul_f32 v78, v30, v30
    v_mul_f32 v79, v31, v31
    v_fma_f32 v72, v72, v249, v248
    v_fma_f32 v73, v73, v249, v248
    v_fma_f32 v74, v74, v249, v248
    v_fma_f32 v75, v75, v249, v248
    v_fma_f32 v76, v76, v249, v248
    v_fma_f32 v77, v77, v249, v248
    v_fma_f32 v78, v78, v249, v248
    v_fma_f32 v79, v79, v249, v248
    v_mul_f32 v72, v72, v24
    v_mul_f32 v73, v73, v25
    v_mul_f32 v74, v74, v26
    v_mul_f32 v75, v75, v27
    v_mul_f32 v76, v76, v28
    v_mul_f32 v77, v77, v29
    v_mul_f32 v78, v78, v30
    v_mul_f32 v79, v79, v31
    s_add_u32 m0, s53, 3072
    s_add_u32 s59, s69, 147456
    buffer_load_dwordx4 v3, s[24:27], s59 offen lds
    s_waitcnt vmcnt(7)
    s_nop 0
    ds_read_b64_tr_b16 v[148:149], v5 offset:0
    ds_read_b64_tr_b16 v[150:151], v5 offset:256
    v_exp_f32 v72, v72
    v_exp_f32 v73, v73
    v_exp_f32 v74, v74
    v_exp_f32 v75, v75
    v_exp_f32 v76, v76
    v_exp_f32 v77, v77
    v_exp_f32 v78, v78
    v_exp_f32 v79, v79
    v_fma_f32 v72, v72, v250, v250
    v_fma_f32 v73, v73, v250, v250
    s_waitcnt lgkmcnt(0)
    s_nop 0
    s_add_u32 m0, s53, 131072
    s_add_u32 s59, s69, 163840
    buffer_load_dwordx4 v3, s[24:27], s59 offen lds
    s_waitcnt vmcnt(7)
    s_nop 0
    ds_read_b64_tr_b16 v[152:153], v5 offset:1024
    ds_read_b64_tr_b16 v[154:155], v5 offset:1280
    v_fma_f32 v74, v74, v250, v250
    v_fma_f32 v75, v75, v250, v250
    v_fma_f32 v76, v76, v250, v250
    v_fma_f32 v77, v77, v250, v250
    v_fma_f32 v78, v78, v250, v250
    v_fma_f32 v79, v79, v250, v250
    v_rcp_f32 v72, v72
    v_rcp_f32 v73, v73
    v_rcp_f32 v74, v74
    v_rcp_f32 v75, v75
    v_rcp_f32 v76, v76
    v_rcp_f32_e64 v77, v77
    s_waitcnt lgkmcnt(0)
    s_add_u32 m0, s53, 132096
    s_add_u32 s59, s69, 180224
    buffer_load_dwordx4 v3, s[24:27], s59 offen lds
    s_waitcnt vmcnt(7)
    s_nop 0
    ds_read_b64_tr_b16 v[156:157], v5 offset:2048
    ds_read_b64_tr_b16 v[158:159], v5 offset:2304
    v_rcp_f32 v78, v78
    v_rcp_f32 v79, v79
    v_mul_f32 v24, v24, v72
    v_mul_f32 v25, v25, v73
    v_mul_f32 v26, v26, v74
    v_mul_f32 v27, v27, v75
    v_mul_f32 v28, v28, v76
    v_mul_f32 v29, v29, v77
    v_mul_f32 v30, v30, v78
    v_mul_f32_e64 v31, v31, v79
    s_waitcnt lgkmcnt(0)
    s_add_u32 m0, s53, 133120
    s_add_u32 s59, s69, 196608
    buffer_load_dwordx4 v3, s[24:27], s59 offen lds
    s_waitcnt vmcnt(7)
    s_nop 0
    ds_read_b64_tr_b16 v[160:161], v5 offset:3072
    ds_read_b64_tr_b16 v[162:163], v5 offset:3328
    v_cvt_pk_bf16_f32 v24, v24, v25
    v_cvt_pk_bf16_f32 v25, v26, v27
    v_cvt_pk_bf16_f32 v26, v28, v29
    v_cvt_pk_bf16_f32 v27, v30, v31
    v_min_u32 v24, -2, v24
    v_mul_f32 v72, v32, v32
    v_mul_f32 v73, v33, v33
    v_mul_f32 v74, v34, v34
    v_mul_f32 v75, v35, v35
    v_mul_f32 v76, v36, v36
    v_mul_f32 v77, v37, v37
    v_mul_f32 v78, v38, v38
    v_mul_f32_e64 v79, v39, v39
    v_fma_f32 v72, v72, v249, v248
    v_fma_f32 v73, v73, v249, v248
    v_fma_f32 v74, v74, v249, v248
    v_fma_f32 v75, v75, v249, v248
    v_fma_f32 v76, v76, v249, v248
    v_fma_f32 v77, v77, v249, v248
    v_fma_f32 v78, v78, v249, v248
    v_fma_f32 v79, v79, v249, v248
    v_mul_f32 v72, v72, v32
    v_mul_f32_e64 v73, v73, v33
    s_waitcnt lgkmcnt(0)
    s_add_u32 m0, s53, 134144
    s_add_u32 s59, s69, 212992
    buffer_load_dwordx4 v3, s[24:27], s59 offen lds
    s_waitcnt vmcnt(7)
    s_nop 0
    ds_read_b64_tr_b16 v[164:165], v4 offset:0
    ds_read_b64_tr_b16 v[166:167], v4 offset:256
    v_mul_f32 v74, v74, v34
    v_mul_f32 v75, v75, v35
    v_mul_f32 v76, v76, v36
    v_mul_f32 v77, v77, v37
    v_mul_f32 v78, v78, v38
    v_mul_f32 v79, v79, v39
    v_exp_f32 v72, v72
    v_exp_f32 v73, v73
    v_exp_f32 v74, v74
    v_exp_f32 v75, v75
    v_exp_f32 v76, v76
    v_exp_f32_e64 v77, v77
    s_waitcnt vmcnt(6)
    ds_read_b64_tr_b16 v[168:169], v4 offset:1024
    ds_read_b64_tr_b16 v[170:171], v4 offset:1280
    v_exp_f32 v78, v78
    v_exp_f32 v79, v79
    v_fma_f32 v72, v72, v250, v250
    v_fma_f32 v73, v73, v250, v250
    v_fma_f32 v74, v74, v250, v250
    v_fma_f32 v75, v75, v250, v250
    v_fma_f32 v76, v76, v250, v250
    v_fma_f32 v77, v77, v250, v250
    v_fma_f32 v78, v78, v250, v250
    v_fma_f32 v79, v79, v250, v250
    v_rcp_f32 v72, v72
    v_rcp_f32 v73, v73
    v_rcp_f32 v74, v74
    s_waitcnt vmcnt(5)
    ds_read_b64_tr_b16 v[172:173], v4 offset:2048
    ds_read_b64_tr_b16 v[174:175], v4 offset:2304
    v_rcp_f32 v75, v75
    v_rcp_f32 v76, v76
    v_rcp_f32 v77, v77
    v_rcp_f32 v78, v78
    v_rcp_f32 v79, v79
    v_mul_f32 v32, v32, v72
    v_mul_f32 v33, v33, v73
    v_mul_f32 v34, v34, v74
    v_mul_f32 v35, v35, v75
    v_mul_f32 v36, v36, v76
    v_mul_f32 v37, v37, v77
    v_mul_f32 v38, v38, v78
    v_mul_f32_e64 v39, v39, v79
    v_cvt_pk_bf16_f32 v32, v32, v33
    v_cvt_pk_bf16_f32 v33, v34, v35
    v_cvt_pk_bf16_f32 v34, v36, v37
    v_cvt_pk_bf16_f32 v35, v38, v39
    v_min_u32 v32, -2, v32
    s_lshl_b32 s59, s49, 11
    v_add_u32_e64 v252, s59, v2
    s_add_u32 s60, s42, 14336
    s_cmp_eq_u32 s64, 1
    s_cbranch_scc1 Lp_49
    buffer_store_dwordx4 v[24:27], v1, s[28:31], s60 offen offset:0 sc1
    buffer_store_dwordx4 v[32:35], v1, s[28:31], s60 offen offset:1024 sc1
    s_branch Lq_50
Lp_49:
    s_nop 0
    buffer_store_dwordx4 v[24:27], v1, s[28:31], s60 offen offset:0
    buffer_store_dwordx4 v[32:35], v1, s[28:31], s60 offen offset:1024
Lq_50:
    ds_write_b128 v252, v[24:27] offset:47104
    ds_write_b128 v252, v[32:35] offset:48128
    s_waitcnt lgkmcnt(0)
    s_barrier
    s_lshl_b32 s59, s50, 12
    v_add_u32 v72, s59, v1
    v_add_u32 v73, 0x20000, v1
    ds_read_b128 v[56:59], v2 offset:14336
    ds_read_b128 v[60:63], v2 offset:15360
    ds_read_b128 v[64:67], v2 offset:16384
    ds_read_b128 v[68:71], v2 offset:17408
    ds_read_b128 v[116:119], v2 offset:18432
    ds_read_b128 v[120:123], v2 offset:19456
    ds_read_b128 v[124:127], v2 offset:20480
    ds_read_b128 v[128:131], v2 offset:21504
    s_waitcnt lgkmcnt(7)
    s_nop 0
    v_mfma_f32_32x32x16_bf16 v[8:23], v[40:43], v[56:59], 0
    s_waitcnt vmcnt(6)
    s_nop 0
    ds_read_b64_tr_b16 v[176:177], v4 offset:3072
    ds_read_b64_tr_b16 v[178:179], v4 offset:3328
    ds_read_b128 v[56:59], v2 offset:22528
    s_waitcnt lgkmcnt(9)
    s_nop 0
    v_mfma_f32_32x32x16_bf16 v[8:23], v[44:47], v[60:63], v[8:23]
    ds_read_b128 v[60:63], v2 offset:23552
    s_waitcnt lgkmcnt(9)
    s_nop 0
    v_mfma_f32_32x32x16_bf16 v[8:23], v[48:51], v[64:67], v[8:23]
    s_waitcnt vmcnt(5)
    s_nop 0
    ds_read_b64_tr_b16 v[180:181], v5 offset:0
    ds_read_b64_tr_b16 v[182:183], v5 offset:256
    ds_read_b128 v[64:67], v2 offset:24576
    s_waitcnt lgkmcnt(11)
    s_nop 0
    v_mfma_f32_32x32x16_bf16 v[8:23], v[52:55], v[68:71], v[8:23]
    ds_read_b128 v[68:71], v2 offset:25600
    s_waitcnt lgkmcnt(11)
    s_nop 0
    v_mfma_f32_32x32x16_bf16 v[8:23], v[84:87], v[116:119], v[8:23]
    s_waitcnt vmcnt(4)
    s_nop 0
    ds_read_b64_tr_b16 v[184:185], v5 offset:1024
    ds_read_b64_tr_b16 v[186:187], v5 offset:1280
    ds_read_b128 v[116:119], v2 offset:26624
    s_waitcnt lgkmcnt(13)
    s_nop 0
    v_mfma_f32_32x32x16_bf16 v[8:23], v[88:91], v[120:123], v[8:23]
    ds_read_b128 v[120:123], v2 offset:27648
    s_waitcnt lgkmcnt(13)
    s_nop 0
    v_mfma_f32_32x32x16_bf16 v[8:23], v[92:95], v[124:127], v[8:23]
    s_waitcnt vmcnt(3)
    s_nop 0
    ds_read_b64_tr_b16 v[188:189], v5 offset:2048
    ds_read_b64_tr_b16 v[190:191], v5 offset:2304
    s_barrier
    s_nop 0
    ds_read_b128 v[196:199], v72 offset:47104
    ds_read_b128 v[200:203], v72 offset:48128
    ds_read_b128 v[204:207], v72 offset:49152
    ds_read_b128 v[208:211], v72 offset:50176
    ds_read_b128 v[124:127], v2 offset:28672
    s_waitcnt lgkmcnt(15)
    s_nop 0
    v_mfma_f32_32x32x16_bf16 v[8:23], v[96:99], v[128:131], v[8:23]
    ds_read_b128 v[128:131], v2 offset:29696
    v_mfma_f32_32x32x16_bf16 v[8:23], v[132:135], v[56:59], v[8:23]
    s_waitcnt vmcnt(2)
    s_nop 0
    ds_read_b64_tr_b16 v[192:193], v5 offset:3072
    ds_read_b64_tr_b16 v[194:195], v5 offset:3328
    ds_read_b128 v[56:59], v2 offset:30720
    v_mfma_f32_32x32x16_bf16 v[8:23], v[136:139], v[60:63], v[8:23]
    ds_read_b128 v[60:63], v2 offset:31744
    s_waitcnt lgkmcnt(15)
    s_nop 0
    v_mfma_f32_32x32x16_bf16 v[8:23], v[140:143], v[64:67], v[8:23]
    s_add_u32 s60, s58, 0x600000
    s_add_u32 s61, s58, 0xa00000
    buffer_load_dwordx4 v[212:215], v1, s[28:31], s60 offen offset:0 sc1
    buffer_load_dwordx4 v[216:219], v1, s[28:31], s60 offen offset:1024 sc1
    buffer_load_dwordx4 v[220:223], v1, s[28:31], s61 offen offset:0 sc1
    buffer_load_dwordx4 v[224:227], v1, s[28:31], s61 offen offset:1024 sc1
    ds_read_b128 v[64:67], v2 offset:61440
    v_mfma_f32_32x32x16_bf16 v[8:23], v[144:147], v[68:71], v[8:23]
    ds_read_b128 v[68:71], v2 offset:62464
    s_waitcnt lgkmcnt(15)
    s_nop 0
    v_mfma_f32_32x32x16_bf16 v[8:23], v[100:103], v[116:119], v[8:23]
    ds_read_b128 v[116:119], v2 offset:63488
    s_waitcnt lgkmcnt(15)
    s_nop 0
    v_mfma_f32_32x32x16_bf16 v[8:23], v[104:107], v[120:123], v[8:23]
    ds_read_b128 v[120:123], v2 offset:64512
    s_waitcnt lgkmcnt(9)
    s_nop 0
    v_mfma_f32_32x32x16_bf16 v[8:23], v[108:111], v[124:127], v[8:23]
    ds_read_b128 v[124:127], v1 offset:28672
    s_waitcnt lgkmcnt(9)
    s_nop 0
    v_mfma_f32_32x32x16_bf16 v[8:23], v[112:115], v[128:131], v[8:23]
    ds_read_b128 v[128:131], v1 offset:29696
    s_waitcnt lgkmcnt(7)
    s_nop 0
    v_mfma_f32_32x32x16_bf16 v[8:23], v[148:151], v[56:59], v[8:23]
    ds_read_b128 v[56:59], v1 offset:30720
    s_waitcnt lgkmcnt(7)
    s_nop 0
    v_mfma_f32_32x32x16_bf16 v[8:23], v[152:155], v[60:63], v[8:23]
    ds_read_b128 v[60:63], v1 offset:31744
    s_waitcnt lgkmcnt(7)
    s_nop 0
    v_mfma_f32_32x32x16_bf16 v[8:23], v[156:159], v[64:67], v[8:23]
    ds_read_b128 v[64:67], v73 offset:28672
    s_waitcnt lgkmcnt(7)
    s_nop 0
    v_mfma_f32_32x32x16_bf16 v[8:23], v[160:163], v[68:71], v[8:23]
    ds_read_b128 v[68:71], v73 offset:29696
    s_waitcnt lgkmcnt(7)
    s_nop 0
    v_mfma_f32_32x32x16_bf16 v[8:23], v[164:167], v[116:119], v[8:23]
    s_waitcnt lgkmcnt(6)
    s_nop 0
    v_mfma_f32_32x32x16_bf16 v[8:23], v[168:171], v[120:123], v[8:23]
    s_waitcnt lgkmcnt(5)
    s_nop 0
    v_mfma_f32_32x32x16_bf16 v[8:23], v[172:175], v[124:127], v[8:23]
    s_waitcnt lgkmcnt(4)
    s_nop 0
    v_mfma_f32_32x32x16_bf16 v[8:23], v[176:179], v[128:131], v[8:23]
    s_waitcnt lgkmcnt(3)
    s_nop 0
    v_mfma_f32_32x32x16_bf16 v[8:23], v[180:183], v[56:59], v[8:23]
    s_waitcnt lgkmcnt(2)
    s_nop 0
    v_mfma_f32_32x32x16_bf16 v[8:23], v[184:187], v[60:63], v[8:23]
    s_waitcnt lgkmcnt(1)
    s_nop 0
    v_mfma_f32_32x32x16_bf16 v[8:23], v[188:191], v[64:67], v[8:23]
    s_waitcnt lgkmcnt(0)
    s_nop 0
    v_mfma_f32_32x32x16_bf16 v[8:23], v[192:195], v[68:71], v[8:23]
    s_xor_b32 s60, s58, 0x8000
    s_add_u32 s60, s60, 0x1000000
    s_nop 9
    v_add_f32 v8, v8, v196
    v_add_f32 v9, v9, v197
    v_add_f32 v10, v10, v198
    v_add_f32 v11, v11, v199
    v_add_f32 v12, v12, v200
    v_add_f32 v13, v13, v201
    v_add_f32 v14, v14, v202
    v_add_f32 v15, v15, v203
    v_add_f32 v16, v16, v204
    v_add_f32 v17, v17, v205
    v_add_f32 v18, v18, v206
    v_add_f32 v19, v19, v207
    v_add_f32 v20, v20, v208
    v_add_f32 v21, v21, v209
    v_add_f32 v22, v22, v210
    v_add_f32_e64 v23, v23, v211
    v_cvt_pk_bf16_f32 v8, v8, v9
    v_cvt_pk_bf16_f32 v9, v10, v11
    v_cvt_pk_bf16_f32 v10, v12, v13
    v_cvt_pk_bf16_f32 v11, v14, v15
    v_min_u32_e64 v8, -2, v8
    v_cvt_pk_bf16_f32 v16, v16, v17
    v_cvt_pk_bf16_f32 v17, v18, v19
    v_cvt_pk_bf16_f32 v18, v20, v21
    v_cvt_pk_bf16_f32 v19, v22, v23
    v_min_u32_e64 v16, -2, v16
    buffer_store_dwordx4 v[8:11], v1, s[28:31], s60 offen offset:0 sc1
    buffer_store_dwordx4 v[16:19], v1, s[28:31], s60 offen offset:1024 sc1
    s_setprio 0
    s_barrier
    s_waitcnt vmcnt(2)
    v_lshlrev_b32 v24, 16, v212
    v_and_b32 v25, 0xffff0000, v212
    v_lshlrev_b32_e64 v26, 16, v213
    v_and_b32 v27, 0xffff0000, v213
    v_lshlrev_b32_e64 v28, 16, v214
    v_and_b32 v29, 0xffff0000, v214
    v_lshlrev_b32_e64 v30, 16, v215
    v_and_b32 v31, 0xffff0000, v215
    v_lshlrev_b32_e64 v32, 16, v216
    v_and_b32 v33, 0xffff0000, v216
    v_lshlrev_b32_e64 v34, 16, v217
    v_and_b32 v35, 0xffff0000, v217
    v_lshlrev_b32_e64 v36, 16, v218
    v_and_b32 v37, 0xffff0000, v218
    v_lshlrev_b32_e64 v38, 16, v219
    v_and_b32 v39, 0xffff0000, v219
    v_lshlrev_b32_e64 v196, 16, v220
    v_and_b32 v197, 0xffff0000, v220
    v_lshlrev_b32_e64 v198, 16, v221
    v_and_b32 v199, 0xffff0000, v221
    v_lshlrev_b32_e64 v200, 16, v222
    v_and_b32 v201, 0xffff0000, v222
    v_lshlrev_b32_e64 v202, 16, v223
    v_and_b32 v203, 0xffff0000, v223
    v_lshlrev_b32_e64 v204, 16, v224
    v_and_b32 v205, 0xffff0000, v224
    v_lshlrev_b32_e64 v206, 16, v225
    v_and_b32 v207, 0xffff0000, v225
    v_lshlrev_b32_e64 v208, 16, v226
    v_and_b32 v209, 0xffff0000, v226
    v_lshlrev_b32_e64 v210, 16, v227
    v_and_b32 v211, 0xffff0000, v227
    v_add_f32 v24, v24, v196
    v_add_f32 v25, v25, v197
    v_add_f32 v26, v26, v198
    v_add_f32 v27, v27, v199
    v_add_f32 v28, v28, v200
    v_add_f32 v29, v29, v201
    v_add_f32 v30, v30, v202
    v_add_f32 v31, v31, v203
    v_add_f32 v32, v32, v204
    v_add_f32 v33, v33, v205
    v_add_f32 v34, v34, v206
    v_add_f32 v35, v35, v207
    v_add_f32 v36, v36, v208
    v_add_f32 v37, v37, v209
    v_add_f32 v38, v38, v210
    v_add_f32 v39, v39, v211
    s_add_u32 s68, s58, 0x1000000
    v_and_b32 v253, 31, v0
    v_lshlrev_b32 v253, 10, v253
    v_lshrrev_b32_e64 v254, 5, v0
    v_lshl_add_u32 v253, v254, 4, v253
    s_lshl_b32 s60, s47, 15
    s_lshl_b32 s61, s48, 8
    s_add_u32 s60, s60, s61
    s_lshl_b32 s61, s50, 6
    s_add_u32 s60, s60, s61
    s_nop 0
    s_add_u32 s59, s53, 131072
    v_and_b32_e64 v74, 31, v0
    v_mul_u32_u24 v74, 80, v74
    v_lshrrev_b32_e64 v75, 5, v0
    v_lshl_add_u32 v74, v75, 4, v74
    v_add_u32 v74, s59, v74
    v_lshrrev_b32 v75, 2, v0
    v_mul_u32_u24 v75, 80, v75
    v_and_b32_e64 v76, 3, v0
    v_lshl_add_u32 v75, v76, 4, v75
    v_add_u32_e64 v75, s59, v75
    ds_read_b128 v[56:59], v1 offset:32768
    ds_read_b128 v[60:63], v1 offset:33792
    ds_read_b128 v[64:67], v1 offset:34816
    ds_read_b128 v[68:71], v1 offset:35840
    ds_read_b128 v[116:119], v1 offset:36864
    ds_read_b128 v[120:123], v1 offset:37888
    ds_read_b128 v[124:127], v1 offset:38912
    ds_read_b128 v[128:131], v1 offset:39936
    s_waitcnt lgkmcnt(7)
    s_nop 0
    v_mfma_f32_32x32x16_bf16 v[24:39], v[40:43], v[56:59], v[24:39]
    ds_read_b128 v[56:59], v1 offset:40960
    s_waitcnt lgkmcnt(7)
    s_nop 0
    v_mfma_f32_32x32x16_bf16 v[24:39], v[44:47], v[60:63], v[24:39]
    ds_read_b128 v[60:63], v1 offset:41984
    s_waitcnt lgkmcnt(7)
    s_nop 0
    v_mfma_f32_32x32x16_bf16 v[24:39], v[48:51], v[64:67], v[24:39]
    buffer_load_dwordx4 v[212:215], v1, s[28:31], s68 offen offset:0 sc1
    buffer_load_dwordx4 v[216:219], v1, s[28:31], s68 offen offset:1024 sc1
    ds_read_b128 v[64:67], v1 offset:43008
    s_waitcnt lgkmcnt(7)
    s_nop 0
    v_mfma_f32_32x32x16_bf16 v[24:39], v[52:55], v[68:71], v[24:39]
    ds_read_b128 v[68:71], v1 offset:44032
    s_waitcnt lgkmcnt(7)
    s_nop 0
    v_mfma_f32_32x32x16_bf16 v[24:39], v[84:87], v[116:119], v[24:39]
    ds_read_b128 v[116:119], v1 offset:45056
    s_waitcnt lgkmcnt(7)
    s_nop 0
    v_mfma_f32_32x32x16_bf16 v[24:39], v[88:91], v[120:123], v[24:39]
    ds_read_b128 v[120:123], v1 offset:46080
    s_waitcnt lgkmcnt(7)
    s_nop 0
    v_mfma_f32_32x32x16_bf16 v[24:39], v[92:95], v[124:127], v[24:39]
    ds_read_b128 v[124:127], v2 offset:0
    s_waitcnt lgkmcnt(7)
    s_nop 0
    v_mfma_f32_32x32x16_bf16 v[24:39], v[96:99], v[128:131], v[24:39]
    ds_read_b128 v[128:131], v2 offset:1024
    s_waitcnt lgkmcnt(7)
    s_nop 0
    v_mfma_f32_32x32x16_bf16 v[24:39], v[132:135], v[56:59], v[24:39]
    s_barrier
    s_nop 0
    ds_read_b128 v[196:199], v72 offset:47104
    ds_read_b128 v[200:203], v72 offset:48128
    ds_read_b128 v[204:207], v72 offset:49152
    ds_read_b128 v[208:211], v72 offset:50176
    ds_read_b128 v[56:59], v2 offset:2048
    s_waitcnt lgkmcnt(11)
    s_nop 0
    v_mfma_f32_32x32x16_bf16 v[24:39], v[136:139], v[60:63], v[24:39]
    ds_read_b128 v[60:63], v2 offset:3072
    s_waitcnt lgkmcnt(11)
    s_nop 0
    v_mfma_f32_32x32x16_bf16 v[24:39], v[140:143], v[64:67], v[24:39]
    ds_read_b128 v[64:67], v2 offset:4096
    s_waitcnt lgkmcnt(11)
    s_nop 0
    v_mfma_f32_32x32x16_bf16 v[24:39], v[144:147], v[68:71], v[24:39]
    ds_read_b128 v[68:71], v2 offset:5120
    s_waitcnt lgkmcnt(11)
    s_nop 0
    v_mfma_f32_32x32x16_bf16 v[24:39], v[100:103], v[116:119], v[24:39]
    ds_read_b128 v[116:119], v2 offset:6144
    s_waitcnt lgkmcnt(11)
    s_nop 0
    v_mfma_f32_32x32x16_bf16 v[24:39], v[104:107], v[120:123], v[24:39]
    ds_read_b128 v[120:123], v2 offset:7168
    s_waitcnt lgkmcnt(11)
    s_nop 0
    v_mfma_f32_32x32x16_bf16 v[24:39], v[108:111], v[124:127], v[24:39]
    ds_read_b128 v[124:127], v2 offset:8192
    s_waitcnt lgkmcnt(11)
    s_nop 0
    v_mfma_f32_32x32x16_bf16 v[24:39], v[112:115], v[128:131], v[24:39]
    ds_read_b128 v[128:131], v2 offset:9216
    s_waitcnt lgkmcnt(7)
    s_nop 0
    v_mfma_f32_32x32x16_bf16 v[24:39], v[148:151], v[56:59], v[24:39]
    s_mov_b32 s67, 0
    s_waitcnt vmcnt(0)
    s_branch Lf_53
Lw_51:
    s_nop 0
    buffer_load_dwordx4 v[212:215], v1, s[28:31], s68 offen offset:0 sc1
    buffer_load_dwordx4 v[216:219], v1, s[28:31], s68 offen offset:1024 sc1
    s_add_u32 s67, s67, 1
    s_waitcnt vmcnt(0)
Lf_53:
    v_max_u32_e64 v252, v212, v216
    v_cmp_eq_u32 vcc, -1, v252
    s_cbranch_vccz Lg_52
    s_cmp_lt_u32 s67, 1000000
    s_cbranch_scc1 Lw_51
Lg_52:
    s_nop 0
    ds_read_b128 v[56:59], v2 offset:10240
    s_waitcnt lgkmcnt(7)
    s_nop 0
    v_mfma_f32_32x32x16_bf16 v[24:39], v[152:155], v[60:63], v[24:39]
    v_lshlrev_b32_e64 v228, 16, v212
    v_and_b32 v229, 0xffff0000, v212
    v_lshlrev_b32_e64 v230, 16, v213
    v_and_b32 v231, 0xffff0000, v213
    ds_read_b128 v[60:63], v2 offset:11264
    s_waitcnt lgkmcnt(7)
    s_nop 0
    v_mfma_f32_32x32x16_bf16 v[24:39], v[156:159], v[64:67], v[24:39]
    v_lshlrev_b32_e64 v232, 16, v214
    v_and_b32 v233, 0xffff0000, v214
    v_lshlrev_b32_e64 v234, 16, v215
    v_and_b32 v235, 0xffff0000, v215
    ds_read_b128 v[64:67], v2 offset:12288
    s_waitcnt lgkmcnt(7)
    s_nop 0
    v_mfma_f32_32x32x16_bf16 v[24:39], v[160:163], v[68:71], v[24:39]
    v_lshlrev_b32_e64 v236, 16, v216
    v_and_b32 v237, 0xffff0000, v216
    v_lshlrev_b32_e64 v238, 16, v217
    v_and_b32 v239, 0xffff0000, v217
    ds_read_b128 v[68:71], v2 offset:13312
    s_waitcnt lgkmcnt(7)
    s_nop 0
    v_mfma_f32_32x32x16_bf16 v[24:39], v[164:167], v[116:119], v[24:39]
    v_lshlrev_b32_e64 v240, 16, v218
    v_and_b32 v241, 0xffff0000, v218
    v_lshlrev_b32_e64 v242, 16, v219
    v_and_b32 v243, 0xffff0000, v219
    s_waitcnt lgkmcnt(6)
    s_nop 0
    v_mfma_f32_32x32x16_bf16 v[24:39], v[168:171], v[120:123], v[24:39]
    v_add_f32 v196, v196, v228
    v_add_f32 v197, v197, v229
    v_add_f32 v198, v198, v230
    v_add_f32_e64 v199, v199, v231
    s_waitcnt lgkmcnt(5)
    v_mfma_f32_32x32x16_bf16 v[24:39], v[172:175], v[124:127], v[24:39]
    v_add_f32 v200, v200, v232
    v_add_f32 v201, v201, v233
    v_add_f32 v202, v202, v234
    v_add_f32_e64 v203, v203, v235
    s_waitcnt lgkmcnt(4)
    v_mfma_f32_32x32x16_bf16 v[24:39], v[176:179], v[128:131], v[24:39]
    v_add_f32 v204, v204, v236
    v_add_f32 v205, v205, v237
    v_add_f32 v206, v206, v238
    v_add_f32_e64 v207, v207, v239
    s_waitcnt lgkmcnt(3)
    v_mfma_f32_32x32x16_bf16 v[24:39], v[180:183], v[56:59], v[24:39]
    v_add_f32 v208, v208, v240
    v_add_f32 v209, v209, v241
    v_add_f32 v210, v210, v242
    v_add_f32_e64 v211, v211, v243
    s_waitcnt lgkmcnt(2)
    v_mfma_f32_32x32x16_bf16 v[24:39], v[184:187], v[60:63], v[24:39]
    s_waitcnt lgkmcnt(1)
    s_nop 0
    v_mfma_f32_32x32x16_bf16 v[24:39], v[188:191], v[64:67], v[24:39]
    s_waitcnt lgkmcnt(0)
    s_nop 0
    v_mfma_f32_32x32x16_bf16 v[24:39], v[192:195], v[68:71], v[24:39]
    s_nop 11
    s_nop 0
    v_pk_add_f32 v[24:25], v[24:25], v[196:197]
    v_pk_add_f32 v[26:27], v[26:27], v[198:199]
    v_pk_add_f32 v[28:29], v[28:29], v[200:201]
    v_pk_add_f32 v[30:31], v[30:31], v[202:203]
    v_pk_add_f32 v[32:33], v[32:33], v[204:205]
    v_pk_add_f32 v[34:35], v[34:35], v[206:207]
    v_pk_add_f32 v[36:37], v[36:37], v[208:209]
    v_pk_add_f32 v[38:39], v[38:39], v[210:211]
    v_cvt_pk_bf16_f32 v24, v24, v25
    v_cvt_pk_bf16_f32 v25, v26, v27
    v_cvt_pk_bf16_f32 v26, v28, v29
    v_cvt_pk_bf16_f32 v27, v30, v31
    v_cvt_pk_bf16_f32 v32, v32, v33
    v_cvt_pk_bf16_f32 v33, v34, v35
    v_cvt_pk_bf16_f32 v34, v36, v37
    v_cvt_pk_bf16_f32 v35, v38, v39
    ds_write_b128 v74, v[24:27]
    ds_write_b128 v74, v[32:35] offset:32
    ds_read_b128 v[24:27], v75
    ds_read_b128 v[32:35], v75 offset:1280
    s_add_u32 s61, s60, 0x4000
    s_waitcnt lgkmcnt(1)
    s_nop 0
    buffer_store_dwordx4 v[24:27], v3, s[36:39], s60 offen
    s_waitcnt lgkmcnt(0)
    s_nop 0
    buffer_store_dwordx4 v[32:35], v3, s[36:39], s61 offen
    s_branch L_join
L_w7:
    s_setprio 3
    s_add_u32 m0, s75, 32768
    s_nop 0
    s_nop 0
    buffer_load_dwordx4 v1, s[28:31], s54 offen offset:0 sc1 lds
    buffer_load_dwordx4 v1, s[28:31], s54 offen offset:1024 sc1 lds
    buffer_load_dwordx4 v1, s[28:31], s54 offen offset:2048 sc1 lds
    buffer_load_dwordx4 v1, s[28:31], s54 offen offset:3072 sc1 lds
    s_add_u32 m0, s75, 36864
    s_nop 0
    s_nop 0
    buffer_load_dwordx4 v1, s[28:31], s41 offen offset:0 sc1 lds
    buffer_load_dwordx4 v1, s[28:31], s41 offen offset:1024 sc1 lds
    buffer_load_dwordx4 v1, s[28:31], s41 offen offset:2048 sc1 lds
    buffer_load_dwordx4 v1, s[28:31], s41 offen offset:3072 sc1 lds
    s_mov_b32 s67, 0
    s_waitcnt vmcnt(8)
    s_branch Lf_56
Lw_54:
    s_nop 0
    buffer_load_dwordx4 v[24:27], v1, s[28:31], s65 offen offset:0 sc1
    buffer_load_dwordx4 v[28:31], v1, s[28:31], s65 offen offset:1024 sc1
    buffer_load_dwordx4 v[32:35], v1, s[28:31], s65 offen offset:2048 sc1
    buffer_load_dwordx4 v[36:39], v1, s[28:31], s65 offen offset:3072 sc1
    buffer_load_dwordx4 v[40:43], v1, s[28:31], s66 offen offset:0 sc1
    buffer_load_dwordx4 v[44:47], v1, s[28:31], s66 offen offset:1024 sc1
    buffer_load_dwordx4 v[48:51], v1, s[28:31], s66 offen offset:2048 sc1
    buffer_load_dwordx4 v[52:55], v1, s[28:31], s66 offen offset:3072 sc1
    s_add_u32 s67, s67, 1
    s_waitcnt vmcnt(0)
Lf_56:
    v_max_u32_e64 v252, v24, v25
    v_max3_u32 v252, v252, v26, v27
    v_max3_u32 v252, v252, v28, v29
    v_max3_u32 v252, v252, v30, v31
    v_max3_u32 v252, v252, v32, v33
    v_max3_u32 v252, v252, v34, v35
    v_max3_u32 v252, v252, v36, v37
    v_max3_u32 v252, v252, v38, v39
    v_max3_u32 v252, v252, v40, v41
    v_max3_u32 v252, v252, v42, v43
    v_max3_u32 v252, v252, v44, v45
    v_max3_u32 v252, v252, v46, v47
    v_max3_u32 v252, v252, v48, v49
    v_max3_u32 v252, v252, v50, v51
    v_max3_u32 v252, v252, v52, v53
    v_max3_u32 v252, v252, v54, v55
    v_cmp_eq_u32 vcc, -1, v252
    s_cbranch_vccz Lg_55
    s_cmp_lt_u32 s67, 1000000
    s_cbranch_scc1 Lw_54
Lg_55:
    v_add_f32 v24, v24, v32
    v_add_f32 v25, v25, v33
    v_add_f32 v26, v26, v34
    v_add_f32 v27, v27, v35
    v_add_f32 v28, v28, v36
    v_add_f32 v29, v29, v37
    v_add_f32 v30, v30, v38
    v_add_f32 v31, v31, v39
    v_add_f32 v24, v24, v28
    v_add_f32 v25, v25, v29
    v_add_f32 v26, v26, v30
    v_add_f32 v27, v27, v31
    v_add_f32 v24, v24, v25
    v_add_f32 v26, v26, v27
    v_add_f32 v24, v24, v26
    v_mul_f32 v24, 0x3b000000, v24
    v_mov_b32 v25, v24
    s_nop 1
    v_permlane32_swap_b32 v24, v25
    v_mov_b32 v247, v24
    v_fma_f32 v25, -v24, v24, v25
    v_max_f32_e64 v25, 0, v25
    v_add_f32 v26, 0x3727c5ac, v25
    v_rsq_f32 v26, v26
    s_nop 0
    v_rcp_f32_e64 v246, v26
    v_mul_f32 v244, 0xc0135761, v26
    v_mul_f32 v25, v26, v26
    v_mul_f32 v25, v25, v26
    v_mul_f32 v245, 0xbdd2d3e8, v25
    ds_write_b128 v2, v[244:247] offset:61440
    v_add_f32 v40, v40, v48
    v_add_f32 v41, v41, v49
    v_add_f32 v42, v42, v50
    v_add_f32 v43, v43, v51
    v_add_f32 v44, v44, v52
    v_add_f32 v45, v45, v53
    v_add_f32 v46, v46, v54
    v_add_f32 v47, v47, v55
    v_add_f32 v40, v40, v44
    v_add_f32 v41, v41, v45
    v_add_f32 v42, v42, v46
    v_add_f32 v43, v43, v47
    v_add_f32 v40, v40, v41
    v_add_f32 v42, v42, v43
    v_add_f32_e64 v40, v40, v42
    v_mul_f32 v40, 0x3b000000, v40
    v_mov_b32 v41, v40
    s_nop 1
    v_permlane32_swap_b32 v40, v41
    v_mov_b32 v251, v40
    v_fma_f32 v41, -v40, v40, v41
    v_max_f32_e64 v41, 0, v41
    v_add_f32 v42, 0x3727c5ac, v41
    v_rsq_f32 v42, v42
    s_nop 0
    v_rcp_f32_e64 v250, v42
    v_mul_f32 v248, 0xc0135761, v42
    v_mul_f32 v41, v42, v42
    v_mul_f32 v41, v41, v42
    v_mul_f32 v249, 0xbdd2d3e8, v41
    ds_write_b128 v2, v[248:251] offset:62464
    s_mov_b32 s67, 0
    s_waitcnt vmcnt(0) lgkmcnt(0)
    s_branch Lf_59
Lw_57:
    s_nop 0
    s_add_u32 m0, s75, 32768
    s_nop 0
    s_nop 0
    buffer_load_dwordx4 v1, s[28:31], s54 offen offset:0 sc1 lds
    buffer_load_dwordx4 v1, s[28:31], s54 offen offset:1024 sc1 lds
    buffer_load_dwordx4 v1, s[28:31], s54 offen offset:2048 sc1 lds
    buffer_load_dwordx4 v1, s[28:31], s54 offen offset:3072 sc1 lds
    s_add_u32 m0, s75, 36864
    s_nop 0
    s_nop 0
    buffer_load_dwordx4 v1, s[28:31], s41 offen offset:0 sc1 lds
    buffer_load_dwordx4 v1, s[28:31], s41 offen offset:1024 sc1 lds
    buffer_load_dwordx4 v1, s[28:31], s41 offen offset:2048 sc1 lds
    buffer_load_dwordx4 v1, s[28:31], s41 offen offset:3072 sc1 lds
    s_add_u32 s67, s67, 1
    s_waitcnt vmcnt(0)
Lf_59:
    ds_read_b32 v72, v82 offset:0
    ds_read_b32 v73, v82 offset:1024
    ds_read_b32 v74, v82 offset:2048
    ds_read_b32 v75, v82 offset:3072
    ds_read_b32 v76, v82 offset:4096
    ds_read_b32 v77, v82 offset:5120
    ds_read_b32 v78, v82 offset:6144
    ds_read_b32 v79, v82 offset:7168
    s_waitcnt lgkmcnt(0)
    v_max_u32 v252, v72, v73
    v_max3_u32 v252, v252, v74, v75
    v_max3_u32 v252, v252, v76, v77
    v_max3_u32 v252, v252, v78, v79
    v_cmp_eq_u32 vcc, -1, v252
    s_cbranch_vccz Lg_58
    s_cmp_lt_u32 s67, 1000000
    s_cbranch_scc1 Lw_57
Lg_58:
    s_barrier
    s_barrier
    s_nop 0
    v_add_u32 v73, 0x20000, v1
    s_xor_b32 s61, s44, 1
    s_nop 0
    s_mul_i32 s61, s61, 28672
    s_mov_b32 m0, 65536
    s_add_u32 s59, s61, 0x1200000
    buffer_load_dwordx4 v1, s[28:31], s59 offen offset:0 sc1 lds
    buffer_load_dwordx4 v1, s[28:31], s59 offen offset:1024 sc1 lds
    buffer_load_dwordx4 v1, s[28:31], s59 offen offset:2048 sc1 lds
    buffer_load_dwordx4 v1, s[28:31], s59 offen offset:3072 sc1 lds
    s_mov_b32 m0, 69632
    s_add_u32 s59, s61, 0x1201000
    buffer_load_dwordx4 v1, s[28:31], s59 offen offset:0 sc1 lds
    buffer_load_dwordx4 v1, s[28:31], s59 offen offset:1024 sc1 lds
    buffer_load_dwordx4 v1, s[28:31], s59 offen offset:2048 sc1 lds
    buffer_load_dwordx4 v1, s[28:31], s59 offen offset:3072 sc1 lds
    s_mov_b32 m0, 73728
    s_add_u32 s59, s61, 0x1202000
    buffer_load_dwordx4 v1, s[28:31], s59 offen offset:0 sc1 lds
    buffer_load_dwordx4 v1, s[28:31], s59 offen offset:1024 sc1 lds
    buffer_load_dwordx4 v1, s[28:31], s59 offen offset:2048 sc1 lds
    buffer_load_dwordx4 v1, s[28:31], s59 offen offset:3072 sc1 lds
    s_mov_b32 m0, 77824
    s_add_u32 s59, s61, 0x1203000
    buffer_load_dwordx4 v1, s[28:31], s59 offen offset:0 sc1 lds
    buffer_load_dwordx4 v1, s[28:31], s59 offen offset:1024 sc1 lds
    s_xor_b32 s61, s44, 2
    s_and_b32 s61, s61, -2
    s_mul_i32 s61, s61, 28672
    s_mov_b32 m0, 79872
    s_add_u32 s59, s61, 0x1200000
    buffer_load_dwordx4 v1, s[28:31], s59 offen offset:0 sc1 lds
    buffer_load_dwordx4 v1, s[28:31], s59 offen offset:1024 sc1 lds
    buffer_load_dwordx4 v1, s[28:31], s59 offen offset:2048 sc1 lds
    buffer_load_dwordx4 v1, s[28:31], s59 offen offset:3072 sc1 lds
    s_mov_b32 m0, 83968
    s_add_u32 s59, s61, 0x1201000
    buffer_load_dwordx4 v1, s[28:31], s59 offen offset:0 sc1 lds
    buffer_load_dwordx4 v1, s[28:31], s59 offen offset:1024 sc1 lds
    buffer_load_dwordx4 v1, s[28:31], s59 offen offset:2048 sc1 lds
    buffer_load_dwordx4 v1, s[28:31], s59 offen offset:3072 sc1 lds
    s_mov_b32 m0, 88064
    s_add_u32 s59, s61, 0x1202000
    buffer_load_dwordx4 v1, s[28:31], s59 offen offset:0 sc1 lds
    buffer_load_dwordx4 v1, s[28:31], s59 offen offset:1024 sc1 lds
    buffer_load_dwordx4 v1, s[28:31], s59 offen offset:2048 sc1 lds
    buffer_load_dwordx4 v1, s[28:31], s59 offen offset:3072 sc1 lds
    s_mov_b32 m0, 92160
    s_add_u32 s59, s61, 0x1203000
    buffer_load_dwordx4 v1, s[28:31], s59 offen offset:0 sc1 lds
    buffer_load_dwordx4 v1, s[28:31], s59 offen offset:1024 sc1 lds
    s_xor_b32 s61, s44, 2
    s_and_b32 s61, s61, -2
    s_or_b32 s61, s61, 1
    s_nop 0
    s_mul_i32 s61, s61, 28672
    s_mov_b32 m0, 94208
    s_add_u32 s59, s61, 0x1200000
    buffer_load_dwordx4 v1, s[28:31], s59 offen offset:0 sc1 lds
    buffer_load_dwordx4 v1, s[28:31], s59 offen offset:1024 sc1 lds
    buffer_load_dwordx4 v1, s[28:31], s59 offen offset:2048 sc1 lds
    buffer_load_dwordx4 v1, s[28:31], s59 offen offset:3072 sc1 lds
    s_mov_b32 m0, 126976
    s_add_u32 s59, s61, 0x1201000
    buffer_load_dwordx4 v1, s[28:31], s59 offen offset:0 sc1 lds
    buffer_load_dwordx4 v1, s[28:31], s59 offen offset:1024 sc1 lds
    buffer_load_dwordx4 v1, s[28:31], s59 offen offset:2048 sc1 lds
    buffer_load_dwordx4 v1, s[28:31], s59 offen offset:3072 sc1 lds
    s_mov_b32 m0, 28672
    s_add_u32 s59, s61, 0x1202000
    buffer_load_dwordx4 v1, s[28:31], s59 offen offset:0 sc1 lds
    buffer_load_dwordx4 v1, s[28:31], s59 offen offset:1024 sc1 lds
    buffer_load_dwordx4 v1, s[28:31], s59 offen offset:2048 sc1 lds
    buffer_load_dwordx4 v1, s[28:31], s59 offen offset:3072 sc1 lds
    s_mov_b32 m0, 159744
    s_add_u32 s59, s61, 0x1203000
    buffer_load_dwordx4 v1, s[28:31], s59 offen offset:0 sc1 lds
    buffer_load_dwordx4 v1, s[28:31], s59 offen offset:1024 sc1 lds
    s_mov_b32 s67, 0
    s_waitcnt vmcnt(28)
    s_branch Lf_62
Lw_60:
    s_xor_b32 s61, s44, 1
    s_mul_i32 s61, s61, 28672
    s_mov_b32 m0, 65536
    s_add_u32 s59, s61, 0x1200000
    buffer_load_dwordx4 v1, s[28:31], s59 offen offset:0 sc1 lds
    buffer_load_dwordx4 v1, s[28:31], s59 offen offset:1024 sc1 lds
    buffer_load_dwordx4 v1, s[28:31], s59 offen offset:2048 sc1 lds
    buffer_load_dwordx4 v1, s[28:31], s59 offen offset:3072 sc1 lds
    s_mov_b32 m0, 69632
    s_add_u32 s59, s61, 0x1201000
    buffer_load_dwordx4 v1, s[28:31], s59 offen offset:0 sc1 lds
    buffer_load_dwordx4 v1, s[28:31], s59 offen offset:1024 sc1 lds
    buffer_load_dwordx4 v1, s[28:31], s59 offen offset:2048 sc1 lds
    buffer_load_dwordx4 v1, s[28:31], s59 offen offset:3072 sc1 lds
    s_mov_b32 m0, 73728
    s_add_u32 s59, s61, 0x1202000
    buffer_load_dwordx4 v1, s[28:31], s59 offen offset:0 sc1 lds
    buffer_load_dwordx4 v1, s[28:31], s59 offen offset:1024 sc1 lds
    buffer_load_dwordx4 v1, s[28:31], s59 offen offset:2048 sc1 lds
    buffer_load_dwordx4 v1, s[28:31], s59 offen offset:3072 sc1 lds
    s_mov_b32 m0, 77824
    s_add_u32 s59, s61, 0x1203000
    buffer_load_dwordx4 v1, s[28:31], s59 offen offset:0 sc1 lds
    buffer_load_dwordx4 v1, s[28:31], s59 offen offset:1024 sc1 lds
    s_add_u32 s67, s67, 1
    s_waitcnt vmcnt(0)
Lf_62:
    ds_read_b32 v8, v2 offset:0
    ds_read_b32 v9, v2 offset:1024
    ds_read_b32 v10, v2 offset:2048
    ds_read_b32 v11, v2 offset:3072
    ds_read_b32 v12, v2 offset:4096
    ds_read_b32 v13, v2 offset:5120
    ds_read_b32 v14, v2 offset:6144
    ds_read_b32 v15, v2 offset:7168
    ds_read_b32 v16, v2 offset:8192
    ds_read_b32 v17, v2 offset:9216
    ds_read_b32 v18, v2 offset:10240
    ds_read_b32 v19, v2 offset:11264
    ds_read_b32 v20, v2 offset:12288
    ds_read_b32 v21, v2 offset:13312
    s_waitcnt lgkmcnt(0)
    v_max_u32 v252, v8, v9
    v_max3_u32 v252, v252, v10, v11
    v_max3_u32 v252, v252, v12, v13
    v_max3_u32 v252, v252, v14, v15
    v_max3_u32 v252, v252, v16, v17
    v_max3_u32 v252, v252, v18, v19
    v_max3_u32 v252, v252, v20, v21
    v_cmp_eq_u32 vcc, -1, v252
    s_cbranch_vccz Lg_61
    s_cmp_lt_u32 s67, 1000000
    s_cbranch_scc1 Lw_60
Lg_61:
    s_mov_b32 s67, 0
    s_waitcnt vmcnt(14)
    s_branch Lf_65
Lw_63:
    s_xor_b32 s61, s44, 2
    s_and_b32 s61, s61, -2
    s_mul_i32 s61, s61, 28672
    s_mov_b32 m0, 79872
    s_add_u32 s59, s61, 0x1200000
    buffer_load_dwordx4 v1, s[28:31], s59 offen offset:0 sc1 lds
    buffer_load_dwordx4 v1, s[28:31], s59 offen offset:1024 sc1 lds
    buffer_load_dwordx4 v1, s[28:31], s59 offen offset:2048 sc1 lds
    buffer_load_dwordx4 v1, s[28:31], s59 offen offset:3072 sc1 lds
    s_mov_b32 m0, 83968
    s_add_u32 s59, s61, 0x1201000
    buffer_load_dwordx4 v1, s[28:31], s59 offen offset:0 sc1 lds
    buffer_load_dwordx4 v1, s[28:31], s59 offen offset:1024 sc1 lds
    buffer_load_dwordx4 v1, s[28:31], s59 offen offset:2048 sc1 lds
    buffer_load_dwordx4 v1, s[28:31], s59 offen offset:3072 sc1 lds
    s_mov_b32 m0, 88064
    s_add_u32 s59, s61, 0x1202000
    buffer_load_dwordx4 v1, s[28:31], s59 offen offset:0 sc1 lds
    buffer_load_dwordx4 v1, s[28:31], s59 offen offset:1024 sc1 lds
    buffer_load_dwordx4 v1, s[28:31], s59 offen offset:2048 sc1 lds
    buffer_load_dwordx4 v1, s[28:31], s59 offen offset:3072 sc1 lds
    s_mov_b32 m0, 92160
    s_add_u32 s59, s61, 0x1203000
    buffer_load_dwordx4 v1, s[28:31], s59 offen offset:0 sc1 lds
    buffer_load_dwordx4 v1, s[28:31], s59 offen offset:1024 sc1 lds
    s_add_u32 s67, s67, 1
    s_waitcnt vmcnt(0)
Lf_65:
    ds_read_b32 v8, v2 offset:14336
    ds_read_b32 v9, v2 offset:15360
    ds_read_b32 v10, v2 offset:16384
    ds_read_b32 v11, v2 offset:17408
    ds_read_b32 v12, v2 offset:18432
    ds_read_b32 v13, v2 offset:19456
    ds_read_b32 v14, v2 offset:20480
    ds_read_b32 v15, v2 offset:21504
    ds_read_b32 v16, v2 offset:22528
    ds_read_b32 v17, v2 offset:23552
    ds_read_b32 v18, v2 offset:24576
    ds_read_b32 v19, v2 offset:25600
    ds_read_b32 v20, v2 offset:26624
    ds_read_b32 v21, v2 offset:27648
    s_waitcnt lgkmcnt(0)
    v_max_u32 v252, v8, v9
    v_max3_u32 v252, v252, v10, v11
    v_max3_u32 v252, v252, v12, v13
    v_max3_u32 v252, v252, v14, v15
    v_max3_u32 v252, v252, v16, v17
    v_max3_u32 v252, v252, v18, v19
    v_max3_u32 v252, v252, v20, v21
    v_cmp_eq_u32 vcc, -1, v252
    s_cbranch_vccz Lg_64
    s_cmp_lt_u32 s67, 1000000
    s_cbranch_scc1 Lw_63
Lg_64:
    s_mov_b32 s67, 0
    s_waitcnt vmcnt(0)
    s_branch Lf_68
Lw_66:
    s_xor_b32 s61, s44, 2
    s_and_b32 s61, s61, -2
    s_or_b32 s61, s61, 1
    s_nop 0
    s_mul_i32 s61, s61, 28672
    s_mov_b32 m0, 94208
    s_add_u32 s59, s61, 0x1200000
    buffer_load_dwordx4 v1, s[28:31], s59 offen offset:0 sc1 lds
    buffer_load_dwordx4 v1, s[28:31], s59 offen offset:1024 sc1 lds
    buffer_load_dwordx4 v1, s[28:31], s59 offen offset:2048 sc1 lds
    buffer_load_dwordx4 v1, s[28:31], s59 offen offset:3072 sc1 lds
    s_mov_b32 m0, 126976
    s_add_u32 s59, s61, 0x1201000
    buffer_load_dwordx4 v1, s[28:31], s59 offen offset:0 sc1 lds
    buffer_load_dwordx4 v1, s[28:31], s59 offen offset:1024 sc1 lds
    buffer_load_dwordx4 v1, s[28:31], s59 offen offset:2048 sc1 lds
    buffer_load_dwordx4 v1, s[28:31], s59 offen offset:3072 sc1 lds
    s_mov_b32 m0, 28672
    s_add_u32 s59, s61, 0x1202000
    buffer_load_dwordx4 v1, s[28:31], s59 offen offset:0 sc1 lds
    buffer_load_dwordx4 v1, s[28:31], s59 offen offset:1024 sc1 lds
    buffer_load_dwordx4 v1, s[28:31], s59 offen offset:2048 sc1 lds
    buffer_load_dwordx4 v1, s[28:31], s59 offen offset:3072 sc1 lds
    s_mov_b32 m0, 159744
    s_add_u32 s59, s61, 0x1203000
    buffer_load_dwordx4 v1, s[28:31], s59 offen offset:0 sc1 lds
    buffer_load_dwordx4 v1, s[28:31], s59 offen offset:1024 sc1 lds
    s_add_u32 s67, s67, 1
    s_waitcnt vmcnt(0)
Lf_68:
    ds_read_b32 v8, v2 offset:28672
    ds_read_b32 v9, v2 offset:29696
    ds_read_b32 v10, v2 offset:30720
    ds_read_b32 v11, v2 offset:31744
    ds_read_b32 v12, v2 offset:61440
    ds_read_b32 v13, v2 offset:62464
    ds_read_b32 v14, v2 offset:63488
    ds_read_b32 v15, v2 offset:64512
    ds_read_b32 v16, v1 offset:28672
    ds_read_b32 v17, v1 offset:29696
    ds_read_b32 v18, v1 offset:30720
    ds_read_b32 v19, v1 offset:31744
    ds_read_b32 v20, v73 offset:28672
    ds_read_b32 v21, v73 offset:29696
    s_waitcnt lgkmcnt(0)
    v_max_u32 v252, v8, v9
    v_max3_u32 v252, v252, v10, v11
    v_max3_u32 v252, v252, v12, v13
    v_max3_u32 v252, v252, v14, v15
    v_max3_u32 v252, v252, v16, v17
    v_max3_u32 v252, v252, v18, v19
    v_max3_u32 v252, v252, v20, v21
    v_cmp_eq_u32 vcc, -1, v252
    s_cbranch_vccz Lg_67
    s_cmp_lt_u32 s67, 1000000
    s_cbranch_scc1 Lw_66
Lg_67:
    s_barrier
    s_setprio 2
    s_lshl_b32 s59, s50, 12
    v_add_u32_e64 v72, s59, v1
    v_add_u32 v73, 0x20000, v1
    ds_read_b128 v[56:59], v2 offset:14336
    ds_read_b128 v[60:63], v2 offset:15360
    ds_read_b128 v[64:67], v2 offset:16384
    ds_read_b128 v[68:71], v2 offset:17408
    ds_read_b128 v[116:119], v2 offset:18432
    ds_read_b128 v[120:123], v2 offset:19456
    ds_read_b128 v[124:127], v2 offset:20480
    ds_read_b128 v[128:131], v2 offset:21504
    s_waitcnt lgkmcnt(7)
    s_nop 0
    v_mfma_f32_32x32x16_bf16 v[8:23], v[132:135], v[56:59], 0
    ds_read_b128 v[56:59], v2 offset:22528
    s_waitcnt lgkmcnt(7)
    s_nop 0
    v_mfma_f32_32x32x16_bf16 v[8:23], v[136:139], v[60:63], v[8:23]
    ds_read_b128 v[60:63], v2 offset:23552
    s_waitcnt lgkmcnt(7)
    s_nop 0
    v_mfma_f32_32x32x16_bf16 v[8:23], v[140:143], v[64:67], v[8:23]
    ds_read_b128 v[64:67], v2 offset:24576
    s_waitcnt lgkmcnt(7)
    s_nop 0
    v_mfma_f32_32x32x16_bf16 v[8:23], v[144:147], v[68:71], v[8:23]
    ds_read_b128 v[68:71], v2 offset:25600
    s_waitcnt lgkmcnt(7)
    s_nop 0
    v_mfma_f32_32x32x16_bf16 v[8:23], v[100:103], v[116:119], v[8:23]
    ds_read_b128 v[116:119], v2 offset:26624
    s_waitcnt lgkmcnt(7)
    s_nop 0
    v_mfma_f32_32x32x16_bf16 v[8:23], v[104:107], v[120:123], v[8:23]
    ds_read_b128 v[120:123], v2 offset:27648
    s_waitcnt lgkmcnt(7)
    s_nop 0
    v_mfma_f32_32x32x16_bf16 v[8:23], v[108:111], v[124:127], v[8:23]
    s_barrier
    s_nop 0
    ds_read_b128 v[228:231], v72 offset:47104
    ds_read_b128 v[232:235], v72 offset:48128
    ds_read_b128 v[236:239], v72 offset:49152
    ds_read_b128 v[240:243], v72 offset:50176
    ds_read_b128 v[124:127], v2 offset:28672
    s_waitcnt lgkmcnt(11)
    s_nop 0
    v_mfma_f32_32x32x16_bf16 v[8:23], v[112:115], v[128:131], v[8:23]
    ds_read_b128 v[128:131], v2 offset:29696
    s_waitcnt lgkmcnt(11)
    s_nop 0
    v_mfma_f32_32x32x16_bf16 v[8:23], v[148:151], v[56:59], v[8:23]
    ds_read_b128 v[56:59], v2 offset:30720
    s_waitcnt lgkmcnt(11)
    s_nop 0
    v_mfma_f32_32x32x16_bf16 v[8:23], v[152:155], v[60:63], v[8:23]
    ds_read_b128 v[60:63], v2 offset:31744
    s_waitcnt lgkmcnt(11)
    s_nop 0
    v_mfma_f32_32x32x16_bf16 v[8:23], v[156:159], v[64:67], v[8:23]
    s_add_u32 s60, s58, 0x600000
    s_add_u32 s61, s58, 0xa00000
    buffer_load_dwordx4 v[40:43], v1, s[28:31], s60 offen offset:0 sc1
    buffer_load_dwordx4 v[44:47], v1, s[28:31], s60 offen offset:1024 sc1
    buffer_load_dwordx4 v[48:51], v1, s[28:31], s61 offen offset:0 sc1
    buffer_load_dwordx4 v[52:55], v1, s[28:31], s61 offen offset:1024 sc1
    ds_read_b128 v[64:67], v2 offset:61440
    s_waitcnt lgkmcnt(11)
    s_nop 0
    v_mfma_f32_32x32x16_bf16 v[8:23], v[160:163], v[68:71], v[8:23]
    ds_read_b128 v[68:71], v2 offset:62464
    s_waitcnt lgkmcnt(11)
    s_nop 0
    v_mfma_f32_32x32x16_bf16 v[8:23], v[164:167], v[116:119], v[8:23]
    ds_read_b128 v[116:119], v2 offset:63488
    s_waitcnt lgkmcnt(11)
    s_nop 0
    v_mfma_f32_32x32x16_bf16 v[8:23], v[168:171], v[120:123], v[8:23]
    ds_read_b128 v[120:123], v2 offset:64512
    s_waitcnt lgkmcnt(7)
    s_nop 0
    v_mfma_f32_32x32x16_bf16 v[8:23], v[172:175], v[124:127], v[8:23]
    ds_read_b128 v[124:127], v1 offset:28672
    s_waitcnt lgkmcnt(7)
    s_nop 0
    v_mfma_f32_32x32x16_bf16 v[8:23], v[176:179], v[128:131], v[8:23]
    ds_read_b128 v[128:131], v1 offset:29696
    s_waitcnt lgkmcnt(7)
    s_nop 0
    v_mfma_f32_32x32x16_bf16 v[8:23], v[180:183], v[56:59], v[8:23]
    ds_read_b128 v[56:59], v1 offset:30720
    s_waitcnt lgkmcnt(7)
    s_nop 0
    v_mfma_f32_32x32x16_bf16 v[8:23], v[184:187], v[60:63], v[8:23]
    ds_read_b128 v[60:63], v1 offset:31744
    s_waitcnt lgkmcnt(7)
    s_nop 0
    v_mfma_f32_32x32x16_bf16 v[8:23], v[188:191], v[64:67], v[8:23]
    ds_read_b128 v[64:67], v73 offset:28672
    s_waitcnt lgkmcnt(7)
    s_nop 0
    v_mfma_f32_32x32x16_bf16 v[8:23], v[192:195], v[68:71], v[8:23]
    ds_read_b128 v[68:71], v73 offset:29696
    s_waitcnt lgkmcnt(7)
    s_nop 0
    v_mfma_f32_32x32x16_bf16 v[8:23], v[196:199], v[116:119], v[8:23]
    s_waitcnt lgkmcnt(6)
    s_nop 0
    v_mfma_f32_32x32x16_bf16 v[8:23], v[200:203], v[120:123], v[8:23]
    s_waitcnt lgkmcnt(5)
    s_nop 0
    v_mfma_f32_32x32x16_bf16 v[8:23], v[204:207], v[124:127], v[8:23]
    s_waitcnt lgkmcnt(4)
    s_nop 0
    v_mfma_f32_32x32x16_bf16 v[8:23], v[208:211], v[128:131], v[8:23]
    s_waitcnt lgkmcnt(3)
    s_nop 0
    v_mfma_f32_32x32x16_bf16 v[8:23], v[212:215], v[56:59], v[8:23]
    s_waitcnt lgkmcnt(2)
    s_nop 0
    v_mfma_f32_32x32x16_bf16 v[8:23], v[216:219], v[60:63], v[8:23]
    s_waitcnt lgkmcnt(1)
    s_nop 0
    v_mfma_f32_32x32x16_bf16 v[8:23], v[220:223], v[64:67], v[8:23]
    s_waitcnt lgkmcnt(0)
    s_nop 0
    v_mfma_f32_32x32x16_bf16 v[8:23], v[224:227], v[68:71], v[8:23]
    s_xor_b32 s60, s58, 0x8000
    s_add_u32 s60, s60, 0x1000000
    s_nop 9
    v_add_f32 v8, v8, v228
    v_add_f32 v9, v9, v229
    v_add_f32 v10, v10, v230
    v_add_f32 v11, v11, v231
    v_add_f32 v12, v12, v232
    v_add_f32 v13, v13, v233
    v_add_f32 v14, v14, v234
    v_add_f32 v15, v15, v235
    v_add_f32 v16, v16, v236
    v_add_f32 v17, v17, v237
    v_add_f32 v18, v18, v238
    v_add_f32 v19, v19, v239
    v_add_f32 v20, v20, v240
    v_add_f32 v21, v21, v241
    v_add_f32 v22, v22, v242
    v_add_f32_e64 v23, v23, v243
    v_cvt_pk_bf16_f32 v8, v8, v9
    v_cvt_pk_bf16_f32 v9, v10, v11
    v_cvt_pk_bf16_f32 v10, v12, v13
    v_cvt_pk_bf16_f32 v11, v14, v15
    v_min_u32_e64 v8, -2, v8
    v_cvt_pk_bf16_f32 v16, v16, v17
    v_cvt_pk_bf16_f32 v17, v18, v19
    v_cvt_pk_bf16_f32 v18, v20, v21
    v_cvt_pk_bf16_f32 v19, v22, v23
    v_min_u32_e64 v16, -2, v16
    buffer_store_dwordx4 v[8:11], v1, s[28:31], s60 offen offset:0 sc1
    buffer_store_dwordx4 v[16:19], v1, s[28:31], s60 offen offset:1024 sc1
    s_setprio 0
    s_barrier
    s_waitcnt vmcnt(2)
    v_lshlrev_b32 v24, 16, v40
    v_and_b32 v25, 0xffff0000, v40
    v_lshlrev_b32_e64 v26, 16, v41
    v_and_b32 v27, 0xffff0000, v41
    v_lshlrev_b32_e64 v28, 16, v42
    v_and_b32 v29, 0xffff0000, v42
    v_lshlrev_b32_e64 v30, 16, v43
    v_and_b32 v31, 0xffff0000, v43
    v_lshlrev_b32_e64 v32, 16, v44
    v_and_b32 v33, 0xffff0000, v44
    v_lshlrev_b32_e64 v34, 16, v45
    v_and_b32 v35, 0xffff0000, v45
    v_lshlrev_b32_e64 v36, 16, v46
    v_and_b32 v37, 0xffff0000, v46
    v_lshlrev_b32_e64 v38, 16, v47
    v_and_b32 v39, 0xffff0000, v47
    v_lshlrev_b32_e64 v228, 16, v48
    v_and_b32 v229, 0xffff0000, v48
    v_lshlrev_b32_e64 v230, 16, v49
    v_and_b32 v231, 0xffff0000, v49
    v_lshlrev_b32_e64 v232, 16, v50
    v_and_b32 v233, 0xffff0000, v50
    v_lshlrev_b32_e64 v234, 16, v51
    v_and_b32 v235, 0xffff0000, v51
    v_lshlrev_b32_e64 v236, 16, v52
    v_and_b32 v237, 0xffff0000, v52
    v_lshlrev_b32_e64 v238, 16, v53
    v_and_b32 v239, 0xffff0000, v53
    v_lshlrev_b32_e64 v240, 16, v54
    v_and_b32 v241, 0xffff0000, v54
    v_lshlrev_b32_e64 v242, 16, v55
    v_and_b32 v243, 0xffff0000, v55
    v_add_f32 v24, v24, v228
    v_add_f32 v25, v25, v229
    v_add_f32 v26, v26, v230
    v_add_f32 v27, v27, v231
    v_add_f32 v28, v28, v232
    v_add_f32 v29, v29, v233
    v_add_f32 v30, v30, v234
    v_add_f32 v31, v31, v235
    v_add_f32 v32, v32, v236
    v_add_f32 v33, v33, v237
    v_add_f32 v34, v34, v238
    v_add_f32 v35, v35, v239
    v_add_f32 v36, v36, v240
    v_add_f32 v37, v37, v241
    v_add_f32 v38, v38, v242
    v_add_f32 v39, v39, v243
    s_add_u32 s68, s58, 0x1000000
    v_and_b32 v253, 31, v0
    v_lshlrev_b32 v253, 10, v253
    v_lshrrev_b32_e64 v254, 5, v0
    v_lshl_add_u32 v253, v254, 4, v253
    s_lshl_b32 s60, s47, 15
    s_lshl_b32 s61, s48, 8
    s_add_u32 s60, s60, s61
    s_lshl_b32 s61, s50, 6
    s_add_u32 s60, s60, s61
    s_nop 0
    s_add_u32 s59, s53, 131072
    v_and_b32_e64 v74, 31, v0
    v_mul_u32_u24 v74, 80, v74
    v_lshrrev_b32_e64 v75, 5, v0
    v_lshl_add_u32 v74, v75, 4, v74
    v_add_u32 v74, s59, v74
    v_lshrrev_b32 v75, 2, v0
    v_mul_u32_u24 v75, 80, v75
    v_and_b32_e64 v76, 3, v0
    v_lshl_add_u32 v75, v76, 4, v75
    v_add_u32_e64 v75, s59, v75
    ds_read_b128 v[56:59], v1 offset:32768
    ds_read_b128 v[60:63], v1 offset:33792
    ds_read_b128 v[64:67], v1 offset:34816
    ds_read_b128 v[68:71], v1 offset:35840
    ds_read_b128 v[116:119], v1 offset:36864
    ds_read_b128 v[120:123], v1 offset:37888
    ds_read_b128 v[124:127], v1 offset:38912
    ds_read_b128 v[128:131], v1 offset:39936
    s_waitcnt lgkmcnt(7)
    s_nop 0
    v_mfma_f32_32x32x16_bf16 v[24:39], v[132:135], v[56:59], v[24:39]
    ds_read_b128 v[56:59], v1 offset:40960
    s_waitcnt lgkmcnt(7)
    s_nop 0
    v_mfma_f32_32x32x16_bf16 v[24:39], v[136:139], v[60:63], v[24:39]
    ds_read_b128 v[60:63], v1 offset:41984
    s_waitcnt lgkmcnt(7)
    s_nop 0
    v_mfma_f32_32x32x16_bf16 v[24:39], v[140:143], v[64:67], v[24:39]
    buffer_load_dwordx4 v[40:43], v1, s[28:31], s68 offen offset:0 sc1
    buffer_load_dwordx4 v[44:47], v1, s[28:31], s68 offen offset:1024 sc1
    ds_read_b128 v[64:67], v1 offset:43008
    s_waitcnt lgkmcnt(7)
    s_nop 0
    v_mfma_f32_32x32x16_bf16 v[24:39], v[144:147], v[68:71], v[24:39]
    ds_read_b128 v[68:71], v1 offset:44032
    s_waitcnt lgkmcnt(7)
    s_nop 0
    v_mfma_f32_32x32x16_bf16 v[24:39], v[100:103], v[116:119], v[24:39]
    ds_read_b128 v[116:119], v1 offset:45056
    s_waitcnt lgkmcnt(7)
    s_nop 0
    v_mfma_f32_32x32x16_bf16 v[24:39], v[104:107], v[120:123], v[24:39]
    ds_read_b128 v[120:123], v1 offset:46080
    s_waitcnt lgkmcnt(7)
    s_nop 0
    v_mfma_f32_32x32x16_bf16 v[24:39], v[108:111], v[124:127], v[24:39]
    ds_read_b128 v[124:127], v2 offset:0
    s_waitcnt lgkmcnt(7)
    s_nop 0
    v_mfma_f32_32x32x16_bf16 v[24:39], v[112:115], v[128:131], v[24:39]
    ds_read_b128 v[128:131], v2 offset:1024
    s_waitcnt lgkmcnt(7)
    s_nop 0
    v_mfma_f32_32x32x16_bf16 v[24:39], v[148:151], v[56:59], v[24:39]
    s_barrier
    s_nop 0
    ds_read_b128 v[228:231], v72 offset:47104
    ds_read_b128 v[232:235], v72 offset:48128
    ds_read_b128 v[236:239], v72 offset:49152
    ds_read_b128 v[240:243], v72 offset:50176
    ds_read_b128 v[56:59], v2 offset:2048
    s_waitcnt lgkmcnt(11)
    s_nop 0
    v_mfma_f32_32x32x16_bf16 v[24:39], v[152:155], v[60:63], v[24:39]
    ds_read_b128 v[60:63], v2 offset:3072
    s_waitcnt lgkmcnt(11)
    s_nop 0
    v_mfma_f32_32x32x16_bf16 v[24:39], v[156:159], v[64:67], v[24:39]
    ds_read_b128 v[64:67], v2 offset:4096
    s_waitcnt lgkmcnt(11)
    s_nop 0
    v_mfma_f32_32x32x16_bf16 v[24:39], v[160:163], v[68:71], v[24:39]
    ds_read_b128 v[68:71], v2 offset:5120
    s_waitcnt lgkmcnt(11)
    s_nop 0
    v_mfma_f32_32x32x16_bf16 v[24:39], v[164:167], v[116:119], v[24:39]
    ds_read_b128 v[116:119], v2 offset:6144
    s_waitcnt lgkmcnt(11)
    s_nop 0
    v_mfma_f32_32x32x16_bf16 v[24:39], v[168:171], v[120:123], v[24:39]
    ds_read_b128 v[120:123], v2 offset:7168
    s_waitcnt lgkmcnt(11)
    s_nop 0
    v_mfma_f32_32x32x16_bf16 v[24:39], v[172:175], v[124:127], v[24:39]
    ds_read_b128 v[124:127], v2 offset:8192
    s_waitcnt lgkmcnt(11)
    s_nop 0
    v_mfma_f32_32x32x16_bf16 v[24:39], v[176:179], v[128:131], v[24:39]
    ds_read_b128 v[128:131], v2 offset:9216
    s_waitcnt lgkmcnt(7)
    s_nop 0
    v_mfma_f32_32x32x16_bf16 v[24:39], v[180:183], v[56:59], v[24:39]
    s_mov_b32 s67, 0
    s_waitcnt vmcnt(0)
    s_branch Lf_71
Lw_69:
    s_nop 0
    buffer_load_dwordx4 v[40:43], v1, s[28:31], s68 offen offset:0 sc1
    buffer_load_dwordx4 v[44:47], v1, s[28:31], s68 offen offset:1024 sc1
    s_add_u32 s67, s67, 1
    s_waitcnt vmcnt(0)
Lf_71:
    v_max_u32_e64 v252, v40, v44
    v_cmp_eq_u32 vcc, -1, v252
    s_cbranch_vccz Lg_70
    s_cmp_lt_u32 s67, 1000000
    s_cbranch_scc1 Lw_69
Lg_70:
    s_nop 0
    ds_read_b128 v[56:59], v2 offset:10240
    s_waitcnt lgkmcnt(7)
    s_nop 0
    v_mfma_f32_32x32x16_bf16 v[24:39], v[184:187], v[60:63], v[24:39]
    v_lshlrev_b32_e64 v84, 16, v40
    v_and_b32 v85, 0xffff0000, v40
    v_lshlrev_b32_e64 v86, 16, v41
    v_and_b32 v87, 0xffff0000, v41
    ds_read_b128 v[60:63], v2 offset:11264
    s_waitcnt lgkmcnt(7)
    s_nop 0
    v_mfma_f32_32x32x16_bf16 v[24:39], v[188:191], v[64:67], v[24:39]
    v_lshlrev_b32_e64 v88, 16, v42
    v_and_b32 v89, 0xffff0000, v42
    v_lshlrev_b32_e64 v90, 16, v43
    v_and_b32 v91, 0xffff0000, v43
    ds_read_b128 v[64:67], v2 offset:12288
    s_waitcnt lgkmcnt(7)
    s_nop 0
    v_mfma_f32_32x32x16_bf16 v[24:39], v[192:195], v[68:71], v[24:39]
    v_lshlrev_b32_e64 v92, 16, v44
    v_and_b32 v93, 0xffff0000, v44
    v_lshlrev_b32_e64 v94, 16, v45
    v_and_b32 v95, 0xffff0000, v45
    ds_read_b128 v[68:71], v2 offset:13312
    s_waitcnt lgkmcnt(7)
    s_nop 0
    v_mfma_f32_32x32x16_bf16 v[24:39], v[196:199], v[116:119], v[24:39]
    v_lshlrev_b32_e64 v96, 16, v46
    v_and_b32 v97, 0xffff0000, v46
    v_lshlrev_b32_e64 v98, 16, v47
    v_and_b32 v99, 0xffff0000, v47
    s_waitcnt lgkmcnt(6)
    s_nop 0
    v_mfma_f32_32x32x16_bf16 v[24:39], v[200:203], v[120:123], v[24:39]
    v_add_f32 v228, v228, v84
    v_add_f32 v229, v229, v85
    v_add_f32 v230, v230, v86
    v_add_f32_e64 v231, v231, v87
    s_waitcnt lgkmcnt(5)
    v_mfma_f32_32x32x16_bf16 v[24:39], v[204:207], v[124:127], v[24:39]
    v_add_f32 v232, v232, v88
    v_add_f32 v233, v233, v89
    v_add_f32 v234, v234, v90
    v_add_f32_e64 v235, v235, v91
    s_waitcnt lgkmcnt(4)
    v_mfma_f32_32x32x16_bf16 v[24:39], v[208:211], v[128:131], v[24:39]
    v_add_f32 v236, v236, v92
    v_add_f32 v237, v237, v93
    v_add_f32 v238, v238, v94
    v_add_f32_e64 v239, v239, v95
    s_waitcnt lgkmcnt(3)
    v_mfma_f32_32x32x16_bf16 v[24:39], v[212:215], v[56:59], v[24:39]
    v_add_f32 v240, v240, v96
    v_add_f32 v241, v241, v97
    v_add_f32 v242, v242, v98
    v_add_f32_e64 v243, v243, v99
    s_waitcnt lgkmcnt(2)
    v_mfma_f32_32x32x16_bf16 v[24:39], v[216:219], v[60:63], v[24:39]
    s_waitcnt lgkmcnt(1)
    s_nop 0
    v_mfma_f32_32x32x16_bf16 v[24:39], v[220:223], v[64:67], v[24:39]
    s_waitcnt lgkmcnt(0)
    s_nop 0
    v_mfma_f32_32x32x16_bf16 v[24:39], v[224:227], v[68:71], v[24:39]
    s_nop 11
    s_nop 0
    v_pk_add_f32 v[24:25], v[24:25], v[228:229]
    v_pk_add_f32 v[26:27], v[26:27], v[230:231]
    v_pk_add_f32 v[28:29], v[28:29], v[232:233]
    v_pk_add_f32 v[30:31], v[30:31], v[234:235]
    v_pk_add_f32 v[32:33], v[32:33], v[236:237]
    v_pk_add_f32 v[34:35], v[34:35], v[238:239]
    v_pk_add_f32 v[36:37], v[36:37], v[240:241]
    v_pk_add_f32 v[38:39], v[38:39], v[242:243]
    v_cvt_pk_bf16_f32 v24, v24, v25
    v_cvt_pk_bf16_f32 v25, v26, v27
    v_cvt_pk_bf16_f32 v26, v28, v29
    v_cvt_pk_bf16_f32 v27, v30, v31
    v_cvt_pk_bf16_f32 v32, v32, v33
    v_cvt_pk_bf16_f32 v33, v34, v35
    v_cvt_pk_bf16_f32 v34, v36, v37
    v_cvt_pk_bf16_f32 v35, v38, v39
    ds_write_b128 v74, v[24:27]
    ds_write_b128 v74, v[32:35] offset:32
    ds_read_b128 v[24:27], v75
    ds_read_b128 v[32:35], v75 offset:1280
    s_add_u32 s61, s60, 0x4000
    s_waitcnt lgkmcnt(1)
    s_nop 0
    buffer_store_dwordx4 v[24:27], v3, s[36:39], s60 offen
    s_waitcnt lgkmcnt(0)
    s_nop 0
    buffer_store_dwordx4 v[32:35], v3, s[36:39], s61 offen
L_join:
    s_or_b32 s59, s44, s49
    s_cmp_lg_u32 s59, 0
    s_cbranch_scc1 L_noep
    v_lshrrev_b32 v8, 1, v0
    v_lshlrev_b32 v8, 7, v8
    v_and_b32 v9, 1, v0
    v_lshl_add_u32 v8, v9, 4, v8
    s_mov_b32 s59, 0xe01000
    s_mov_b32 s67, 0
L_ep:
    s_nop 0
    buffer_load_dwordx4 v[12:15], v8, s[28:31], s59 offen sc1
    s_add_u32 s67, s67, 1
    s_waitcnt vmcnt(0)
    v_xor_b32 v12, s40, v12
    v_xor_b32 v13, s40, v13
    v_xor_b32 v14, s40, v14
    v_xor_b32 v15, s40, v15
    v_or3_b32 v12, v12, v13, v14
    v_or_b32_e64 v12, v12, v15
    v_cmp_lt_u32 vcc, 7, v12
    s_cbranch_vccz L_ep2
    s_cmp_lt_u32 s67, 1000000
    s_cbranch_scc1 L_ep
L_ep2:
    v_mov_b32 v9, s40
    s_mov_b32 s59, 0xe02000
    s_mov_b64 exec, 1
    s_nop 0
    buffer_store_dword v9, v1, s[28:31], s59 offen
    s_mov_b64 exec, -1
L_noep:
K_end:
    s_endpgm
L_slow:
    v_mov_b32 v252, 0xff800000
    s_mov_b32 s67, 0x200000
L_slow1:
    buffer_load_dwordx4 v[60:63], v1, s[28:31], s67 offen sc1
    s_waitcnt vmcnt(0)
    s_nop 0
    v_mfma_f32_32x32x16_bf16 v[8:23], v[60:63], v[56:59], 0
    s_add_u32 s67, s67, 2048
    s_nop 11
    s_nop 0
    v_max3_f32 v252, v252, v8, v9
    v_max3_f32 v252, v252, v10, v11
    v_max3_f32 v252, v252, v12, v13
    v_max3_f32 v252, v252, v14, v15
    v_max3_f32 v252, v252, v16, v17
    v_max3_f32 v252, v252, v18, v19
    v_max3_f32 v252, v252, v20, v21
    v_max3_f32 v252, v252, v22, v23
    s_cmp_lt_u32 s67, 0x220000
    s_cbranch_scc1 L_slow1
    v_mov_b32 v253, v252
    s_nop 1
    v_permlane32_swap_b32 v252, v253
    v_max_f32 v252, v252, v253
    v_sub_f32 v24, 0, v252
    v_sub_f32 v25, 0, v252
    v_sub_f32 v26, 0, v252
    v_sub_f32 v27, 0, v252
    v_sub_f32 v28, 0, v252
    v_sub_f32 v29, 0, v252
    v_sub_f32 v30, 0, v252
    v_sub_f32 v31, 0, v252
    v_sub_f32 v32, 0, v252
    v_sub_f32 v33, 0, v252
    v_sub_f32 v34, 0, v252
    v_sub_f32 v35, 0, v252
    v_sub_f32 v36, 0, v252
    v_sub_f32 v37, 0, v252
    v_sub_f32 v38, 0, v252
    v_sub_f32 v39, 0, v252
    v_mov_b32 v40, 0
    v_mov_b32 v41, 0
    v_mov_b32 v42, 0
    v_mov_b32 v43, 0
    v_mov_b32 v44, 0
    v_mov_b32 v45, 0
    v_mov_b32 v46, 0
    v_mov_b32 v47, 0
    v_mov_b32 v48, 0
    v_mov_b32 v49, 0
    v_mov_b32 v50, 0
    v_mov_b32 v51, 0
    v_mov_b32 v52, 0
    v_mov_b32 v53, 0
    v_mov_b32 v54, 0
    v_mov_b32_e64 v55, 0
    s_mov_b32 s67, 0x200000
L_slow2:
    buffer_load_dwordx4 v[60:63], v1, s[28:31], s67 offen sc1
    s_mov_b64 exec, s[62:63]
    s_nop 0
    buffer_load_dwordx4 v[64:67], v1, s[28:31], s67 offen offset:1024 sc1
    buffer_load_dwordx4 v[68:71], v1, s[28:31], s67 offen offset:768 sc1
    s_mov_b64 exec, -1
    s_waitcnt vmcnt(0)
    v_mfma_f32_32x32x16_bf16 v[8:23], v[60:63], v[56:59], v[24:39]
    s_add_u32 s67, s67, 2048
    s_nop 11
    v_exp_f32 v8, v8
    v_exp_f32 v9, v9
    v_exp_f32 v10, v10
    v_exp_f32 v11, v11
    v_exp_f32 v12, v12
    v_exp_f32 v13, v13
    v_exp_f32 v14, v14
    v_exp_f32 v15, v15
    v_exp_f32 v16, v16
    v_exp_f32 v17, v17
    v_exp_f32 v18, v18
    v_exp_f32 v19, v19
    v_exp_f32 v20, v20
    v_exp_f32 v21, v21
    v_exp_f32 v22, v22
    v_exp_f32 v23, v23
    s_nop 1
    v_smfmac_f32_32x32x32_bf16 v[40:55], v[64:67], v[8:15], v7
    v_smfmac_f32_32x32x32_bf16 v[40:55], v[68:71], v[16:23], v7
    s_nop 3
    s_nop 0
    s_cmp_lt_u32 s67, 0x220000
    s_cbranch_scc1 L_slow2
    s_nop 11
    s_branch L_attn_done
L_codeend:
.section .rodata,"a"
.p2align 6
.amdhsa_kernel sequential_preLN__grouped_kv_mqa__mixer_s_mlp__prompt_kernel
  .amdhsa_next_free_vgpr 256
  .amdhsa_next_free_sgpr 102
  .amdhsa_accum_offset 256
  .amdhsa_group_segment_fixed_size 0
  .amdhsa_kernarg_size 104
  .amdhsa_user_sgpr_count 2
  .amdhsa_user_sgpr_kernarg_segment_ptr 1
  .amdhsa_system_sgpr_workgroup_id_x 1
.end_amdhsa_kernel
```
